```python
import torch

def _softmax(x, axis=-1):
    return torch.softmax(x, dim=axis)
def _gelu(x):
    return torch.nn.functional.gelu(x, approximate="tanh")
def _silu(x):
    return torch.nn.functional.silu(x)
def _sigmoid(x):
    return torch.sigmoid(x)
def _layernorm(x, axis=-1, eps=1e-5):
    m = x.mean(dim=axis, keepdim=True)
    v = x.var(dim=axis, keepdim=True, unbiased=False)
    return (x - m) / torch.sqrt(v + eps)
def _scatter_add(tgt, idx, src, axis=0):
    return tgt.clone().index_add_(axis, idx, src)
def _segment_sum(src, seg, n):
    out = torch.zeros((n,) + src.shape[1:], dtype=src.dtype)
    return out.index_add_(0, seg, src)
def _pad(x, pw):
    flat = tuple(v for pair in reversed(pw) for v in pair)
    return torch.nn.functional.pad(x, flat)

kernel_name = 'sequential_preLN__ssm_conv_h3__glu_gated_swiglu__prompt'

def setup_inputs():

    _w = (lambda a: (lambda t: t.to(torch.bfloat16) if t.is_floating_point() else t)(torch.as_tensor(a)))
    def _A_setup():
        B, S, D = 1, 2048, 576
        ks = 4
        return {
            "q": _w((lambda *s: torch.randn(*s, dtype=torch.bfloat16) * 0.05)(B, S, D)),
            "k": _w((lambda *s: torch.randn(*s, dtype=torch.bfloat16) * 0.2)(B, S, D)),
            "v": _w((lambda *s: torch.randn(*s, dtype=torch.bfloat16) * 0.2)(B, S, D)),
            "shift_k": _w((lambda *s: torch.randn(*s, dtype=torch.bfloat16) * 0.2)(D, ks) * 0.5),
            "ssm_k": _w((lambda *s: torch.randn(*s, dtype=torch.bfloat16) * 0.4)(D, S) * (1.0 / S ** 0.5)),
            "ssm_D": _w((lambda *s: torch.randn(*s, dtype=torch.bfloat16) * 0.2)(D)),
        }
    _A_in = _A_setup()

    def _B_setup():
        B, S, D, F = 1, 2048, 576, 4608
        return {
            "x": _w((lambda *s: torch.randn(*s, dtype=torch.bfloat16) * 0.05)(B, S, D)),
            "w1": _w((lambda *s: torch.randn(*s, dtype=torch.bfloat16) * 0.2)(D, F) * (2.0 / D) ** 0.5),
            "w3": _w((lambda *s: torch.randn(*s, dtype=torch.bfloat16) * 0.2)(D, F) * (2.0 / D) ** 0.5),
            "w2": _w((lambda *s: torch.randn(*s, dtype=torch.bfloat16) * 0.2)(F, D) * (2.0 / F) ** 0.5),
        }
    _B_in = _B_setup()

    return {
        "A_q": _A_in["q"],
        "A_k": _A_in["k"],
        "A_v": _A_in["v"],
        "A_shift_k": _A_in["shift_k"],
        "A_ssm_k": _A_in["ssm_k"],
        "A_ssm_D": _A_in["ssm_D"],
        "B_x": _B_in["x"],
        "B_w1": _B_in["w1"],
        "B_w3": _B_in["w3"],
        "B_w2": _B_in["w2"],
    }

def reference(A_q, A_k, A_v, A_shift_k, A_ssm_k, A_ssm_D, B_x, B_w1, B_w3, B_w2):
    def _A_ref(q, k, v, shift_k, ssm_k, ssm_D):
        B, S, D = q.shape
        ks = shift_k.shape[-1]
        k_pad = _pad(k, ((0, 0), (ks - 1, 0), (0, 0)))
        k_shift = torch.zeros_like(k)
        for t in range(ks):
            k_shift = k_shift + k_pad[:, t:t + S, :] * shift_k[:, ks - 1 - t][None, None, :]
        kv = k_shift * v
        L = 2 * S
        kv_pad = _pad(kv, ((0, 0), (0, S), (0, 0)))
        kf_pad = _pad(ssm_k, ((0, 0), (0, S)))
        kv_f = (lambda x, axes=(-2,-1): torch.fft.rfft2(x.float(), dim=axes))(kv_pad[:, None, :, :], axes=(1, 2))
        kf_f = (lambda x, axes=(-2,-1): torch.fft.rfft2(x.float(), dim=axes))(kf_pad[:, None, :], axes=(1, 2))
        kf_f = (lambda x, *d: x.permute(*d))(kf_f, 1, 2, 0)
        y_f = kv_f * kf_f[None, :, :, :]
        y = (lambda x, s, axes=(-2,-1): torch.fft.irfft2(x, s=s, dim=axes).to(torch.bfloat16))(y_f, (1, L), axes=(1, 2))[:, 0, :S, :]
        y = y + kv * ssm_D[None, None, :]
        return q * y

    def _B_ref(x, w1, w3, w2):
        gate = torch.einsum("bsd,df->bsf", x, w1)
        up = torch.einsum("bsd,df->bsf", x, w3)
        h = _silu(gate) * up
        out = torch.einsum("bsf,fd->bsd", h, w2)
        return out

    x = A_q
    h = x + _A_ref(_layernorm(x, axis=-1), A_k, A_v, A_shift_k, A_ssm_k, A_ssm_D)
    h2 = h + _B_ref(_layernorm(h, axis=-1), B_w1, B_w3, B_w2)
    return h2
```

```asm
; @launch kernel=pre_kernel grid=(256,1,1) block=(512,1,1) lds=84512
; @launch kernel=ffn_kernel grid=(256,1,1) block=(256,1,1) lds=159872

.amdgcn_target "amdgcn-amd-amdhsa--gfx950"
.text
.p2align 8
pre_kernel:
  s_load_dwordx4 s[4:7], s[0:1], 0
  s_load_dwordx4 s[8:11], s[0:1], 16
  s_load_dwordx4 s[12:15], s[0:1], 88
  v_lshrrev_b32 v2, 6, v0
  v_and_b32 v1, 7, v0
  v_readfirstlane_b32 s16, v2
  v_bfe_u32 v2, v0, 3, 3
  s_mov_b32 s23, 0x20000
  s_mov_b32 s27, 0x20000
  s_mov_b32 s31, 0x20000
  s_mov_b32 s35, 0x20000
  s_mov_b32 s22, 2359296
  s_mov_b32 s26, 2359296
  s_cmp_ge_u32 s2, 256
  s_cbranch_scc1 pre_end
  s_cmp_lt_u32 s16, 4
  s_cbranch_scc1 pre_low
  s_cmp_eq_u32 s16, 4
  s_cbranch_scc1 pre_ln
  s_cmp_eq_u32 s16, 7
  s_cbranch_scc1 pre_hk
  s_mov_b32 s3, s2
  s_branch pre_kv
pre_low:
  s_add_u32 s3, s2, 112
  s_sub_u32 s17, s2, 144
  s_lshr_b32 s18, s16, 1
  s_lshl_b32 s18, s18, 5
  s_or_b32 s17, s17, s18
  s_cmp_lt_u32 s17, 32
  s_cbranch_scc1 pre_kv
  s_barrier
  s_waitcnt lgkmcnt(0)
  s_mov_b64 exec, 0
  s_and_b32 s92, s16, 3
  s_cmp_lg_u32 s92, 0
  s_cbranch_scc1 pre_lh1_n0
  s_call_b64 s[90:91], kv_hopq0
  s_branch pre_lh1_ret
pre_lh1_n0:
  s_cmp_lg_u32 s92, 1
  s_cbranch_scc1 pre_lh1_n1
  s_call_b64 s[90:91], kv_hopq1
  s_branch pre_lh1_ret
pre_lh1_n1:
  s_cmp_lg_u32 s92, 2
  s_cbranch_scc1 pre_lh1_n2
  s_call_b64 s[90:91], kv_hopq2
  s_branch pre_lh1_ret
pre_lh1_n2:
  s_call_b64 s[90:91], kv_hopq3
pre_lh1_ret:
  s_mov_b64 exec, -1
  s_mov_b64 exec, 0
  s_and_b32 s92, s16, 3
  s_cmp_lg_u32 s92, 0
  s_cbranch_scc1 pre_lh2_n0
  s_call_b64 s[90:91], ln_hopq0
  s_branch pre_lh2_ret
pre_lh2_n0:
  s_cmp_lg_u32 s92, 1
  s_cbranch_scc1 pre_lh2_n1
  s_call_b64 s[90:91], ln_hopq1
  s_branch pre_lh2_ret
pre_lh2_n1:
  s_cmp_lg_u32 s92, 2
  s_cbranch_scc1 pre_lh2_n2
  s_call_b64 s[90:91], ln_hopq2
  s_branch pre_lh2_ret
pre_lh2_n2:
  s_call_b64 s[90:91], ln_hopq3
pre_lh2_ret:
  s_mov_b64 exec, -1
  s_cmp_lt_u32 s2, 144
  s_cbranch_scc1 pre_conv
  s_branch pre_join
pre_end:
  s_endpgm
  .p2align 9
pre_kv:
kv_hopq0:
kv_hop0:
  s_cbranch_execz kv_hopret
  s_mov_b32 s18, 477218589
  s_mul_hi_u32 s17, s3, s18
  s_mul_i32 s18, s17, 9
  s_sub_u32 s18, s3, s18
  s_lshl_b32 s36, s18, 5
  s_add_u32 s36, s36, s17
  s_and_b32 s19, s16, 1
  s_lshl_b32 s17, s17, 1
  s_add_u32 s17, s17, s19
  s_lshr_b32 s37, s16, 2
  s_lshl_b32 s37, s37, 2
  s_add_u32 s37, s37, 84488
  s_lshl_b32 s19, s17, 5
  v_lshl_add_u32 v3, v2, 2, s19
  s_lshl_b32 s18, s18, 3
  v_add_u32 v1, s18, v1
  v_mul_u32_u24 v4, 1152, v3
  v_lshl_add_u32 v4, v1, 4, v4
  v_subrev_u32 v5, 3456, v4
  v_lshlrev_b32 v6, 6, v1
  s_waitcnt lgkmcnt(0)
  s_mov_b32 s20, s6
  s_mov_b32 s21, s7
  s_mov_b32 s24, s8
  s_mov_b32 s25, s9
  buffer_load_dwordx4 v[12:15], v5, s[20:23], 0 offen offset:0
  buffer_load_dwordx4 v[16:19], v5, s[20:23], 0 offen offset:1152
  buffer_load_dwordx4 v[20:23], v5, s[20:23], 0 offen offset:2304
  buffer_load_dwordx4 v[24:27], v4, s[20:23], 0 offen offset:0
  buffer_load_dwordx4 v[28:31], v4, s[20:23], 0 offen offset:1152
  buffer_load_dwordx4 v[32:35], v4, s[20:23], 0 offen offset:2304
  buffer_load_dwordx4 v[36:39], v4, s[20:23], 0 offen offset:3456
  s_mov_b32 s28, s10
  s_mov_b32 s29, s11
  s_mov_b32 s30, 4608
  buffer_load_dwordx4 v[56:59], v6, s[28:31], 0 offen offset:0
  buffer_load_dwordx4 v[60:63], v6, s[28:31], 0 offen offset:16
  buffer_load_dwordx4 v[64:67], v6, s[28:31], 0 offen offset:32
  buffer_load_dwordx4 v[68:71], v6, s[28:31], 0 offen offset:48
  buffer_load_dwordx4 v[40:43], v4, s[24:27], 0 offen offset:0
  buffer_load_dwordx4 v[44:47], v4, s[24:27], 0 offen offset:1152
  buffer_load_dwordx4 v[48:51], v4, s[24:27], 0 offen offset:2304
  buffer_load_dwordx4 v[52:55], v4, s[24:27], 0 offen offset:3456
  s_barrier
  s_add_u32 s32, s14, 0
  s_addc_u32 s33, s15, 0
  s_mov_b32 s34, 2359296
  s_sub_u32 s17, 63, s17
  s_lshl_b32 s17, s17, 8
  v_lshlrev_b32 v7, 15, v1
  v_and_b32 v3, 1, v2
  v_lshl_add_u32 v7, v3, 6, v7
  v_lshrrev_b32 v3, 1, v2
  v_sub_u32 v3, 3, v3
  v_lshl_add_u32 v7, v3, 4, v7
  s_add_u32 s18, s17, 16384
  s_waitcnt vmcnt(14)
  v_lshlrev_b32 v72, 16, v12
  v_and_b32 v73, 0xffff0000, v12
  s_waitcnt vmcnt(13)
  v_lshlrev_b32 v74, 16, v16
  v_and_b32 v75, 0xffff0000, v16
  s_waitcnt vmcnt(12)
  v_lshlrev_b32 v76, 16, v20
  v_and_b32 v77, 0xffff0000, v20
  s_waitcnt vmcnt(11)
  v_lshlrev_b32 v78, 16, v24
  v_and_b32 v79, 0xffff0000, v24
  s_waitcnt vmcnt(10)
  v_lshlrev_b32 v80, 16, v28
  v_and_b32 v81, 0xffff0000, v28
  s_waitcnt vmcnt(9)
  v_lshlrev_b32 v82, 16, v32
  v_and_b32 v83, 0xffff0000, v32
  s_waitcnt vmcnt(8)
  v_lshlrev_b32 v84, 16, v36
  v_and_b32 v85, 0xffff0000, v36
  s_waitcnt vmcnt(7)
  v_lshlrev_b32 v86, 16, v56
  v_and_b32 v88, 0xffff0000, v56
  v_lshlrev_b32 v90, 16, v57
  v_and_b32 v92, 0xffff0000, v57
  v_lshlrev_b32 v87, 16, v58
  v_and_b32 v89, 0xffff0000, v58
  v_lshlrev_b32 v91, 16, v59
  v_and_b32 v93, 0xffff0000, v59
  v_pk_mul_f32 v[102:103], v[78:79], v[86:87]
  v_pk_mul_f32 v[104:105], v[80:81], v[86:87]
kv_hopq1:
kv_hop1:
  s_cbranch_execz kv_hopret
  v_pk_mul_f32 v[106:107], v[82:83], v[86:87]
  v_pk_mul_f32 v[108:109], v[84:85], v[86:87]
  v_pk_fma_f32 v[102:103], v[76:77], v[88:89], v[102:103]
  v_pk_fma_f32 v[104:105], v[78:79], v[88:89], v[104:105]
  v_pk_fma_f32 v[106:107], v[80:81], v[88:89], v[106:107]
  v_pk_fma_f32 v[108:109], v[82:83], v[88:89], v[108:109]
  v_pk_fma_f32 v[102:103], v[74:75], v[90:91], v[102:103]
  v_pk_fma_f32 v[104:105], v[76:77], v[90:91], v[104:105]
  v_pk_fma_f32 v[106:107], v[78:79], v[90:91], v[106:107]
  v_pk_fma_f32 v[108:109], v[80:81], v[90:91], v[108:109]
  v_pk_fma_f32 v[102:103], v[72:73], v[92:93], v[102:103]
  v_pk_fma_f32 v[104:105], v[74:75], v[92:93], v[104:105]
  v_pk_fma_f32 v[106:107], v[76:77], v[92:93], v[106:107]
  v_pk_fma_f32 v[108:109], v[78:79], v[92:93], v[108:109]
  s_waitcnt vmcnt(3)
  v_lshlrev_b32 v94, 16, v40
  v_and_b32 v95, 0xffff0000, v40
  s_waitcnt vmcnt(2)
  v_lshlrev_b32 v96, 16, v44
  v_and_b32 v97, 0xffff0000, v44
  s_waitcnt vmcnt(1)
  v_lshlrev_b32 v98, 16, v48
  v_and_b32 v99, 0xffff0000, v48
  s_waitcnt vmcnt(0)
  v_lshlrev_b32 v100, 16, v52
  v_and_b32 v101, 0xffff0000, v52
  v_pk_mul_f32 v[102:103], v[102:103], v[94:95]
  v_pk_mul_f32 v[104:105], v[104:105], v[96:97]
  v_pk_mul_f32 v[106:107], v[106:107], v[98:99]
  v_pk_mul_f32 v[108:109], v[108:109], v[100:101]
  v_cvt_pk_bf16_f32 v110, v109, v107
  v_cvt_pk_bf16_f32 v111, v105, v103
  v_cvt_pk_bf16_f32 v112, v108, v106
  v_cvt_pk_bf16_f32 v113, v104, v102
  v_mov_b32 v8, v110
  v_mov_b32 v9, v111
  v_mov_b32_dpp v110, v112 row_ror:8 row_mask:0xf bank_mask:0x3
  v_mov_b32_dpp v111, v113 row_ror:8 row_mask:0xf bank_mask:0x3
  v_mov_b32_dpp v112, v8 row_ror:8 row_mask:0xf bank_mask:0xc
  v_mov_b32_dpp v113, v9 row_ror:8 row_mask:0xf bank_mask:0xc
  buffer_store_dwordx4 v[110:113], v7, s[32:35], s17 offen offset:0 sc1
  v_lshlrev_b32 v72, 16, v13
  v_and_b32 v73, 0xffff0000, v13
  v_lshlrev_b32 v74, 16, v17
  v_and_b32 v75, 0xffff0000, v17
  v_lshlrev_b32 v76, 16, v21
  v_and_b32 v77, 0xffff0000, v21
  v_lshlrev_b32 v78, 16, v25
  v_and_b32 v79, 0xffff0000, v25
  v_lshlrev_b32 v80, 16, v29
  v_and_b32 v81, 0xffff0000, v29
  v_lshlrev_b32 v82, 16, v33
  v_and_b32 v83, 0xffff0000, v33
  v_lshlrev_b32 v84, 16, v37
  v_and_b32 v85, 0xffff0000, v37
  v_lshlrev_b32 v86, 16, v60
  v_and_b32 v88, 0xffff0000, v60
  v_lshlrev_b32 v90, 16, v61
  v_and_b32 v92, 0xffff0000, v61
  v_lshlrev_b32 v87, 16, v62
  v_and_b32 v89, 0xffff0000, v62
  v_lshlrev_b32 v91, 16, v63
  v_and_b32 v93, 0xffff0000, v63
  v_pk_mul_f32 v[102:103], v[78:79], v[86:87]
  v_pk_mul_f32 v[104:105], v[80:81], v[86:87]
  v_pk_mul_f32 v[106:107], v[82:83], v[86:87]
  v_pk_mul_f32 v[108:109], v[84:85], v[86:87]
  v_pk_fma_f32 v[102:103], v[76:77], v[88:89], v[102:103]
  v_pk_fma_f32 v[104:105], v[78:79], v[88:89], v[104:105]
  v_pk_fma_f32 v[106:107], v[80:81], v[88:89], v[106:107]
  v_pk_fma_f32 v[108:109], v[82:83], v[88:89], v[108:109]
  v_pk_fma_f32 v[102:103], v[74:75], v[90:91], v[102:103]
  v_pk_fma_f32 v[104:105], v[76:77], v[90:91], v[104:105]
  v_pk_fma_f32 v[106:107], v[78:79], v[90:91], v[106:107]
kv_hopq2:
kv_hop2:
  s_cbranch_execz kv_hopret
  v_pk_fma_f32 v[108:109], v[80:81], v[90:91], v[108:109]
  v_pk_fma_f32 v[102:103], v[72:73], v[92:93], v[102:103]
  v_pk_fma_f32 v[104:105], v[74:75], v[92:93], v[104:105]
  v_pk_fma_f32 v[106:107], v[76:77], v[92:93], v[106:107]
  v_pk_fma_f32 v[108:109], v[78:79], v[92:93], v[108:109]
  v_lshlrev_b32 v94, 16, v41
  v_and_b32 v95, 0xffff0000, v41
  v_lshlrev_b32 v96, 16, v45
  v_and_b32 v97, 0xffff0000, v45
  v_lshlrev_b32 v98, 16, v49
  v_and_b32 v99, 0xffff0000, v49
  v_lshlrev_b32 v100, 16, v53
  v_and_b32 v101, 0xffff0000, v53
  v_pk_mul_f32 v[102:103], v[102:103], v[94:95]
  v_pk_mul_f32 v[104:105], v[104:105], v[96:97]
  v_pk_mul_f32 v[106:107], v[106:107], v[98:99]
  v_pk_mul_f32 v[108:109], v[108:109], v[100:101]
  v_cvt_pk_bf16_f32 v114, v109, v107
  v_cvt_pk_bf16_f32 v115, v105, v103
  v_cvt_pk_bf16_f32 v116, v108, v106
  v_cvt_pk_bf16_f32 v117, v104, v102
  v_mov_b32 v8, v114
  v_mov_b32 v9, v115
  v_mov_b32_dpp v114, v116 row_ror:8 row_mask:0xf bank_mask:0x3
  v_mov_b32_dpp v115, v117 row_ror:8 row_mask:0xf bank_mask:0x3
  v_mov_b32_dpp v116, v8 row_ror:8 row_mask:0xf bank_mask:0xc
  v_mov_b32_dpp v117, v9 row_ror:8 row_mask:0xf bank_mask:0xc
  buffer_store_dwordx4 v[114:117], v7, s[32:35], s17 offen offset:128 sc1
  v_lshlrev_b32 v72, 16, v14
  v_and_b32 v73, 0xffff0000, v14
  v_lshlrev_b32 v74, 16, v18
  v_and_b32 v75, 0xffff0000, v18
  v_lshlrev_b32 v76, 16, v22
  v_and_b32 v77, 0xffff0000, v22
  v_lshlrev_b32 v78, 16, v26
  v_and_b32 v79, 0xffff0000, v26
  v_lshlrev_b32 v80, 16, v30
  v_and_b32 v81, 0xffff0000, v30
  v_lshlrev_b32 v82, 16, v34
  v_and_b32 v83, 0xffff0000, v34
  v_lshlrev_b32 v84, 16, v38
  v_and_b32 v85, 0xffff0000, v38
  v_lshlrev_b32 v86, 16, v64
  v_and_b32 v88, 0xffff0000, v64
  v_lshlrev_b32 v90, 16, v65
  v_and_b32 v92, 0xffff0000, v65
  v_lshlrev_b32 v87, 16, v66
  v_and_b32 v89, 0xffff0000, v66
  v_lshlrev_b32 v91, 16, v67
  v_and_b32 v93, 0xffff0000, v67
  v_pk_mul_f32 v[102:103], v[78:79], v[86:87]
  v_pk_mul_f32 v[104:105], v[80:81], v[86:87]
  v_pk_mul_f32 v[106:107], v[82:83], v[86:87]
  v_pk_mul_f32 v[108:109], v[84:85], v[86:87]
  v_pk_fma_f32 v[102:103], v[76:77], v[88:89], v[102:103]
  v_pk_fma_f32 v[104:105], v[78:79], v[88:89], v[104:105]
  v_pk_fma_f32 v[106:107], v[80:81], v[88:89], v[106:107]
  v_pk_fma_f32 v[108:109], v[82:83], v[88:89], v[108:109]
  v_pk_fma_f32 v[102:103], v[74:75], v[90:91], v[102:103]
  v_pk_fma_f32 v[104:105], v[76:77], v[90:91], v[104:105]
  v_pk_fma_f32 v[106:107], v[78:79], v[90:91], v[106:107]
  v_pk_fma_f32 v[108:109], v[80:81], v[90:91], v[108:109]
  v_pk_fma_f32 v[102:103], v[72:73], v[92:93], v[102:103]
  v_pk_fma_f32 v[104:105], v[74:75], v[92:93], v[104:105]
  v_pk_fma_f32 v[106:107], v[76:77], v[92:93], v[106:107]
  v_pk_fma_f32 v[108:109], v[78:79], v[92:93], v[108:109]
  v_lshlrev_b32 v94, 16, v42
  v_and_b32 v95, 0xffff0000, v42
  v_lshlrev_b32 v96, 16, v46
  v_and_b32 v97, 0xffff0000, v46
  v_lshlrev_b32 v98, 16, v50
  v_and_b32 v99, 0xffff0000, v50
  v_lshlrev_b32 v100, 16, v54
  v_and_b32 v101, 0xffff0000, v54
kv_hopq3:
kv_hop3:
  s_cbranch_execz kv_hop4
  v_pk_mul_f32 v[102:103], v[102:103], v[94:95]
  v_pk_mul_f32 v[104:105], v[104:105], v[96:97]
  v_pk_mul_f32 v[106:107], v[106:107], v[98:99]
  v_pk_mul_f32 v[108:109], v[108:109], v[100:101]
  v_cvt_pk_bf16_f32 v118, v109, v107
  v_cvt_pk_bf16_f32 v119, v105, v103
  v_cvt_pk_bf16_f32 v120, v108, v106
  v_cvt_pk_bf16_f32 v121, v104, v102
  v_mov_b32 v8, v118
  v_mov_b32 v9, v119
  v_mov_b32_dpp v118, v120 row_ror:8 row_mask:0xf bank_mask:0x3
  v_mov_b32_dpp v119, v121 row_ror:8 row_mask:0xf bank_mask:0x3
  v_mov_b32_dpp v120, v8 row_ror:8 row_mask:0xf bank_mask:0xc
  v_mov_b32_dpp v121, v9 row_ror:8 row_mask:0xf bank_mask:0xc
  buffer_store_dwordx4 v[118:121], v7, s[32:35], s18 offen offset:0 sc1
  v_lshlrev_b32 v72, 16, v15
  v_and_b32 v73, 0xffff0000, v15
  v_lshlrev_b32 v74, 16, v19
  v_and_b32 v75, 0xffff0000, v19
  v_lshlrev_b32 v76, 16, v23
  v_and_b32 v77, 0xffff0000, v23
  v_lshlrev_b32 v78, 16, v27
  v_and_b32 v79, 0xffff0000, v27
  v_lshlrev_b32 v80, 16, v31
  v_and_b32 v81, 0xffff0000, v31
  v_lshlrev_b32 v82, 16, v35
  v_and_b32 v83, 0xffff0000, v35
  v_lshlrev_b32 v84, 16, v39
  v_and_b32 v85, 0xffff0000, v39
  v_lshlrev_b32 v86, 16, v68
  v_and_b32 v88, 0xffff0000, v68
  v_lshlrev_b32 v90, 16, v69
  v_and_b32 v92, 0xffff0000, v69
  v_lshlrev_b32 v87, 16, v70
  v_and_b32 v89, 0xffff0000, v70
  v_lshlrev_b32 v91, 16, v71
  v_and_b32 v93, 0xffff0000, v71
  v_pk_mul_f32 v[102:103], v[78:79], v[86:87]
  v_pk_mul_f32 v[104:105], v[80:81], v[86:87]
  v_pk_mul_f32 v[106:107], v[82:83], v[86:87]
  v_pk_mul_f32 v[108:109], v[84:85], v[86:87]
  v_pk_fma_f32 v[102:103], v[76:77], v[88:89], v[102:103]
  v_pk_fma_f32 v[104:105], v[78:79], v[88:89], v[104:105]
  v_pk_fma_f32 v[106:107], v[80:81], v[88:89], v[106:107]
  v_pk_fma_f32 v[108:109], v[82:83], v[88:89], v[108:109]
  v_pk_fma_f32 v[102:103], v[74:75], v[90:91], v[102:103]
  v_pk_fma_f32 v[104:105], v[76:77], v[90:91], v[104:105]
  v_pk_fma_f32 v[106:107], v[78:79], v[90:91], v[106:107]
  v_pk_fma_f32 v[108:109], v[80:81], v[90:91], v[108:109]
  v_pk_fma_f32 v[102:103], v[72:73], v[92:93], v[102:103]
  v_pk_fma_f32 v[104:105], v[74:75], v[92:93], v[104:105]
  v_pk_fma_f32 v[106:107], v[76:77], v[92:93], v[106:107]
  v_pk_fma_f32 v[108:109], v[78:79], v[92:93], v[108:109]
  v_lshlrev_b32 v94, 16, v43
  v_and_b32 v95, 0xffff0000, v43
  v_lshlrev_b32 v96, 16, v47
  v_and_b32 v97, 0xffff0000, v47
  v_lshlrev_b32 v98, 16, v51
  v_and_b32 v99, 0xffff0000, v51
  v_lshlrev_b32 v100, 16, v55
  v_and_b32 v101, 0xffff0000, v55
  v_pk_mul_f32 v[102:103], v[102:103], v[94:95]
  v_pk_mul_f32 v[104:105], v[104:105], v[96:97]
  v_pk_mul_f32 v[106:107], v[106:107], v[98:99]
  v_pk_mul_f32 v[108:109], v[108:109], v[100:101]
  v_cvt_pk_bf16_f32 v122, v109, v107
  v_cvt_pk_bf16_f32 v123, v105, v103
  v_cvt_pk_bf16_f32 v124, v108, v106
  v_cvt_pk_bf16_f32 v125, v104, v102
  v_mov_b32 v8, v122
  v_mov_b32 v9, v123
  v_mov_b32_dpp v122, v124 row_ror:8 row_mask:0xf bank_mask:0x3
  v_mov_b32_dpp v123, v125 row_ror:8 row_mask:0xf bank_mask:0x3
kv_hop4:
  s_cbranch_execz kv_hopret
  v_mov_b32_dpp v124, v8 row_ror:8 row_mask:0xf bank_mask:0xc
  v_mov_b32_dpp v125, v9 row_ror:8 row_mask:0xf bank_mask:0xc
  buffer_store_dwordx4 v[122:125], v7, s[32:35], s18 offen offset:128 sc1
  s_branch pre_sig
kv_hopret:
  s_setpc_b64 s[90:91]
  .p2align 9
pre_ln:
ln_hopq0:
ln_hop0:
  s_cbranch_execz ln_hopret
  s_lshl_b32 s3, s2, 3
  v_add_u32 v2, s3, v2
  v_mul_u32_u24 v4, 1152, v2
  v_lshl_add_u32 v4, v1, 4, v4
  s_waitcnt lgkmcnt(0)
  s_mov_b32 s20, s4
  s_mov_b32 s21, s5
  buffer_load_dwordx4 v[12:15], v4, s[20:23], 0 offen offset:0
  buffer_load_dwordx4 v[16:19], v4, s[20:23], 0 offen offset:128
  buffer_load_dwordx4 v[20:23], v4, s[20:23], 0 offen offset:256
  buffer_load_dwordx4 v[24:27], v4, s[20:23], 0 offen offset:384
  buffer_load_dwordx4 v[28:31], v4, s[20:23], 0 offen offset:512
  buffer_load_dwordx4 v[32:35], v4, s[20:23], 0 offen offset:640
  buffer_load_dwordx4 v[36:39], v4, s[20:23], 0 offen offset:768
  buffer_load_dwordx4 v[40:43], v4, s[20:23], 0 offen offset:896
  buffer_load_dwordx4 v[44:47], v4, s[20:23], 0 offen offset:1024
  s_barrier
  s_add_u32 s24, s14, 2359296
  s_addc_u32 s25, s15, 0
  s_add_u32 s28, s14, 4718592
  s_addc_u32 s29, s15, 0
  s_mov_b32 s30, 16384
  s_lshl_b32 s3, s3, 4
  v_lshl_add_u32 v3, v1, 15, s3
  v_and_b32 v5, 1, v2
  v_lshl_add_u32 v3, v5, 6, v3
  v_bfe_u32 v5, v2, 1, 2
  v_lshl_add_u32 v3, v5, 4, v3
  v_lshlrev_b32 v2, 3, v2
  v_mov_b32 v10, 0x3f803f80
  v_mov_b32 v6, 0
  v_mov_b32 v7, 0
  v_mov_b32 v8, 0
  v_mov_b32 v9, 0
  s_waitcnt vmcnt(8)
  v_dot2_f32_bf16 v6, v12, v10, v6
  v_dot2_f32_bf16 v8, v12, v12, v8
  v_dot2_f32_bf16 v7, v13, v10, v7
  v_dot2_f32_bf16 v9, v13, v13, v9
  v_dot2_f32_bf16 v6, v14, v10, v6
  v_dot2_f32_bf16 v8, v14, v14, v8
  v_dot2_f32_bf16 v7, v15, v10, v7
  v_dot2_f32_bf16 v9, v15, v15, v9
  v_mov_b32 v48, v14
  v_mov_b32 v49, v15
  v_mov_b32_dpp v14, v12 row_ror:8 row_mask:0xf bank_mask:0x3
  v_mov_b32_dpp v15, v13 row_ror:8 row_mask:0xf bank_mask:0x3
  v_mov_b32_dpp v12, v48 row_ror:8 row_mask:0xf bank_mask:0xc
  v_mov_b32_dpp v13, v49 row_ror:8 row_mask:0xf bank_mask:0xc
  s_mov_b32 s3, 0
  buffer_store_dwordx4 v[12:15], v3, s[24:27], s3 offen sc1
  s_waitcnt vmcnt(8)
  v_dot2_f32_bf16 v6, v16, v10, v6
  v_dot2_f32_bf16 v8, v16, v16, v8
  v_dot2_f32_bf16 v7, v17, v10, v7
  v_dot2_f32_bf16 v9, v17, v17, v9
  v_dot2_f32_bf16 v6, v18, v10, v6
  v_dot2_f32_bf16 v8, v18, v18, v8
  v_dot2_f32_bf16 v7, v19, v10, v7
  v_dot2_f32_bf16 v9, v19, v19, v9
  v_mov_b32 v48, v18
  v_mov_b32 v49, v19
  v_mov_b32_dpp v18, v16 row_ror:8 row_mask:0xf bank_mask:0x3
  v_mov_b32_dpp v19, v17 row_ror:8 row_mask:0xf bank_mask:0x3
  v_mov_b32_dpp v16, v48 row_ror:8 row_mask:0xf bank_mask:0xc
  v_mov_b32_dpp v17, v49 row_ror:8 row_mask:0xf bank_mask:0xc
  s_mov_b32 s3, 262144
  buffer_store_dwordx4 v[16:19], v3, s[24:27], s3 offen sc1
  s_waitcnt vmcnt(8)
  v_dot2_f32_bf16 v6, v20, v10, v6
  v_dot2_f32_bf16 v8, v20, v20, v8
  v_dot2_f32_bf16 v7, v21, v10, v7
  v_dot2_f32_bf16 v9, v21, v21, v9
  v_dot2_f32_bf16 v6, v22, v10, v6
  v_dot2_f32_bf16 v8, v22, v22, v8
ln_hopq1:
ln_hop1:
  s_cbranch_execz ln_hopret
  v_dot2_f32_bf16 v7, v23, v10, v7
  v_dot2_f32_bf16 v9, v23, v23, v9
  v_mov_b32 v48, v22
  v_mov_b32 v49, v23
  v_mov_b32_dpp v22, v20 row_ror:8 row_mask:0xf bank_mask:0x3
  v_mov_b32_dpp v23, v21 row_ror:8 row_mask:0xf bank_mask:0x3
  v_mov_b32_dpp v20, v48 row_ror:8 row_mask:0xf bank_mask:0xc
  v_mov_b32_dpp v21, v49 row_ror:8 row_mask:0xf bank_mask:0xc
  s_mov_b32 s3, 524288
  buffer_store_dwordx4 v[20:23], v3, s[24:27], s3 offen sc1
  s_waitcnt vmcnt(8)
  v_dot2_f32_bf16 v6, v24, v10, v6
  v_dot2_f32_bf16 v8, v24, v24, v8
  v_dot2_f32_bf16 v7, v25, v10, v7
  v_dot2_f32_bf16 v9, v25, v25, v9
  v_dot2_f32_bf16 v6, v26, v10, v6
  v_dot2_f32_bf16 v8, v26, v26, v8
  v_dot2_f32_bf16 v7, v27, v10, v7
  v_dot2_f32_bf16 v9, v27, v27, v9
  v_mov_b32 v48, v26
  v_mov_b32 v49, v27
  v_mov_b32_dpp v26, v24 row_ror:8 row_mask:0xf bank_mask:0x3
  v_mov_b32_dpp v27, v25 row_ror:8 row_mask:0xf bank_mask:0x3
  v_mov_b32_dpp v24, v48 row_ror:8 row_mask:0xf bank_mask:0xc
  v_mov_b32_dpp v25, v49 row_ror:8 row_mask:0xf bank_mask:0xc
  s_mov_b32 s3, 786432
  buffer_store_dwordx4 v[24:27], v3, s[24:27], s3 offen sc1
  s_waitcnt vmcnt(8)
  v_dot2_f32_bf16 v6, v28, v10, v6
  v_dot2_f32_bf16 v8, v28, v28, v8
  v_dot2_f32_bf16 v7, v29, v10, v7
  v_dot2_f32_bf16 v9, v29, v29, v9
  v_dot2_f32_bf16 v6, v30, v10, v6
  v_dot2_f32_bf16 v8, v30, v30, v8
  v_dot2_f32_bf16 v7, v31, v10, v7
  v_dot2_f32_bf16 v9, v31, v31, v9
  v_mov_b32 v48, v30
  v_mov_b32 v49, v31
  v_mov_b32_dpp v30, v28 row_ror:8 row_mask:0xf bank_mask:0x3
  v_mov_b32_dpp v31, v29 row_ror:8 row_mask:0xf bank_mask:0x3
  v_mov_b32_dpp v28, v48 row_ror:8 row_mask:0xf bank_mask:0xc
  v_mov_b32_dpp v29, v49 row_ror:8 row_mask:0xf bank_mask:0xc
  s_mov_b32 s3, 1048576
  buffer_store_dwordx4 v[28:31], v3, s[24:27], s3 offen sc1
  s_waitcnt vmcnt(8)
  v_dot2_f32_bf16 v6, v32, v10, v6
  v_dot2_f32_bf16 v8, v32, v32, v8
  v_dot2_f32_bf16 v7, v33, v10, v7
  v_dot2_f32_bf16 v9, v33, v33, v9
  v_dot2_f32_bf16 v6, v34, v10, v6
  v_dot2_f32_bf16 v8, v34, v34, v8
  v_dot2_f32_bf16 v7, v35, v10, v7
  v_dot2_f32_bf16 v9, v35, v35, v9
  v_mov_b32 v48, v34
  v_mov_b32 v49, v35
  v_mov_b32_dpp v34, v32 row_ror:8 row_mask:0xf bank_mask:0x3
  v_mov_b32_dpp v35, v33 row_ror:8 row_mask:0xf bank_mask:0x3
  v_mov_b32_dpp v32, v48 row_ror:8 row_mask:0xf bank_mask:0xc
  v_mov_b32_dpp v33, v49 row_ror:8 row_mask:0xf bank_mask:0xc
  s_mov_b32 s3, 1310720
  buffer_store_dwordx4 v[32:35], v3, s[24:27], s3 offen sc1
  s_waitcnt vmcnt(8)
  v_dot2_f32_bf16 v6, v36, v10, v6
  v_dot2_f32_bf16 v8, v36, v36, v8
  v_dot2_f32_bf16 v7, v37, v10, v7
  v_dot2_f32_bf16 v9, v37, v37, v9
  v_dot2_f32_bf16 v6, v38, v10, v6
  v_dot2_f32_bf16 v8, v38, v38, v8
  v_dot2_f32_bf16 v7, v39, v10, v7
  v_dot2_f32_bf16 v9, v39, v39, v9
ln_hopq2:
ln_hop2:
  s_cbranch_execz ln_hopret
  v_mov_b32 v48, v38
  v_mov_b32 v49, v39
  v_mov_b32_dpp v38, v36 row_ror:8 row_mask:0xf bank_mask:0x3
  v_mov_b32_dpp v39, v37 row_ror:8 row_mask:0xf bank_mask:0x3
  v_mov_b32_dpp v36, v48 row_ror:8 row_mask:0xf bank_mask:0xc
  v_mov_b32_dpp v37, v49 row_ror:8 row_mask:0xf bank_mask:0xc
  s_mov_b32 s3, 1572864
  buffer_store_dwordx4 v[36:39], v3, s[24:27], s3 offen sc1
  s_waitcnt vmcnt(8)
  v_dot2_f32_bf16 v6, v40, v10, v6
  v_dot2_f32_bf16 v8, v40, v40, v8
  v_dot2_f32_bf16 v7, v41, v10, v7
  v_dot2_f32_bf16 v9, v41, v41, v9
  v_dot2_f32_bf16 v6, v42, v10, v6
  v_dot2_f32_bf16 v8, v42, v42, v8
  v_dot2_f32_bf16 v7, v43, v10, v7
  v_dot2_f32_bf16 v9, v43, v43, v9
  v_mov_b32 v48, v42
  v_mov_b32 v49, v43
  v_mov_b32_dpp v42, v40 row_ror:8 row_mask:0xf bank_mask:0x3
  v_mov_b32_dpp v43, v41 row_ror:8 row_mask:0xf bank_mask:0x3
  v_mov_b32_dpp v40, v48 row_ror:8 row_mask:0xf bank_mask:0xc
  v_mov_b32_dpp v41, v49 row_ror:8 row_mask:0xf bank_mask:0xc
  s_mov_b32 s3, 1835008
  buffer_store_dwordx4 v[40:43], v3, s[24:27], s3 offen sc1
  s_waitcnt vmcnt(8)
  v_dot2_f32_bf16 v6, v44, v10, v6
  v_dot2_f32_bf16 v8, v44, v44, v8
  v_dot2_f32_bf16 v7, v45, v10, v7
  v_dot2_f32_bf16 v9, v45, v45, v9
  v_dot2_f32_bf16 v6, v46, v10, v6
  v_dot2_f32_bf16 v8, v46, v46, v8
  v_dot2_f32_bf16 v7, v47, v10, v7
  v_dot2_f32_bf16 v9, v47, v47, v9
  v_mov_b32 v48, v46
  v_mov_b32 v49, v47
  v_mov_b32_dpp v46, v44 row_ror:8 row_mask:0xf bank_mask:0x3
  v_mov_b32_dpp v47, v45 row_ror:8 row_mask:0xf bank_mask:0x3
  v_mov_b32_dpp v44, v48 row_ror:8 row_mask:0xf bank_mask:0xc
  v_mov_b32_dpp v45, v49 row_ror:8 row_mask:0xf bank_mask:0xc
  s_mov_b32 s3, 2097152
  buffer_store_dwordx4 v[44:47], v3, s[24:27], s3 offen sc1
  v_add_f32 v6, v6, v7
  v_add_f32 v8, v8, v9
  s_nop 0
  v_add_f32_dpp v6, v6, v6 quad_perm:[1,0,3,2] row_mask:0xf bank_mask:0xf
  v_add_f32_dpp v8, v8, v8 quad_perm:[1,0,3,2] row_mask:0xf bank_mask:0xf
  s_nop 0
  v_add_f32_dpp v6, v6, v6 quad_perm:[2,3,0,1] row_mask:0xf bank_mask:0xf
  v_add_f32_dpp v8, v8, v8 quad_perm:[2,3,0,1] row_mask:0xf bank_mask:0xf
  s_nop 0
  v_add_f32_dpp v6, v6, v6 row_half_mirror row_mask:0xf bank_mask:0xf
  v_add_f32_dpp v8, v8, v8 row_half_mirror row_mask:0xf bank_mask:0xf
  v_mul_f32 v7, -0.001736111111111111, v6
  v_mov_b32 v6, 0x3727c5ac
  v_fmac_f32 v6, 0.001736111111111111, v8
  v_fma_f32 v6, -v7, v7, v6
  v_max_f32 v6, 0x3727c5ac, v6
  v_rsq_f32 v6, v6
  s_nop 0
  v_mul_f32 v7, v7, v6
  buffer_store_dwordx2 v[6:7], v2, s[28:31], 0 offen sc1
  s_add_u32 s36, s2, 288
  s_mov_b32 s37, 0
pre_sig:
  v_mov_b32 v56, s37
  v_mov_b32 v57, 1
  s_lshl_b32 s36, s36, 7
  s_add_u32 s36, s36, 9633792
  v_mov_b32 v54, 0
  s_mov_b32 s87, 0x40000
pre_tag1:
  global_load_dwordx2 v[52:53], v54, s[12:13] sc1
  s_waitcnt vmcnt(0)
  v_readfirstlane_b32 s51, v53
  v_readfirstlane_b32 s50, v52
  s_sub_u32 s87, s87, 1
  s_cbranch_scc1 pre_tag1_x
  s_cmp_eq_u32 s51, 0
  s_cbranch_scc1 pre_tag1
pre_tag1_x:
  s_waitcnt vmcnt(0)
  v_mov_b32 v54, s36
  s_mov_b64 exec, 1
  s_cmp_eq_u32 s37, 0
  s_cbranch_scc1 pre_sig1
  ds_add_rtn_u32 v57, v56, v57
ln_hopq3:
ln_hop3:
  s_cbranch_execz ln_hopret
  s_waitcnt lgkmcnt(0)
  v_readfirstlane_b32 s3, v57
  s_nop 1
  s_cmp_eq_u32 s3, 0
  s_cbranch_scc1 pre_sig2
pre_sig1:
  global_store_dword v54, v52, s[14:15] sc1
pre_sig2:
  s_mov_b64 exec, -1
  s_branch pre_join
ln_hopret:
  s_setpc_b64 s[90:91]
pre_hk:
  v_and_b32 v1, 63, v0
  v_lshlrev_b32 v2, 4, v1
  v_mov_b32 v8, 0
  v_mov_b32 v9, 0
  v_mov_b32 v10, 0
  v_mov_b32 v11, 0
  v_mov_b32 v3, 84480
  ds_write_b128 v3, v[8:11]
  ds_write_b32 v3, v8 offset:16
  s_lshr_b32 s18, s2, 3
  s_mul_i32 s18, s18, 3072
  s_getpc_b64 s[20:21]
  pre_pc:
  s_add_u32 s20, s20, pre_conv-pre_pc
  s_addc_u32 s21, s21, 0
  s_mov_b32 s22, code_end-pre_conv
  s_waitcnt lgkmcnt(0)
  s_barrier
  s_cmp_lg_u32 s2, 0
  s_cbranch_scc1 pre_hk2
  s_mov_b32 s17, 9830400
  s_load_dword s3, s[14:15], s17
  v_mov_b32 v5, 1
  v_mov_b32 v6, 0
  v_mov_b32 v7, 9830400
  s_waitcnt lgkmcnt(0)
  s_add_u32 s3, s3, 1
  v_mov_b32 v4, s3
  global_store_dwordx2 v6, v[4:5], s[12:13] sc1
  global_store_dword v7, v4, s[14:15] sc1
pre_hk2:
  buffer_load_dwordx4 v[12:15], v2, s[20:23], s18 offen offset:0
  buffer_load_dwordx4 v[16:19], v2, s[20:23], s18 offen offset:1024
  buffer_load_dwordx4 v[20:23], v2, s[20:23], s18 offen offset:2048
  s_lshl_b32 s3, s2, 8
  s_add_u32 s3, s3, 9568256
  v_lshl_add_u32 v2, v1, 2, s3
  v_mov_b32 v3, 0
  global_store_dword v2, v3, s[14:15] sc1
  s_waitcnt vmcnt(0)
pre_join:
  s_waitcnt lgkmcnt(0)
  s_cmp_lt_u32 s16, 4
  s_cbranch_scc1 pre_cs
  s_mov_b64 exec, 0
  s_and_b32 s92, s16, 3
  s_cmp_lg_u32 s92, 0
  s_cbranch_scc1 pre_hfh_n0
  s_call_b64 s[90:91], ffn_hopq0
  s_branch pre_hfh_ret
pre_hfh_n0:
  s_cmp_lg_u32 s92, 1
  s_cbranch_scc1 pre_hfh_n1
  s_call_b64 s[90:91], ffn_hopq1
  s_branch pre_hfh_ret
pre_hfh_n1:
  s_cmp_lg_u32 s92, 2
  s_cbranch_scc1 pre_hfh_n2
  s_call_b64 s[90:91], ffn_hopq2
  s_branch pre_hfh_ret
pre_hfh_n2:
  s_call_b64 s[90:91], ffn_hopq3
pre_hfh_ret:
  s_mov_b64 exec, -1
  s_endpgm
pre_cs:
  s_cmp_ge_u32 s2, 240
  s_cbranch_scc1 pre_end
  s_load_dwordx4 s[8:11], s[0:1], 56
  v_and_b32 v1, 63, v0
  s_sub_u32 s3, s2, 144
  s_and_b32 s17, s3, 7
  s_lshr_b32 s18, s3, 3
  s_mul_i32 s17, s17, 1152
  s_lshr_b32 s19, s18, 2
  s_mul_i32 s19, s19, 384
  s_add_u32 s17, s17, s19
  s_and_b32 s19, s18, 1
  s_mul_i32 s24, s19, 36864
  s_lshl_b32 s19, s19, 2
  s_add_u32 s19, s19, s16
  s_mul_i32 s19, s19, 663552
  s_add_u32 s19, s19, s17
  v_cmp_le_u32 vcc, 24, v1
  s_nop 1
  v_cndmask_b32 v2, 0, 1, vcc
  v_mul_u32_u24 v2, 8832, v2
  v_lshl_add_u32 v2, v1, 4, v2
  v_bfrev_b32 v3, 1
  v_cmp_le_u32 vcc, 48, v1
  s_nop 1
  v_cndmask_b32 v2, v2, v3, vcc
  s_bitcmp1_b32 s18, 1
  s_waitcnt lgkmcnt(0)
  s_cselect_b32 s20, s10, s8
  s_cselect_b32 s21, s11, s9
  s_cselect_b32 s25, 18432, 0
  s_mov_b32 s22, 5308416
  s_mov_b32 s23, 0x20000
  s_add_u32 s28, s14, 9437184
  s_addc_u32 s29, s15, 0
  s_mov_b32 s30, 73728
  s_mov_b32 s31, 0x20000
  v_mov_b32 v8, 0
  v_mov_b32 v9, 0
  v_mov_b32 v10, 0
  v_mov_b32 v11, 0
  v_mov_b32 v12, 0
  v_mov_b32 v13, 0
  v_mov_b32 v14, 0
  v_mov_b32 v15, 0
  buffer_load_dwordx4 v[32:35], v2, s[20:23], s19 offen
  s_add_u32 s19, s19, 18432
  buffer_load_dwordx4 v[36:39], v2, s[20:23], s19 offen
  s_add_u32 s19, s19, 18432
  buffer_load_dwordx4 v[40:43], v2, s[20:23], s19 offen
  s_add_u32 s19, s19, 18432
  buffer_load_dwordx4 v[44:47], v2, s[20:23], s19 offen
  s_add_u32 s19, s19, 18432
  buffer_load_dwordx4 v[48:51], v2, s[20:23], s19 offen
  s_add_u32 s19, s19, 18432
  buffer_load_dwordx4 v[52:55], v2, s[20:23], s19 offen
  s_add_u32 s19, s19, 18432
  buffer_load_dwordx4 v[56:59], v2, s[20:23], s19 offen
  s_add_u32 s19, s19, 18432
  buffer_load_dwordx4 v[60:63], v2, s[20:23], s19 offen
  s_add_u32 s19, s19, 18432
  buffer_load_dwordx4 v[64:67], v2, s[20:23], s19 offen
  s_add_u32 s19, s19, 18432
  s_mov_b32 s26, 4
pre_csl:
  s_sub_u32 s26, s26, 1
  s_cmp_eq_u32 s26, 0
  s_cselect_b32 s22, 0, s22
  s_waitcnt vmcnt(8)
  v_lshlrev_b32 v16, 16, v32
  v_and_b32 v17, 0xffff0000, v32
  v_lshlrev_b32 v18, 16, v33
  v_and_b32 v19, 0xffff0000, v33
  v_lshlrev_b32 v20, 16, v34
  v_and_b32 v21, 0xffff0000, v34
  v_lshlrev_b32 v22, 16, v35
  v_and_b32 v23, 0xffff0000, v35
  buffer_load_dwordx4 v[32:35], v2, s[20:23], s19 offen
  s_add_u32 s19, s19, 18432
  v_pk_add_f32 v[8:9], v[8:9], v[16:17]
  v_pk_add_f32 v[10:11], v[10:11], v[18:19]
  v_pk_add_f32 v[12:13], v[12:13], v[20:21]
  v_pk_add_f32 v[14:15], v[14:15], v[22:23]
  s_waitcnt vmcnt(8)
  v_lshlrev_b32 v16, 16, v36
  v_and_b32 v17, 0xffff0000, v36
  v_lshlrev_b32 v18, 16, v37
  v_and_b32 v19, 0xffff0000, v37
  v_lshlrev_b32 v20, 16, v38
  v_and_b32 v21, 0xffff0000, v38
  v_lshlrev_b32 v22, 16, v39
  v_and_b32 v23, 0xffff0000, v39
  buffer_load_dwordx4 v[36:39], v2, s[20:23], s19 offen
  s_add_u32 s19, s19, 18432
  v_pk_add_f32 v[8:9], v[8:9], v[16:17]
  v_pk_add_f32 v[10:11], v[10:11], v[18:19]
  v_pk_add_f32 v[12:13], v[12:13], v[20:21]
  v_pk_add_f32 v[14:15], v[14:15], v[22:23]
  s_waitcnt vmcnt(8)
  v_lshlrev_b32 v16, 16, v40
  v_and_b32 v17, 0xffff0000, v40
  v_lshlrev_b32 v18, 16, v41
  v_and_b32 v19, 0xffff0000, v41
  v_lshlrev_b32 v20, 16, v42
  v_and_b32 v21, 0xffff0000, v42
  v_lshlrev_b32 v22, 16, v43
  v_and_b32 v23, 0xffff0000, v43
  buffer_load_dwordx4 v[40:43], v2, s[20:23], s19 offen
  s_add_u32 s19, s19, 18432
  v_pk_add_f32 v[8:9], v[8:9], v[16:17]
  v_pk_add_f32 v[10:11], v[10:11], v[18:19]
  v_pk_add_f32 v[12:13], v[12:13], v[20:21]
  v_pk_add_f32 v[14:15], v[14:15], v[22:23]
  s_waitcnt vmcnt(8)
  v_lshlrev_b32 v16, 16, v44
  v_and_b32 v17, 0xffff0000, v44
  v_lshlrev_b32 v18, 16, v45
  v_and_b32 v19, 0xffff0000, v45
  v_lshlrev_b32 v20, 16, v46
  v_and_b32 v21, 0xffff0000, v46
  v_lshlrev_b32 v22, 16, v47
  v_and_b32 v23, 0xffff0000, v47
  buffer_load_dwordx4 v[44:47], v2, s[20:23], s19 offen
  s_add_u32 s19, s19, 18432
  v_pk_add_f32 v[8:9], v[8:9], v[16:17]
  v_pk_add_f32 v[10:11], v[10:11], v[18:19]
  v_pk_add_f32 v[12:13], v[12:13], v[20:21]
  v_pk_add_f32 v[14:15], v[14:15], v[22:23]
  s_waitcnt vmcnt(8)
  v_lshlrev_b32 v16, 16, v48
  v_and_b32 v17, 0xffff0000, v48
  v_lshlrev_b32 v18, 16, v49
  v_and_b32 v19, 0xffff0000, v49
  v_lshlrev_b32 v20, 16, v50
  v_and_b32 v21, 0xffff0000, v50
  v_lshlrev_b32 v22, 16, v51
  v_and_b32 v23, 0xffff0000, v51
  buffer_load_dwordx4 v[48:51], v2, s[20:23], s19 offen
  s_add_u32 s19, s19, 18432
  v_pk_add_f32 v[8:9], v[8:9], v[16:17]
  v_pk_add_f32 v[10:11], v[10:11], v[18:19]
  v_pk_add_f32 v[12:13], v[12:13], v[20:21]
  v_pk_add_f32 v[14:15], v[14:15], v[22:23]
  s_waitcnt vmcnt(8)
  v_lshlrev_b32 v16, 16, v52
  v_and_b32 v17, 0xffff0000, v52
  v_lshlrev_b32 v18, 16, v53
  v_and_b32 v19, 0xffff0000, v53
  v_lshlrev_b32 v20, 16, v54
  v_and_b32 v21, 0xffff0000, v54
  v_lshlrev_b32 v22, 16, v55
  v_and_b32 v23, 0xffff0000, v55
  buffer_load_dwordx4 v[52:55], v2, s[20:23], s19 offen
  s_add_u32 s19, s19, 18432
  v_pk_add_f32 v[8:9], v[8:9], v[16:17]
  v_pk_add_f32 v[10:11], v[10:11], v[18:19]
  v_pk_add_f32 v[12:13], v[12:13], v[20:21]
  v_pk_add_f32 v[14:15], v[14:15], v[22:23]
  s_waitcnt vmcnt(8)
  v_lshlrev_b32 v16, 16, v56
  v_and_b32 v17, 0xffff0000, v56
  v_lshlrev_b32 v18, 16, v57
  v_and_b32 v19, 0xffff0000, v57
  v_lshlrev_b32 v20, 16, v58
  v_and_b32 v21, 0xffff0000, v58
  v_lshlrev_b32 v22, 16, v59
  v_and_b32 v23, 0xffff0000, v59
  buffer_load_dwordx4 v[56:59], v2, s[20:23], s19 offen
  s_add_u32 s19, s19, 18432
  v_pk_add_f32 v[8:9], v[8:9], v[16:17]
  v_pk_add_f32 v[10:11], v[10:11], v[18:19]
  v_pk_add_f32 v[12:13], v[12:13], v[20:21]
  v_pk_add_f32 v[14:15], v[14:15], v[22:23]
  s_waitcnt vmcnt(8)
  v_lshlrev_b32 v16, 16, v60
  v_and_b32 v17, 0xffff0000, v60
  v_lshlrev_b32 v18, 16, v61
  v_and_b32 v19, 0xffff0000, v61
  v_lshlrev_b32 v20, 16, v62
  v_and_b32 v21, 0xffff0000, v62
  v_lshlrev_b32 v22, 16, v63
  v_and_b32 v23, 0xffff0000, v63
  buffer_load_dwordx4 v[60:63], v2, s[20:23], s19 offen
  s_add_u32 s19, s19, 18432
  v_pk_add_f32 v[8:9], v[8:9], v[16:17]
  v_pk_add_f32 v[10:11], v[10:11], v[18:19]
  v_pk_add_f32 v[12:13], v[12:13], v[20:21]
  v_pk_add_f32 v[14:15], v[14:15], v[22:23]
  s_waitcnt vmcnt(8)
  v_lshlrev_b32 v16, 16, v64
  v_and_b32 v17, 0xffff0000, v64
  v_lshlrev_b32 v18, 16, v65
  v_and_b32 v19, 0xffff0000, v65
  v_lshlrev_b32 v20, 16, v66
  v_and_b32 v21, 0xffff0000, v66
  v_lshlrev_b32 v22, 16, v67
  v_and_b32 v23, 0xffff0000, v67
  buffer_load_dwordx4 v[64:67], v2, s[20:23], s19 offen
  s_add_u32 s19, s19, 18432
  v_pk_add_f32 v[8:9], v[8:9], v[16:17]
  v_pk_add_f32 v[10:11], v[10:11], v[18:19]
  v_pk_add_f32 v[12:13], v[12:13], v[20:21]
  v_pk_add_f32 v[14:15], v[14:15], v[22:23]
  s_cmp_lg_u32 s26, 0
  s_cbranch_scc1 pre_csl
  v_lshlrev_b32 v4, 5, v0
  ds_write_b128 v4, v[8:11]
  ds_write_b128 v4, v[12:15] offset:16
  v_lshlrev_b32 v5, 2, v0
  s_waitcnt lgkmcnt(0)
  s_barrier
  s_cmp_ge_u32 s16, 3
  s_cbranch_scc1 pre_end
  ds_read_b32 v8, v5 offset:0
  ds_read_b32 v9, v5 offset:768
  ds_read_b32 v10, v5 offset:2048
  ds_read_b32 v11, v5 offset:2816
  ds_read_b32 v12, v5 offset:4096
  ds_read_b32 v13, v5 offset:4864
  ds_read_b32 v14, v5 offset:6144
  ds_read_b32 v15, v5 offset:6912
  s_waitcnt lgkmcnt(3)
  v_add_f32 v8, v8, v12
  s_waitcnt lgkmcnt(2)
  v_add_f32 v9, v9, v13
  s_waitcnt lgkmcnt(1)
  v_add_f32 v10, v10, v14
  s_waitcnt lgkmcnt(0)
  v_add_f32 v11, v11, v15
  v_add_f32 v8, v8, v10
  v_add_f32 v9, v9, v11
  v_add_f32 v8, v8, v9
  s_lshl_b32 s17, s17, 1
  s_add_u32 s17, s17, s24
  s_add_u32 s17, s17, s25
  buffer_store_dword v8, v5, s[28:31], s17 offen sc1
  s_endpgm
  .p2align 9
pre_conv:
cv_hopq0:
cv_hop0:
  s_cbranch_execz cv_hop1
  s_waitcnt lgkmcnt(0)
  s_load_dwordx4 s[4:7], s[0:1], 32
  v_and_b32 v1, 63, v0
  s_lshl_b32 s3, s2, 2
  s_add_u32 s3, s3, s16
  s_lshl_b32 s17, s3, 12
  s_mul_i32 s18, s16, 12928
  v_lshlrev_b32 v2, 4, v1
  v_add_u32 v3, 2, v2
  s_mov_b32 s20, s14
  s_mov_b32 s21, s15
  s_mov_b32 s22, 2359296
  s_mov_b32 s23, 0x20000
  s_add_u32 s32, s14, 2359296
  s_addc_u32 s33, s15, 0
  s_mov_b32 s34, 2359296
  s_mov_b32 s35, 0x20000
  s_add_u32 s36, s14, 7077888
  s_addc_u32 s37, s15, 0
  s_mov_b32 s38, 2359296
  s_mov_b32 s39, 0x20000
  s_add_u32 s44, s14, 4718592
  s_addc_u32 s45, s15, 0
  s_mov_b32 s46, 16384
  s_mov_b32 s47, 0x20000
  v_mov_b32 v8, 0
  v_mov_b32 v9, 0
  v_lshl_add_u32 v10, v1, 3, s18
  ds_write_b64 v10, v[8:9] offset:4096
  v_mov_b32 v23, 84480
  v_and_b32 v11, 15, v1
  v_lshrrev_b32 v12, 4, v1
  v_and_b32 v13, 1, v1
  v_cmp_eq_u32 vcc, 1, v13
  v_mov_b32 v13, 4160
  s_nop 0
  v_cndmask_b32 v13, v13, 2, vcc
  v_lshl_add_u32 v13, v11, 1, v13
  v_lshl_add_u32 v13, v12, 4, v13
  s_add_u32 s40, s18, 4608
  v_add_u32 v16, s40, v13
  v_add_u32 v17, 1024, v16
  v_add_u32 v18, 2048, v16
  v_add_u32 v19, 3072, v16
  v_lshlrev_b32 v13, 5, v11
  v_sub_u32 v13, 480, v13
  v_lshl_add_u32 v13, v12, 4, v13
  v_add_u32 v15, s18, v13
  s_waitcnt lgkmcnt(0)
  s_mov_b32 s24, s4
  s_mov_b32 s25, s5
  s_mov_b32 s26, 2359296
  s_mov_b32 s27, 0x20000
  s_mov_b32 s28, s6
  s_mov_b32 s29, s7
  s_mov_b32 s30, 1152
  s_mov_b32 s31, 0x20000
  s_add_u32 m0, s18, 4640
  v_mov_b32 v4, 0
  s_lshl_b32 s19, s3, 1
  buffer_load_ushort v5, v4, s[24:27], s17 offen
  buffer_load_ushort v6, v4, s[28:31], s19 offen
  s_add_u32 m0, s18, 4640
  s_nop 0
  buffer_load_dwordx4 v2, s[24:27], s17 offen offset:0 lds
  buffer_load_dwordx4 v2, s[24:27], s17 offen offset:1024 lds
  buffer_load_dwordx4 v2, s[24:27], s17 offen offset:2048 lds
  buffer_load_dwordx4 v2, s[24:27], s17 offen offset:3072 lds
  v_lshrrev_b32 v20, 2, v1
  s_mov_b64 exec, 0
  s_and_b32 s92, s16, 3
  s_cmp_lg_u32 s92, 0
  s_cbranch_scc1 pre_cvh_n0
  s_call_b64 s[90:91], cv_hopq0
  s_branch pre_cvh_ret
pre_cvh_n0:
  s_cmp_lg_u32 s92, 1
  s_cbranch_scc1 pre_cvh_n1
  s_call_b64 s[90:91], cv_hopq1
  s_branch pre_cvh_ret
pre_cvh_n1:
  s_cmp_lg_u32 s92, 2
  s_cbranch_scc1 pre_cvh_n2
  s_call_b64 s[90:91], cv_hopq2
  s_branch pre_cvh_ret
pre_cvh_n2:
  s_call_b64 s[90:91], cv_hopq3
pre_cvh_ret:
  s_mov_b64 exec, -1
  s_add_u32 m0, s18, 8800
  s_nop 0
  buffer_load_dwordx4 v3, s[24:27], s17 offen offset:0 lds
cv_hop1:
  s_cbranch_execz cv_hop2
  buffer_load_dwordx4 v3, s[24:27], s17 offen offset:1024 lds
  buffer_load_dwordx4 v3, s[24:27], s17 offen offset:2048 lds
  buffer_load_dwordx4 v3, s[24:27], s17 offen offset:3072 lds
  v_lshlrev_b32 v20, 8, v20
  v_and_b32 v8, 3, v1
  v_lshl_add_u32 v20, v8, 4, v20
  v_lshlrev_b32 v7, 6, v11
  v_lshl_add_u32 v7, v12, 4, v7
  s_lshl_b32 s41, s16, 13
  s_add_u32 s41, s41, 51712
  v_add_u32 v7, s41, v7
  v_lshlrev_b32 v10, 3, v0
  v_add_u32 v10, 51712, v10
  v_lshlrev_b32 v4, 4, v0
  s_lshl_b32 s19, s2, 14
  v_lshrrev_b32 v8, 2, v0
  v_lshlrev_b32 v8, 7, v8
  v_and_b32 v9, 3, v0
  v_lshl_add_u32 v8, v9, 4, v8
  s_lshr_b32 s42, s2, 1
  s_lshl_b32 s42, s42, 15
  s_and_b32 s43, s2, 1
  s_lshl_b32 s43, s43, 6
  s_add_u32 s42, s42, s43
  v_sub_u32 v13, 15, v11
  v_and_b32 v14, 1, v13
  v_lshlrev_b32 v14, 4, v14
  v_lshrrev_b32 v13, 1, v13
  v_lshlrev_b32 v12, 2, v12
  v_sub_u32 v12, v13, v12
  s_waitcnt vmcnt(8)
  v_lshlrev_b32 v6, v14, v6
  v_cmp_eq_u32 vcc, 0, v12
  s_nop 1
  v_cndmask_b32 v176, 0, v6, vcc
  v_cmp_eq_u32 vcc, 1, v12
  s_nop 1
  v_cndmask_b32 v177, 0, v6, vcc
  v_cmp_eq_u32 vcc, 2, v12
  s_nop 1
  v_cndmask_b32 v178, 0, v6, vcc
  v_cmp_eq_u32 vcc, 3, v12
  s_nop 1
  v_cndmask_b32 v179, 0, v6, vcc
  v_and_b32 v13, 7, v1
  v_lshlrev_b32 v13, 2, v13
  v_bfe_u32 v14, v1, 3, 1
  v_mul_u32_u24 v14, 4160, v14
  v_add3_u32 v13, v13, v14, s40
  v_lshlrev_b32 v5, 16, v5
  v_cmp_eq_u32 vcc, 15, v11
  s_nop 1
  v_cndmask_b32 v14, 0, v5, vcc
  ds_write_b32 v13, v14
  s_lshl_b32 s41, s16, 6
  s_add_u32 s41, s41, s19
  s_mov_b32 m0, s18
  v_mov_b32 v26, 0
  s_mov_b32 s87, 0x40000
pre_tag2:
  global_load_dwordx2 v[24:25], v26, s[12:13] sc1
  s_waitcnt vmcnt(0)
  v_readfirstlane_b32 s51, v25
  v_readfirstlane_b32 s50, v24
  s_sub_u32 s87, s87, 1
  s_cbranch_scc1 pre_tag2_x
  s_cmp_eq_u32 s51, 0
  s_cbranch_scc1 pre_tag2
pre_tag2_x:
  s_waitcnt vmcnt(0)
  s_waitcnt lgkmcnt(0)
  s_add_u32 s52, s14, 9633792
  s_addc_u32 s53, s15, 0
  s_mov_b32 s54, 69632
  s_mov_b32 s55, 0x20000
  v_lshlrev_b32 v244, 7, v0
  v_add_u32 v244, 36864, v244
  s_cmp_lg_u32 s16, 0
  s_cbranch_scc1 pre_wgo
  s_lshr_b32 s43, s2, 4
  s_add_u32 s52, s14, 9633792
  s_addc_u32 s53, s15, 0
  s_mov_b32 s54, 69632
  s_mov_b32 s55, 0x20000
  v_and_b32 v60, 31, v0
  v_lshlrev_b32 v60, 7, v60
  s_lshl_b32 s43, s43, 12
  s_mov_b32 s87, 0x40000
pre_wkv:
  buffer_load_dword v64, v60, s[52:55], s43 offen sc1
  s_waitcnt vmcnt(0)
  s_sub_u32 s87, s87, 1
  s_cbranch_scc1 pre_wkv_x
  v_cmp_ne_u32 vcc, s50, v64
  s_cbranch_vccnz pre_wkv_s
  s_branch pre_wkv_x
pre_wkv_s:
  s_sleep 1
  s_branch pre_wkv
pre_wkv_x:
  ds_write_b32 v23, v23
  s_branch pre_go
pre_wgo:
  s_mov_b32 s87, 0x40000
pre_wgo1:
  ds_read_b32 v22, v23
  s_waitcnt lgkmcnt(0)
  s_sub_u32 s87, s87, 1
  s_cbranch_scc1 pre_wgo1_x
  v_cmp_eq_u32 vcc, 0, v22
  s_cbranch_vccnz pre_wgo1
pre_wgo1_x:
pre_go:
  s_add_u32 s40, s41, 0
  buffer_load_dwordx4 v20, s[20:23], s40 offen offset:0 sc1 lds
  s_add_u32 s40, s41, 3072
cv_hop2:
  s_cbranch_execz cv_hopret
  buffer_load_dwordx4 v20, s[20:23], s40 offen offset:1024 sc1 lds
  s_add_u32 s40, s41, 6144
  buffer_load_dwordx4 v20, s[20:23], s40 offen offset:2048 sc1 lds
  s_add_u32 s40, s41, 9216
  buffer_load_dwordx4 v20, s[20:23], s40 offen offset:3072 sc1 lds
  v_mov_b32 v14, 84480
  ds_read2_b32 v[52:53], v16 offset0:0 offset1:1
  ds_read2_b32 v[54:55], v16 offset0:2 offset1:3
  ds_read2_b32 v[56:57], v16 offset0:128 offset1:129
  ds_read2_b32 v[58:59], v16 offset0:130 offset1:131
  ds_read2_b32 v[60:61], v17 offset0:0 offset1:1
  ds_read2_b32 v[62:63], v17 offset0:2 offset1:3
  ds_read2_b32 v[64:65], v17 offset0:128 offset1:129
  ds_read2_b32 v[66:67], v17 offset0:130 offset1:131
  ds_read2_b32 v[68:69], v18 offset0:0 offset1:1
  ds_read2_b32 v[70:71], v18 offset0:2 offset1:3
  ds_read2_b32 v[72:73], v18 offset0:128 offset1:129
  ds_read2_b32 v[74:75], v18 offset0:130 offset1:131
  ds_read2_b32 v[76:77], v19 offset0:0 offset1:1
  ds_read2_b32 v[78:79], v19 offset0:2 offset1:3
  ds_read2_b32 v[80:81], v19 offset0:128 offset1:129
  ds_read2_b32 v[82:83], v19 offset0:130 offset1:131
  s_waitcnt vmcnt(0)
  v_mov_b32 v13, 1
  ds_read_b128 v[116:119], v15 offset:3584
  ds_read_b128 v[120:123], v15 offset:3072
  ds_read_b128 v[124:127], v15 offset:2560
  ds_read_b128 v[128:131], v15 offset:2048
  ds_read_b128 v[132:135], v15 offset:1536
  ds_read_b128 v[136:139], v15 offset:1024
  ds_read_b128 v[140:143], v15 offset:512
  ds_read_b128 v[144:147], v15 offset:0
  s_waitcnt lgkmcnt(7)
  v_mfma_f32_16x16x32_bf16 v[20:23], v[52:55], v[116:119], 0
  buffer_load_dword v245, v244, s[52:55], 0 offen sc1
  v_mfma_f32_16x16x32_bf16 v[24:27], v[56:59], v[116:119], 0
  v_mfma_f32_16x16x32_bf16 v[28:31], v[60:63], v[116:119], 0
  v_mfma_f32_16x16x32_bf16 v[32:35], v[64:67], v[116:119], 0
  v_mfma_f32_16x16x32_bf16 v[36:39], v[68:71], v[116:119], 0
  v_mfma_f32_16x16x32_bf16 v[40:43], v[72:75], v[116:119], 0
  v_mfma_f32_16x16x32_bf16 v[44:47], v[76:79], v[116:119], 0
  ds_read2_b32 v[84:85], v16 offset0:16 offset1:17
  v_mfma_f32_16x16x32_bf16 v[48:51], v[80:83], v[116:119], 0
  s_waitcnt lgkmcnt(7)
  v_mfma_f32_16x16x32_bf16 v[24:27], v[52:55], v[120:123], v[24:27]
  ds_read2_b32 v[86:87], v16 offset0:18 offset1:19
  v_mfma_f32_16x16x32_bf16 v[28:31], v[56:59], v[120:123], v[28:31]
  ds_read_b128 v[212:215], v15 offset:3648
  v_mfma_f32_16x16x32_bf16 v[32:35], v[60:63], v[120:123], v[32:35]
  ds_read_b128 v[216:219], v15 offset:3136
  v_mfma_f32_16x16x32_bf16 v[36:39], v[64:67], v[120:123], v[36:39]
  ds_read2_b32 v[88:89], v16 offset0:144 offset1:145
  v_mfma_f32_16x16x32_bf16 v[40:43], v[68:71], v[120:123], v[40:43]
  ds_read2_b32 v[90:91], v16 offset0:146 offset1:147
  v_mfma_f32_16x16x32_bf16 v[44:47], v[72:75], v[120:123], v[44:47]
  ds_read_b128 v[220:223], v15 offset:2624
  v_mfma_f32_16x16x32_bf16 v[48:51], v[76:79], v[120:123], v[48:51]
  ds_read2_b32 v[92:93], v17 offset0:16 offset1:17
  s_waitcnt lgkmcnt(13)
  v_mfma_f32_16x16x32_bf16 v[28:31], v[52:55], v[124:127], v[28:31]
  ds_read2_b32 v[94:95], v17 offset0:18 offset1:19
  v_mfma_f32_16x16x32_bf16 v[32:35], v[56:59], v[124:127], v[32:35]
cv_hopq1:
cv_hop3:
  s_cbranch_execz cv_hop4
  v_mfma_f32_16x16x32_bf16 v[36:39], v[60:63], v[124:127], v[36:39]
  ds_read_b128 v[224:227], v15 offset:2112
  v_mfma_f32_16x16x32_bf16 v[40:43], v[64:67], v[124:127], v[40:43]
  ds_read2_b32 v[96:97], v17 offset0:144 offset1:145
  v_mfma_f32_16x16x32_bf16 v[44:47], v[68:71], v[124:127], v[44:47]
  ds_read2_b32 v[98:99], v17 offset0:146 offset1:147
  v_mfma_f32_16x16x32_bf16 v[48:51], v[72:75], v[124:127], v[48:51]
  ds_read_b128 v[228:231], v15 offset:1600
  s_waitcnt lgkmcnt(15)
  v_mfma_f32_16x16x32_bf16 v[32:35], v[52:55], v[128:131], v[32:35]
  ds_read2_b32 v[100:101], v18 offset0:16 offset1:17
  v_mfma_f32_16x16x32_bf16 v[36:39], v[56:59], v[128:131], v[36:39]
  ds_read2_b32 v[102:103], v18 offset0:18 offset1:19
  v_mfma_f32_16x16x32_bf16 v[40:43], v[60:63], v[128:131], v[40:43]
  ds_read_b128 v[232:235], v15 offset:1088
  v_mfma_f32_16x16x32_bf16 v[44:47], v[64:67], v[128:131], v[44:47]
  ds_read2_b32 v[104:105], v18 offset0:144 offset1:145
  v_mfma_f32_16x16x32_bf16 v[48:51], v[68:71], v[128:131], v[48:51]
  v_mfma_f32_16x16x32_bf16 v[36:39], v[52:55], v[132:135], v[36:39]
  ds_read2_b32 v[106:107], v18 offset0:146 offset1:147
  v_mfma_f32_16x16x32_bf16 v[40:43], v[56:59], v[132:135], v[40:43]
  ds_read_b128 v[236:239], v15 offset:576
  v_mfma_f32_16x16x32_bf16 v[44:47], v[60:63], v[132:135], v[44:47]
  ds_read2_b32 v[108:109], v19 offset0:16 offset1:17
  v_mfma_f32_16x16x32_bf16 v[48:51], v[64:67], v[132:135], v[48:51]
  ds_read2_b32 v[110:111], v19 offset0:18 offset1:19
  v_mfma_f32_16x16x32_bf16 v[40:43], v[52:55], v[136:139], v[40:43]
  ds_read_b128 v[240:243], v15 offset:64
  v_mfma_f32_16x16x32_bf16 v[44:47], v[56:59], v[136:139], v[44:47]
  ds_read2_b32 v[112:113], v19 offset0:144 offset1:145
  v_mfma_f32_16x16x32_bf16 v[48:51], v[60:63], v[136:139], v[48:51]
  ds_read2_b32 v[114:115], v19 offset0:146 offset1:147
  s_waitcnt lgkmcnt(15)
  v_mfma_f32_16x16x32_bf16 v[44:47], v[52:55], v[140:143], v[44:47]
  v_mfma_f32_16x16x32_bf16 v[48:51], v[56:59], v[140:143], v[48:51]
  v_mfma_f32_16x16x32_bf16 v[48:51], v[52:55], v[144:147], v[48:51]
  v_mfma_f32_16x16x32_bf16 v[20:23], v[176:179], v[116:119], v[20:23]
  v_mfma_f32_16x16x32_bf16 v[24:27], v[176:179], v[120:123], v[24:27]
  v_mfma_f32_16x16x32_bf16 v[28:31], v[176:179], v[124:127], v[28:31]
  v_mfma_f32_16x16x32_bf16 v[32:35], v[176:179], v[128:131], v[32:35]
  v_mfma_f32_16x16x32_bf16 v[36:39], v[176:179], v[132:135], v[36:39]
  v_mfma_f32_16x16x32_bf16 v[40:43], v[176:179], v[136:139], v[40:43]
  v_mfma_f32_16x16x32_bf16 v[44:47], v[176:179], v[140:143], v[44:47]
  v_mfma_f32_16x16x32_bf16 v[48:51], v[176:179], v[144:147], v[48:51]
  s_waitcnt lgkmcnt(0)
  v_mfma_f32_16x16x32_bf16 v[20:23], v[84:87], v[212:215], v[20:23]
  ds_read2_b32 v[52:53], v16 offset0:32 offset1:33
  v_mfma_f32_16x16x32_bf16 v[24:27], v[84:87], v[216:219], v[24:27]
  v_mfma_f32_16x16x32_bf16 v[24:27], v[88:91], v[212:215], v[24:27]
  ds_read2_b32 v[54:55], v16 offset0:34 offset1:35
  v_mfma_f32_16x16x32_bf16 v[28:31], v[88:91], v[216:219], v[28:31]
  ds_read_b128 v[116:119], v15 offset:3712
  v_mfma_f32_16x16x32_bf16 v[28:31], v[84:87], v[220:223], v[28:31]
  ds_read_b128 v[120:123], v15 offset:3200
  v_mfma_f32_16x16x32_bf16 v[28:31], v[92:95], v[212:215], v[28:31]
  ds_read2_b32 v[56:57], v16 offset0:160 offset1:161
  v_mfma_f32_16x16x32_bf16 v[32:35], v[88:91], v[220:223], v[32:35]
  ds_read2_b32 v[58:59], v16 offset0:162 offset1:163
  v_mfma_f32_16x16x32_bf16 v[32:35], v[92:95], v[216:219], v[32:35]
  ds_read_b128 v[124:127], v15 offset:2688
  v_mfma_f32_16x16x32_bf16 v[36:39], v[92:95], v[220:223], v[36:39]
  ds_read2_b32 v[60:61], v17 offset0:32 offset1:33
  v_mfma_f32_16x16x32_bf16 v[32:35], v[84:87], v[224:227], v[32:35]
  ds_read2_b32 v[62:63], v17 offset0:34 offset1:35
  v_mfma_f32_16x16x32_bf16 v[32:35], v[96:99], v[212:215], v[32:35]
cv_hop4:
  s_cbranch_execz cv_hop5
  v_mfma_f32_16x16x32_bf16 v[36:39], v[88:91], v[224:227], v[36:39]
  ds_read_b128 v[128:131], v15 offset:2176
  v_mfma_f32_16x16x32_bf16 v[36:39], v[96:99], v[216:219], v[36:39]
  ds_read2_b32 v[64:65], v17 offset0:160 offset1:161
  v_mfma_f32_16x16x32_bf16 v[40:43], v[92:95], v[224:227], v[40:43]
  ds_read2_b32 v[66:67], v17 offset0:162 offset1:163
  v_mfma_f32_16x16x32_bf16 v[40:43], v[96:99], v[220:223], v[40:43]
  ds_read_b128 v[132:135], v15 offset:1664
  v_mfma_f32_16x16x32_bf16 v[44:47], v[96:99], v[224:227], v[44:47]
  ds_read2_b32 v[68:69], v18 offset0:32 offset1:33
  v_mfma_f32_16x16x32_bf16 v[36:39], v[84:87], v[228:231], v[36:39]
  ds_read2_b32 v[70:71], v18 offset0:34 offset1:35
  v_mfma_f32_16x16x32_bf16 v[36:39], v[100:103], v[212:215], v[36:39]
  ds_read_b128 v[136:139], v15 offset:1152
  v_mfma_f32_16x16x32_bf16 v[40:43], v[88:91], v[228:231], v[40:43]
  ds_read2_b32 v[72:73], v18 offset0:160 offset1:161
  v_mfma_f32_16x16x32_bf16 v[40:43], v[100:103], v[216:219], v[40:43]
  v_mfma_f32_16x16x32_bf16 v[44:47], v[92:95], v[228:231], v[44:47]
  ds_read2_b32 v[74:75], v18 offset0:162 offset1:163
  v_mfma_f32_16x16x32_bf16 v[44:47], v[100:103], v[220:223], v[44:47]
  ds_read_b128 v[140:143], v15 offset:640
  v_mfma_f32_16x16x32_bf16 v[48:51], v[96:99], v[228:231], v[48:51]
  ds_read2_b32 v[76:77], v19 offset0:32 offset1:33
  v_mfma_f32_16x16x32_bf16 v[48:51], v[100:103], v[224:227], v[48:51]
  ds_read2_b32 v[78:79], v19 offset0:34 offset1:35
  v_mfma_f32_16x16x32_bf16 v[40:43], v[84:87], v[232:235], v[40:43]
  ds_read_b128 v[144:147], v15 offset:128
  v_mfma_f32_16x16x32_bf16 v[40:43], v[104:107], v[212:215], v[40:43]
  ds_read2_b32 v[80:81], v19 offset0:160 offset1:161
  v_mfma_f32_16x16x32_bf16 v[44:47], v[88:91], v[232:235], v[44:47]
  ds_read2_b32 v[82:83], v19 offset0:162 offset1:163
  v_mfma_f32_16x16x32_bf16 v[44:47], v[104:107], v[216:219], v[44:47]
  v_mfma_f32_16x16x32_bf16 v[48:51], v[92:95], v[232:235], v[48:51]
  v_mfma_f32_16x16x32_bf16 v[48:51], v[104:107], v[220:223], v[48:51]
  v_mfma_f32_16x16x32_bf16 v[44:47], v[84:87], v[236:239], v[44:47]
  s_waitcnt vmcnt(0)
  v_cmp_ne_u32 vcc, s50, v245
  s_cbranch_vccnz pre_wln
pre_wlb:
  s_mov_b64 exec, 1
  ds_add_u32 v14, v13 offset:16
  s_mov_b64 exec, -1
  v_mfma_f32_16x16x32_bf16 v[44:47], v[108:111], v[212:215], v[44:47]
  v_mfma_f32_16x16x32_bf16 v[48:51], v[88:91], v[236:239], v[48:51]
  v_mfma_f32_16x16x32_bf16 v[48:51], v[108:111], v[216:219], v[48:51]
  v_mfma_f32_16x16x32_bf16 v[48:51], v[84:87], v[240:243], v[48:51]
  v_mfma_f32_16x16x32_bf16 v[48:51], v[112:115], v[212:215], v[48:51]
  s_waitcnt lgkmcnt(1)
  v_mfma_f32_16x16x32_bf16 v[20:23], v[52:55], v[116:119], v[20:23]
  ds_read2_b32 v[84:85], v16 offset0:48 offset1:49
  v_mfma_f32_16x16x32_bf16 v[24:27], v[52:55], v[120:123], v[24:27]
  v_mfma_f32_16x16x32_bf16 v[24:27], v[56:59], v[116:119], v[24:27]
  ds_read2_b32 v[86:87], v16 offset0:50 offset1:51
  v_mfma_f32_16x16x32_bf16 v[28:31], v[56:59], v[120:123], v[28:31]
  ds_read_b128 v[212:215], v15 offset:3776
  v_mfma_f32_16x16x32_bf16 v[28:31], v[52:55], v[124:127], v[28:31]
  ds_read_b128 v[216:219], v15 offset:3264
  v_mfma_f32_16x16x32_bf16 v[28:31], v[60:63], v[116:119], v[28:31]
  ds_read2_b32 v[88:89], v16 offset0:176 offset1:177
  v_mfma_f32_16x16x32_bf16 v[32:35], v[56:59], v[124:127], v[32:35]
  ds_read2_b32 v[90:91], v16 offset0:178 offset1:179
  v_mfma_f32_16x16x32_bf16 v[32:35], v[60:63], v[120:123], v[32:35]
  ds_read_b128 v[220:223], v15 offset:2752
  v_mfma_f32_16x16x32_bf16 v[36:39], v[60:63], v[124:127], v[36:39]
  ds_read2_b32 v[92:93], v17 offset0:48 offset1:49
  v_mfma_f32_16x16x32_bf16 v[32:35], v[52:55], v[128:131], v[32:35]
  ds_read2_b32 v[94:95], v17 offset0:50 offset1:51
cv_hop5:
  s_cbranch_execz cv_hopret
  v_mfma_f32_16x16x32_bf16 v[32:35], v[64:67], v[116:119], v[32:35]
  v_mfma_f32_16x16x32_bf16 v[36:39], v[56:59], v[128:131], v[36:39]
  ds_read_b128 v[224:227], v15 offset:2240
  v_mfma_f32_16x16x32_bf16 v[36:39], v[64:67], v[120:123], v[36:39]
  ds_read2_b32 v[96:97], v17 offset0:176 offset1:177
  v_mfma_f32_16x16x32_bf16 v[40:43], v[60:63], v[128:131], v[40:43]
  ds_read2_b32 v[98:99], v17 offset0:178 offset1:179
  v_mfma_f32_16x16x32_bf16 v[40:43], v[64:67], v[124:127], v[40:43]
  ds_read_b128 v[228:231], v15 offset:1728
  v_mfma_f32_16x16x32_bf16 v[44:47], v[64:67], v[128:131], v[44:47]
  ds_read2_b32 v[100:101], v18 offset0:48 offset1:49
  v_mfma_f32_16x16x32_bf16 v[36:39], v[52:55], v[132:135], v[36:39]
  ds_read2_b32 v[102:103], v18 offset0:50 offset1:51
  v_mfma_f32_16x16x32_bf16 v[36:39], v[68:71], v[116:119], v[36:39]
  ds_read_b128 v[232:235], v15 offset:1216
  v_mfma_f32_16x16x32_bf16 v[40:43], v[56:59], v[132:135], v[40:43]
  ds_read2_b32 v[104:105], v18 offset0:176 offset1:177
  v_mfma_f32_16x16x32_bf16 v[40:43], v[68:71], v[120:123], v[40:43]
  v_mfma_f32_16x16x32_bf16 v[44:47], v[60:63], v[132:135], v[44:47]
  ds_read2_b32 v[106:107], v18 offset0:178 offset1:179
  v_mfma_f32_16x16x32_bf16 v[44:47], v[68:71], v[124:127], v[44:47]
  ds_read_b128 v[236:239], v15 offset:704
  v_mfma_f32_16x16x32_bf16 v[48:51], v[64:67], v[132:135], v[48:51]
  ds_read2_b32 v[108:109], v19 offset0:48 offset1:49
  v_mfma_f32_16x16x32_bf16 v[48:51], v[68:71], v[128:131], v[48:51]
  ds_read2_b32 v[110:111], v19 offset0:50 offset1:51
  v_mfma_f32_16x16x32_bf16 v[40:43], v[52:55], v[136:139], v[40:43]
  ds_read_b128 v[240:243], v15 offset:192
  v_mfma_f32_16x16x32_bf16 v[40:43], v[72:75], v[116:119], v[40:43]
  ds_read2_b32 v[112:113], v19 offset0:176 offset1:177
  ds_read_b32 v245, v14 offset:16
  v_mfma_f32_16x16x32_bf16 v[44:47], v[56:59], v[136:139], v[44:47]
  ds_read2_b32 v[114:115], v19 offset0:178 offset1:179
  v_mfma_f32_16x16x32_bf16 v[44:47], v[72:75], v[120:123], v[44:47]
  v_mfma_f32_16x16x32_bf16 v[48:51], v[60:63], v[136:139], v[48:51]
  v_mfma_f32_16x16x32_bf16 v[48:51], v[72:75], v[124:127], v[48:51]
  v_mfma_f32_16x16x32_bf16 v[44:47], v[52:55], v[140:143], v[44:47]
  v_mfma_f32_16x16x32_bf16 v[44:47], v[76:79], v[116:119], v[44:47]
  v_mfma_f32_16x16x32_bf16 v[48:51], v[56:59], v[140:143], v[48:51]
  v_mfma_f32_16x16x32_bf16 v[48:51], v[76:79], v[120:123], v[48:51]
  s_waitcnt lgkmcnt(1)
  v_cmp_ne_u32 vcc, 4, v245
  s_cbranch_vccnz pre_wl2
pre_wl2b:
  v_mfma_f32_16x16x32_bf16 v[48:51], v[52:55], v[144:147], v[48:51]
  v_mfma_f32_16x16x32_bf16 v[48:51], v[80:83], v[116:119], v[48:51]
  s_waitcnt lgkmcnt(0)
  v_mfma_f32_16x16x32_bf16 v[20:23], v[84:87], v[212:215], v[20:23]
  ds_read2_b32 v[52:53], v16 offset0:64 offset1:65
  v_mfma_f32_16x16x32_bf16 v[24:27], v[84:87], v[216:219], v[24:27]
  v_mfma_f32_16x16x32_bf16 v[24:27], v[88:91], v[212:215], v[24:27]
  ds_read2_b32 v[54:55], v16 offset0:66 offset1:67
  v_mfma_f32_16x16x32_bf16 v[28:31], v[88:91], v[216:219], v[28:31]
  ds_read_b128 v[116:119], v15 offset:3840
  v_mfma_f32_16x16x32_bf16 v[28:31], v[84:87], v[220:223], v[28:31]
  ds_read_b128 v[120:123], v15 offset:3328
  v_mfma_f32_16x16x32_bf16 v[28:31], v[92:95], v[212:215], v[28:31]
  ds_read2_b32 v[56:57], v16 offset0:192 offset1:193
  v_mfma_f32_16x16x32_bf16 v[32:35], v[88:91], v[220:223], v[32:35]
  ds_read2_b32 v[58:59], v16 offset0:194 offset1:195
  v_mfma_f32_16x16x32_bf16 v[32:35], v[92:95], v[216:219], v[32:35]
  ds_read_b128 v[124:127], v15 offset:2816
  v_mfma_f32_16x16x32_bf16 v[36:39], v[92:95], v[220:223], v[36:39]
  ds_read2_b32 v[60:61], v17 offset0:64 offset1:65
  v_mfma_f32_16x16x32_bf16 v[32:35], v[84:87], v[224:227], v[32:35]
  ds_read2_b32 v[62:63], v17 offset0:66 offset1:67
  v_mfma_f32_16x16x32_bf16 v[32:35], v[96:99], v[212:215], v[32:35]
cv_hopq2:
cv_hop6:
  s_cbranch_execz cv_hop7
  v_mfma_f32_16x16x32_bf16 v[36:39], v[88:91], v[224:227], v[36:39]
  ds_read_b128 v[128:131], v15 offset:2304
  v_mfma_f32_16x16x32_bf16 v[36:39], v[96:99], v[216:219], v[36:39]
  ds_read2_b32 v[64:65], v17 offset0:192 offset1:193
  v_mfma_f32_16x16x32_bf16 v[40:43], v[92:95], v[224:227], v[40:43]
  ds_read2_b32 v[66:67], v17 offset0:194 offset1:195
  v_mfma_f32_16x16x32_bf16 v[40:43], v[96:99], v[220:223], v[40:43]
  ds_read_b128 v[132:135], v15 offset:1792
  v_mfma_f32_16x16x32_bf16 v[44:47], v[96:99], v[224:227], v[44:47]
  ds_read2_b32 v[68:69], v18 offset0:64 offset1:65
  v_mfma_f32_16x16x32_bf16 v[36:39], v[84:87], v[228:231], v[36:39]
  ds_read2_b32 v[70:71], v18 offset0:66 offset1:67
  v_mfma_f32_16x16x32_bf16 v[36:39], v[100:103], v[212:215], v[36:39]
  ds_read_b128 v[136:139], v15 offset:1280
  v_mfma_f32_16x16x32_bf16 v[40:43], v[88:91], v[228:231], v[40:43]
  ds_read2_b32 v[72:73], v18 offset0:192 offset1:193
  v_mfma_f32_16x16x32_bf16 v[40:43], v[100:103], v[216:219], v[40:43]
  v_mfma_f32_16x16x32_bf16 v[44:47], v[92:95], v[228:231], v[44:47]
  ds_read2_b32 v[74:75], v18 offset0:194 offset1:195
  v_mfma_f32_16x16x32_bf16 v[44:47], v[100:103], v[220:223], v[44:47]
  ds_read_b128 v[140:143], v15 offset:768
  v_mfma_f32_16x16x32_bf16 v[48:51], v[96:99], v[228:231], v[48:51]
  ds_read2_b32 v[76:77], v19 offset0:64 offset1:65
  v_mfma_f32_16x16x32_bf16 v[48:51], v[100:103], v[224:227], v[48:51]
  ds_read2_b32 v[78:79], v19 offset0:66 offset1:67
  v_mfma_f32_16x16x32_bf16 v[40:43], v[84:87], v[232:235], v[40:43]
  ds_read_b128 v[144:147], v15 offset:256
  v_mfma_f32_16x16x32_bf16 v[40:43], v[104:107], v[212:215], v[40:43]
  ds_read2_b32 v[80:81], v19 offset0:192 offset1:193
  s_add_u32 s40, s42, 0
  buffer_load_dwordx4 v[180:183], v8, s[32:35], s40 offen sc1
  v_mfma_f32_16x16x32_bf16 v[44:47], v[88:91], v[232:235], v[44:47]
  ds_read2_b32 v[82:83], v19 offset0:194 offset1:195
  v_mfma_f32_16x16x32_bf16 v[44:47], v[104:107], v[216:219], v[44:47]
  s_mov_b32 s40, 0
  buffer_load_dwordx4 v[184:187], v4, s[44:47], s40 offen sc1
  v_mfma_f32_16x16x32_bf16 v[48:51], v[92:95], v[232:235], v[48:51]
  v_mfma_f32_16x16x32_bf16 v[48:51], v[104:107], v[220:223], v[48:51]
  s_add_u32 s40, s42, 8192
  buffer_load_dwordx4 v[188:191], v8, s[32:35], s40 offen sc1
  v_mfma_f32_16x16x32_bf16 v[44:47], v[84:87], v[236:239], v[44:47]
  v_mfma_f32_16x16x32_bf16 v[44:47], v[108:111], v[212:215], v[44:47]
  s_mov_b32 s40, 4096
  buffer_load_dwordx4 v[192:195], v4, s[44:47], s40 offen sc1
  v_mfma_f32_16x16x32_bf16 v[48:51], v[88:91], v[236:239], v[48:51]
  v_mfma_f32_16x16x32_bf16 v[48:51], v[108:111], v[216:219], v[48:51]
  v_mfma_f32_16x16x32_bf16 v[48:51], v[84:87], v[240:243], v[48:51]
  v_mfma_f32_16x16x32_bf16 v[48:51], v[112:115], v[212:215], v[48:51]
  s_waitcnt lgkmcnt(0)
  v_mfma_f32_16x16x32_bf16 v[20:23], v[52:55], v[116:119], v[20:23]
  ds_read2_b32 v[84:85], v16 offset0:80 offset1:81
  v_mfma_f32_16x16x32_bf16 v[24:27], v[52:55], v[120:123], v[24:27]
  v_mfma_f32_16x16x32_bf16 v[24:27], v[56:59], v[116:119], v[24:27]
  ds_read2_b32 v[86:87], v16 offset0:82 offset1:83
  v_mfma_f32_16x16x32_bf16 v[28:31], v[56:59], v[120:123], v[28:31]
  ds_read_b128 v[212:215], v15 offset:3904
  v_mfma_f32_16x16x32_bf16 v[28:31], v[52:55], v[124:127], v[28:31]
  ds_read_b128 v[216:219], v15 offset:3392
  v_mfma_f32_16x16x32_bf16 v[28:31], v[60:63], v[116:119], v[28:31]
  ds_read2_b32 v[88:89], v16 offset0:208 offset1:209
  v_mfma_f32_16x16x32_bf16 v[32:35], v[56:59], v[124:127], v[32:35]
  ds_read2_b32 v[90:91], v16 offset0:210 offset1:211
  v_mfma_f32_16x16x32_bf16 v[32:35], v[60:63], v[120:123], v[32:35]
  ds_read_b128 v[220:223], v15 offset:2880
  v_mfma_f32_16x16x32_bf16 v[36:39], v[60:63], v[124:127], v[36:39]
  ds_read2_b32 v[92:93], v17 offset0:80 offset1:81
  v_mfma_f32_16x16x32_bf16 v[32:35], v[52:55], v[128:131], v[32:35]
  ds_read2_b32 v[94:95], v17 offset0:82 offset1:83
  v_mfma_f32_16x16x32_bf16 v[32:35], v[64:67], v[116:119], v[32:35]
cv_hop7:
  s_cbranch_execz cv_hop8
  v_mfma_f32_16x16x32_bf16 v[36:39], v[56:59], v[128:131], v[36:39]
  ds_read_b128 v[224:227], v15 offset:2368
  v_mfma_f32_16x16x32_bf16 v[36:39], v[64:67], v[120:123], v[36:39]
  ds_read2_b32 v[96:97], v17 offset0:208 offset1:209
  v_mfma_f32_16x16x32_bf16 v[40:43], v[60:63], v[128:131], v[40:43]
  ds_read2_b32 v[98:99], v17 offset0:210 offset1:211
  v_mfma_f32_16x16x32_bf16 v[40:43], v[64:67], v[124:127], v[40:43]
  ds_read_b128 v[228:231], v15 offset:1856
  v_mfma_f32_16x16x32_bf16 v[44:47], v[64:67], v[128:131], v[44:47]
  ds_read2_b32 v[100:101], v18 offset0:80 offset1:81
  v_mfma_f32_16x16x32_bf16 v[36:39], v[52:55], v[132:135], v[36:39]
  ds_read2_b32 v[102:103], v18 offset0:82 offset1:83
  v_mfma_f32_16x16x32_bf16 v[36:39], v[68:71], v[116:119], v[36:39]
  ds_read_b128 v[232:235], v15 offset:1344
  v_mfma_f32_16x16x32_bf16 v[40:43], v[56:59], v[132:135], v[40:43]
  ds_read2_b32 v[104:105], v18 offset0:208 offset1:209
  v_mfma_f32_16x16x32_bf16 v[40:43], v[68:71], v[120:123], v[40:43]
  v_mfma_f32_16x16x32_bf16 v[44:47], v[60:63], v[132:135], v[44:47]
  ds_read2_b32 v[106:107], v18 offset0:210 offset1:211
  v_mfma_f32_16x16x32_bf16 v[44:47], v[68:71], v[124:127], v[44:47]
  ds_read_b128 v[236:239], v15 offset:832
  v_mfma_f32_16x16x32_bf16 v[48:51], v[64:67], v[132:135], v[48:51]
  ds_read2_b32 v[108:109], v19 offset0:80 offset1:81
  v_mfma_f32_16x16x32_bf16 v[48:51], v[68:71], v[128:131], v[48:51]
  ds_read2_b32 v[110:111], v19 offset0:82 offset1:83
  v_mfma_f32_16x16x32_bf16 v[40:43], v[52:55], v[136:139], v[40:43]
  ds_read_b128 v[240:243], v15 offset:320
  v_mfma_f32_16x16x32_bf16 v[40:43], v[72:75], v[116:119], v[40:43]
  ds_read2_b32 v[112:113], v19 offset0:208 offset1:209
  s_add_u32 s40, s42, 16384
  buffer_load_dwordx4 v[196:199], v8, s[32:35], s40 offen sc1
  v_mfma_f32_16x16x32_bf16 v[44:47], v[56:59], v[136:139], v[44:47]
  ds_read2_b32 v[114:115], v19 offset0:210 offset1:211
  v_mfma_f32_16x16x32_bf16 v[44:47], v[72:75], v[120:123], v[44:47]
  s_mov_b32 s40, 8192
  buffer_load_dwordx4 v[200:203], v4, s[44:47], s40 offen sc1
  v_mfma_f32_16x16x32_bf16 v[48:51], v[60:63], v[136:139], v[48:51]
  v_mfma_f32_16x16x32_bf16 v[48:51], v[72:75], v[124:127], v[48:51]
  s_add_u32 s40, s42, 24576
  buffer_load_dwordx4 v[204:207], v8, s[32:35], s40 offen sc1
  v_mfma_f32_16x16x32_bf16 v[44:47], v[52:55], v[140:143], v[44:47]
  v_mfma_f32_16x16x32_bf16 v[44:47], v[76:79], v[116:119], v[44:47]
  s_mov_b32 s40, 12288
  buffer_load_dwordx4 v[208:211], v4, s[44:47], s40 offen sc1
  v_mfma_f32_16x16x32_bf16 v[48:51], v[56:59], v[140:143], v[48:51]
  v_mfma_f32_16x16x32_bf16 v[48:51], v[76:79], v[120:123], v[48:51]
  v_mfma_f32_16x16x32_bf16 v[48:51], v[52:55], v[144:147], v[48:51]
  v_mfma_f32_16x16x32_bf16 v[48:51], v[80:83], v[116:119], v[48:51]
  s_waitcnt lgkmcnt(0)
  v_mfma_f32_16x16x32_bf16 v[20:23], v[84:87], v[212:215], v[20:23]
  ds_read2_b32 v[52:53], v16 offset0:96 offset1:97
  v_mfma_f32_16x16x32_bf16 v[24:27], v[84:87], v[216:219], v[24:27]
  v_mfma_f32_16x16x32_bf16 v[24:27], v[88:91], v[212:215], v[24:27]
  ds_read2_b32 v[54:55], v16 offset0:98 offset1:99
  v_mfma_f32_16x16x32_bf16 v[28:31], v[88:91], v[216:219], v[28:31]
  ds_read_b128 v[116:119], v15 offset:3968
  v_mfma_f32_16x16x32_bf16 v[28:31], v[84:87], v[220:223], v[28:31]
  ds_read_b128 v[120:123], v15 offset:3456
  v_mfma_f32_16x16x32_bf16 v[28:31], v[92:95], v[212:215], v[28:31]
  ds_read2_b32 v[56:57], v16 offset0:224 offset1:225
cv_hop8:
  s_cbranch_execz cv_hopret
  v_mfma_f32_16x16x32_bf16 v[32:35], v[88:91], v[220:223], v[32:35]
  ds_read2_b32 v[58:59], v16 offset0:226 offset1:227
  v_mfma_f32_16x16x32_bf16 v[32:35], v[92:95], v[216:219], v[32:35]
  ds_read_b128 v[124:127], v15 offset:2944
  v_mfma_f32_16x16x32_bf16 v[36:39], v[92:95], v[220:223], v[36:39]
  ds_read2_b32 v[60:61], v17 offset0:96 offset1:97
  v_mfma_f32_16x16x32_bf16 v[32:35], v[84:87], v[224:227], v[32:35]
  ds_read2_b32 v[62:63], v17 offset0:98 offset1:99
  v_mfma_f32_16x16x32_bf16 v[32:35], v[96:99], v[212:215], v[32:35]
  v_mfma_f32_16x16x32_bf16 v[36:39], v[88:91], v[224:227], v[36:39]
  ds_read_b128 v[128:131], v15 offset:2432
  v_mfma_f32_16x16x32_bf16 v[36:39], v[96:99], v[216:219], v[36:39]
  ds_read2_b32 v[64:65], v17 offset0:224 offset1:225
  v_mfma_f32_16x16x32_bf16 v[40:43], v[92:95], v[224:227], v[40:43]
  ds_read2_b32 v[66:67], v17 offset0:226 offset1:227
  v_mfma_f32_16x16x32_bf16 v[40:43], v[96:99], v[220:223], v[40:43]
  ds_read_b128 v[132:135], v15 offset:1920
  v_mfma_f32_16x16x32_bf16 v[44:47], v[96:99], v[224:227], v[44:47]
  ds_read2_b32 v[68:69], v18 offset0:96 offset1:97
  v_mfma_f32_16x16x32_bf16 v[36:39], v[84:87], v[228:231], v[36:39]
  ds_read2_b32 v[70:71], v18 offset0:98 offset1:99
  v_mfma_f32_16x16x32_bf16 v[36:39], v[100:103], v[212:215], v[36:39]
  ds_read_b128 v[136:139], v15 offset:1408
  v_mfma_f32_16x16x32_bf16 v[40:43], v[88:91], v[228:231], v[40:43]
  ds_read2_b32 v[72:73], v18 offset0:224 offset1:225
  v_mfma_f32_16x16x32_bf16 v[40:43], v[100:103], v[216:219], v[40:43]
  v_mfma_f32_16x16x32_bf16 v[44:47], v[92:95], v[228:231], v[44:47]
  ds_read2_b32 v[74:75], v18 offset0:226 offset1:227
  v_mfma_f32_16x16x32_bf16 v[44:47], v[100:103], v[220:223], v[44:47]
  ds_read_b128 v[140:143], v15 offset:896
  v_mfma_f32_16x16x32_bf16 v[48:51], v[96:99], v[228:231], v[48:51]
  ds_read2_b32 v[76:77], v19 offset0:96 offset1:97
  v_mfma_f32_16x16x32_bf16 v[48:51], v[100:103], v[224:227], v[48:51]
  ds_read2_b32 v[78:79], v19 offset0:98 offset1:99
  v_mfma_f32_16x16x32_bf16 v[40:43], v[84:87], v[232:235], v[40:43]
  ds_read_b128 v[144:147], v15 offset:384
  v_mfma_f32_16x16x32_bf16 v[40:43], v[104:107], v[212:215], v[40:43]
  ds_read2_b32 v[80:81], v19 offset0:224 offset1:225
  v_mfma_f32_16x16x32_bf16 v[44:47], v[88:91], v[232:235], v[44:47]
  ds_read2_b32 v[82:83], v19 offset0:226 offset1:227
  v_mfma_f32_16x16x32_bf16 v[44:47], v[104:107], v[216:219], v[44:47]
  v_mfma_f32_16x16x32_bf16 v[48:51], v[92:95], v[232:235], v[48:51]
  v_mfma_f32_16x16x32_bf16 v[48:51], v[104:107], v[220:223], v[48:51]
  v_mfma_f32_16x16x32_bf16 v[44:47], v[84:87], v[236:239], v[44:47]
  v_mfma_f32_16x16x32_bf16 v[44:47], v[108:111], v[212:215], v[44:47]
  v_mfma_f32_16x16x32_bf16 v[48:51], v[88:91], v[236:239], v[48:51]
  v_mfma_f32_16x16x32_bf16 v[48:51], v[108:111], v[216:219], v[48:51]
  v_mfma_f32_16x16x32_bf16 v[48:51], v[84:87], v[240:243], v[48:51]
  v_mfma_f32_16x16x32_bf16 v[48:51], v[112:115], v[212:215], v[48:51]
  s_waitcnt lgkmcnt(0)
  v_mfma_f32_16x16x32_bf16 v[20:23], v[52:55], v[116:119], v[20:23]
  ds_read2_b32 v[84:85], v16 offset0:112 offset1:113
  v_mfma_f32_16x16x32_bf16 v[24:27], v[52:55], v[120:123], v[24:27]
  v_mfma_f32_16x16x32_bf16 v[24:27], v[56:59], v[116:119], v[24:27]
  ds_read2_b32 v[86:87], v16 offset0:114 offset1:115
  v_mfma_f32_16x16x32_bf16 v[28:31], v[56:59], v[120:123], v[28:31]
  ds_read_b128 v[212:215], v15 offset:4032
  v_mfma_f32_16x16x32_bf16 v[28:31], v[52:55], v[124:127], v[28:31]
  ds_read_b128 v[216:219], v15 offset:3520
  v_mfma_f32_16x16x32_bf16 v[28:31], v[60:63], v[116:119], v[28:31]
  ds_read2_b32 v[88:89], v16 offset0:240 offset1:241
  v_mfma_f32_16x16x32_bf16 v[32:35], v[56:59], v[124:127], v[32:35]
  ds_read2_b32 v[90:91], v16 offset0:242 offset1:243
  v_mfma_f32_16x16x32_bf16 v[32:35], v[60:63], v[120:123], v[32:35]
cv_hopq3:
cv_hop9:
  s_cbranch_execz cv_hop10
  ds_read_b128 v[220:223], v15 offset:3008
  v_mfma_f32_16x16x32_bf16 v[36:39], v[60:63], v[124:127], v[36:39]
  ds_read2_b32 v[92:93], v17 offset0:112 offset1:113
  v_mfma_f32_16x16x32_bf16 v[32:35], v[52:55], v[128:131], v[32:35]
  ds_read2_b32 v[94:95], v17 offset0:114 offset1:115
  v_mfma_f32_16x16x32_bf16 v[32:35], v[64:67], v[116:119], v[32:35]
  v_mfma_f32_16x16x32_bf16 v[36:39], v[56:59], v[128:131], v[36:39]
  ds_read_b128 v[224:227], v15 offset:2496
  v_mfma_f32_16x16x32_bf16 v[36:39], v[64:67], v[120:123], v[36:39]
  ds_read2_b32 v[96:97], v17 offset0:240 offset1:241
  v_mfma_f32_16x16x32_bf16 v[40:43], v[60:63], v[128:131], v[40:43]
  ds_read2_b32 v[98:99], v17 offset0:242 offset1:243
  v_mfma_f32_16x16x32_bf16 v[40:43], v[64:67], v[124:127], v[40:43]
  ds_read_b128 v[228:231], v15 offset:1984
  v_mfma_f32_16x16x32_bf16 v[44:47], v[64:67], v[128:131], v[44:47]
  ds_read2_b32 v[100:101], v18 offset0:112 offset1:113
  v_mfma_f32_16x16x32_bf16 v[36:39], v[52:55], v[132:135], v[36:39]
  ds_read2_b32 v[102:103], v18 offset0:114 offset1:115
  v_mfma_f32_16x16x32_bf16 v[36:39], v[68:71], v[116:119], v[36:39]
  ds_read_b128 v[232:235], v15 offset:1472
  v_mfma_f32_16x16x32_bf16 v[40:43], v[56:59], v[132:135], v[40:43]
  ds_read2_b32 v[104:105], v18 offset0:240 offset1:241
  v_mfma_f32_16x16x32_bf16 v[40:43], v[68:71], v[120:123], v[40:43]
  v_mfma_f32_16x16x32_bf16 v[44:47], v[60:63], v[132:135], v[44:47]
  ds_read2_b32 v[106:107], v18 offset0:242 offset1:243
  v_mfma_f32_16x16x32_bf16 v[44:47], v[68:71], v[124:127], v[44:47]
  ds_read_b128 v[236:239], v15 offset:960
  v_mfma_f32_16x16x32_bf16 v[48:51], v[64:67], v[132:135], v[48:51]
  ds_read2_b32 v[108:109], v19 offset0:112 offset1:113
  v_mfma_f32_16x16x32_bf16 v[48:51], v[68:71], v[128:131], v[48:51]
  ds_read2_b32 v[110:111], v19 offset0:114 offset1:115
  v_mfma_f32_16x16x32_bf16 v[40:43], v[52:55], v[136:139], v[40:43]
  ds_read_b128 v[240:243], v15 offset:448
  v_mfma_f32_16x16x32_bf16 v[40:43], v[72:75], v[116:119], v[40:43]
  ds_read2_b32 v[112:113], v19 offset0:240 offset1:241
  v_mfma_f32_16x16x32_bf16 v[44:47], v[56:59], v[136:139], v[44:47]
  ds_read2_b32 v[114:115], v19 offset0:242 offset1:243
  v_mfma_f32_16x16x32_bf16 v[44:47], v[72:75], v[120:123], v[44:47]
  v_mfma_f32_16x16x32_bf16 v[48:51], v[60:63], v[136:139], v[48:51]
  v_mfma_f32_16x16x32_bf16 v[48:51], v[72:75], v[124:127], v[48:51]
  v_mfma_f32_16x16x32_bf16 v[44:47], v[52:55], v[140:143], v[44:47]
  v_mfma_f32_16x16x32_bf16 v[44:47], v[76:79], v[116:119], v[44:47]
  v_mfma_f32_16x16x32_bf16 v[48:51], v[56:59], v[140:143], v[48:51]
  v_mfma_f32_16x16x32_bf16 v[48:51], v[76:79], v[120:123], v[48:51]
  v_mfma_f32_16x16x32_bf16 v[48:51], v[52:55], v[144:147], v[48:51]
  v_mfma_f32_16x16x32_bf16 v[48:51], v[80:83], v[116:119], v[48:51]
  s_waitcnt lgkmcnt(0)
  v_mfma_f32_16x16x32_bf16 v[48:51], v[84:87], v[240:243], v[48:51]
  s_waitcnt vmcnt(7)
  v_lshlrev_b32 v116, 16, v180
  v_and_b32 v117, 0xffff0000, v180
  v_mfma_f32_16x16x32_bf16 v[48:51], v[88:91], v[236:239], v[48:51]
  s_waitcnt vmcnt(6)
  v_fma_f32 v118, v116, v184, v185
  v_fma_f32 v119, v117, v184, v185
  v_mfma_f32_16x16x32_bf16 v[48:51], v[92:95], v[232:235], v[48:51]
  v_lshlrev_b32 v120, 16, v181
  v_and_b32 v121, 0xffff0000, v181
  v_mfma_f32_16x16x32_bf16 v[48:51], v[96:99], v[228:231], v[48:51]
  v_fma_f32 v122, v120, v184, v185
  v_fma_f32 v123, v121, v184, v185
  v_mfma_f32_16x16x32_bf16 v[48:51], v[100:103], v[224:227], v[48:51]
  v_lshlrev_b32 v124, 16, v182
  v_and_b32 v125, 0xffff0000, v182
  v_mfma_f32_16x16x32_bf16 v[48:51], v[104:107], v[220:223], v[48:51]
  v_fma_f32 v126, v124, v186, v187
cv_hop10:
  s_cbranch_execz cv_hop11
  v_fma_f32 v127, v125, v186, v187
  v_mfma_f32_16x16x32_bf16 v[48:51], v[108:111], v[216:219], v[48:51]
  v_lshlrev_b32 v128, 16, v183
  v_and_b32 v129, 0xffff0000, v183
  v_mfma_f32_16x16x32_bf16 v[48:51], v[112:115], v[212:215], v[48:51]
  v_fma_f32 v130, v128, v186, v187
  v_fma_f32 v131, v129, v186, v187
  v_mfma_f32_16x16x32_bf16 v[44:47], v[84:87], v[236:239], v[44:47]
  s_waitcnt vmcnt(5)
  v_lshlrev_b32 v132, 16, v188
  v_and_b32 v133, 0xffff0000, v188
  v_mfma_f32_16x16x32_bf16 v[44:47], v[88:91], v[232:235], v[44:47]
  s_waitcnt vmcnt(4)
  v_fma_f32 v134, v132, v192, v193
  v_fma_f32 v135, v133, v192, v193
  v_mfma_f32_16x16x32_bf16 v[44:47], v[92:95], v[228:231], v[44:47]
  v_lshlrev_b32 v136, 16, v189
  v_and_b32 v137, 0xffff0000, v189
  v_mfma_f32_16x16x32_bf16 v[44:47], v[96:99], v[224:227], v[44:47]
  ds_write_b128 v7, v[48:51] offset:7168
  v_fma_f32 v138, v136, v192, v193
  v_mfma_f32_16x16x32_bf16 v[44:47], v[100:103], v[220:223], v[44:47]
  v_fma_f32 v139, v137, v192, v193
  v_lshlrev_b32 v140, 16, v190
  v_mfma_f32_16x16x32_bf16 v[44:47], v[104:107], v[216:219], v[44:47]
  v_and_b32 v141, 0xffff0000, v190
  v_fma_f32 v142, v140, v194, v195
  v_mfma_f32_16x16x32_bf16 v[44:47], v[108:111], v[212:215], v[44:47]
  v_fma_f32 v143, v141, v194, v195
  v_lshlrev_b32 v144, 16, v191
  v_mfma_f32_16x16x32_bf16 v[40:43], v[84:87], v[232:235], v[40:43]
  v_and_b32 v145, 0xffff0000, v191
  v_fma_f32 v146, v144, v194, v195
  v_mfma_f32_16x16x32_bf16 v[40:43], v[88:91], v[228:231], v[40:43]
  v_fma_f32 v147, v145, v194, v195
  s_waitcnt vmcnt(3)
  v_lshlrev_b32 v148, 16, v196
  v_mfma_f32_16x16x32_bf16 v[40:43], v[92:95], v[224:227], v[40:43]
  v_and_b32 v149, 0xffff0000, v196
  s_waitcnt vmcnt(2)
  v_fma_f32 v150, v148, v200, v201
  v_mfma_f32_16x16x32_bf16 v[40:43], v[96:99], v[220:223], v[40:43]
  ds_write_b128 v7, v[44:47] offset:6144
  v_fma_f32 v151, v149, v200, v201
  v_mfma_f32_16x16x32_bf16 v[40:43], v[100:103], v[216:219], v[40:43]
  v_lshlrev_b32 v152, 16, v197
  v_and_b32 v153, 0xffff0000, v197
  v_mfma_f32_16x16x32_bf16 v[40:43], v[104:107], v[212:215], v[40:43]
  v_fma_f32 v154, v152, v200, v201
  v_fma_f32 v155, v153, v200, v201
  v_mfma_f32_16x16x32_bf16 v[36:39], v[84:87], v[228:231], v[36:39]
  v_lshlrev_b32 v156, 16, v198
  v_and_b32 v157, 0xffff0000, v198
  v_mfma_f32_16x16x32_bf16 v[36:39], v[88:91], v[224:227], v[36:39]
  v_fma_f32 v158, v156, v202, v203
  v_fma_f32 v159, v157, v202, v203
  v_mfma_f32_16x16x32_bf16 v[36:39], v[92:95], v[220:223], v[36:39]
  v_lshlrev_b32 v160, 16, v199
  v_and_b32 v161, 0xffff0000, v199
  v_mfma_f32_16x16x32_bf16 v[36:39], v[96:99], v[216:219], v[36:39]
  ds_write_b128 v7, v[40:43] offset:5120
  v_fma_f32 v162, v160, v202, v203
  v_mfma_f32_16x16x32_bf16 v[36:39], v[100:103], v[212:215], v[36:39]
  v_fma_f32 v163, v161, v202, v203
  s_waitcnt vmcnt(1)
  v_lshlrev_b32 v164, 16, v204
  v_mfma_f32_16x16x32_bf16 v[32:35], v[84:87], v[224:227], v[32:35]
  v_and_b32 v165, 0xffff0000, v204
  s_waitcnt vmcnt(0)
  v_fma_f32 v166, v164, v208, v209
  v_mfma_f32_16x16x32_bf16 v[32:35], v[88:91], v[220:223], v[32:35]
  v_fma_f32 v167, v165, v208, v209
cv_hop11:
  s_cbranch_execz cv_hop12
  v_lshlrev_b32 v168, 16, v205
  v_mfma_f32_16x16x32_bf16 v[32:35], v[92:95], v[216:219], v[32:35]
  v_and_b32 v169, 0xffff0000, v205
  v_fma_f32 v170, v168, v208, v209
  v_mfma_f32_16x16x32_bf16 v[32:35], v[96:99], v[212:215], v[32:35]
  ds_write_b128 v7, v[36:39] offset:4096
  v_fma_f32 v171, v169, v208, v209
  v_mfma_f32_16x16x32_bf16 v[28:31], v[84:87], v[220:223], v[28:31]
  v_lshlrev_b32 v172, 16, v206
  v_and_b32 v173, 0xffff0000, v206
  v_mfma_f32_16x16x32_bf16 v[28:31], v[88:91], v[216:219], v[28:31]
  v_fma_f32 v174, v172, v210, v211
  v_fma_f32 v175, v173, v210, v211
  v_mfma_f32_16x16x32_bf16 v[28:31], v[92:95], v[212:215], v[28:31]
  v_lshlrev_b32 v176, 16, v207
  v_and_b32 v177, 0xffff0000, v207
  v_mfma_f32_16x16x32_bf16 v[24:27], v[84:87], v[216:219], v[24:27]
  ds_write_b128 v7, v[32:35] offset:3072
  v_fma_f32 v178, v176, v210, v211
  v_mfma_f32_16x16x32_bf16 v[24:27], v[88:91], v[212:215], v[24:27]
  v_fma_f32 v179, v177, v210, v211
  v_mfma_f32_16x16x32_bf16 v[20:23], v[84:87], v[212:215], v[20:23]
  ds_write_b128 v7, v[28:31] offset:2048
  s_nop 4
  ds_write_b128 v7, v[24:27] offset:1024
  s_nop 0
  ds_write_b128 v7, v[20:23] offset:0
  s_waitcnt lgkmcnt(0)
  s_barrier
  ds_read_b64 v[52:53], v10 offset:0
  ds_read_b64 v[54:55], v10 offset:8192
  ds_read_b64 v[56:57], v10 offset:16384
  ds_read_b64 v[58:59], v10 offset:24576
  ds_read_b64 v[60:61], v10 offset:2048
  ds_read_b64 v[62:63], v10 offset:10240
  ds_read_b64 v[64:65], v10 offset:18432
  ds_read_b64 v[66:67], v10 offset:26624
  ds_read_b64 v[68:69], v10 offset:4096
  ds_read_b64 v[70:71], v10 offset:12288
  ds_read_b64 v[72:73], v10 offset:20480
  ds_read_b64 v[74:75], v10 offset:28672
  ds_read_b64 v[76:77], v10 offset:6144
  ds_read_b64 v[78:79], v10 offset:14336
  ds_read_b64 v[80:81], v10 offset:22528
  ds_read_b64 v[82:83], v10 offset:30720
  s_waitcnt lgkmcnt(15)
  v_fmac_f32 v116, v118, v52
  s_waitcnt lgkmcnt(14)
  v_fmac_f32 v117, v119, v54
  v_cvt_pk_bf16_f32 v20, v116, v117
  s_waitcnt lgkmcnt(13)
  v_fmac_f32 v120, v122, v56
  s_waitcnt lgkmcnt(12)
  v_fmac_f32 v121, v123, v58
  v_cvt_pk_bf16_f32 v21, v120, v121
  v_fmac_f32 v124, v126, v53
  v_fmac_f32 v125, v127, v55
  v_cvt_pk_bf16_f32 v22, v124, v125
  v_fmac_f32 v128, v130, v57
  v_fmac_f32 v129, v131, v59
  v_cvt_pk_bf16_f32 v23, v128, v129
  s_add_u32 s40, s19, 0
  buffer_store_dwordx4 v[20:23], v4, s[36:39], s40 offen sc1
  s_waitcnt lgkmcnt(11)
  v_fmac_f32 v132, v134, v60
  s_waitcnt lgkmcnt(10)
  v_fmac_f32 v133, v135, v62
  v_cvt_pk_bf16_f32 v24, v132, v133
  s_waitcnt lgkmcnt(9)
  v_fmac_f32 v136, v138, v64
  s_waitcnt lgkmcnt(8)
  v_fmac_f32 v137, v139, v66
  v_cvt_pk_bf16_f32 v25, v136, v137
  v_fmac_f32 v140, v142, v61
  v_fmac_f32 v141, v143, v63
  v_cvt_pk_bf16_f32 v26, v140, v141
  v_fmac_f32 v144, v146, v65
  v_fmac_f32 v145, v147, v67
  v_cvt_pk_bf16_f32 v27, v144, v145
cv_hop12:
  s_cbranch_execz cv_hopret
  s_add_u32 s40, s19, 4096
  buffer_store_dwordx4 v[24:27], v4, s[36:39], s40 offen sc1
  s_waitcnt lgkmcnt(7)
  v_fmac_f32 v148, v150, v68
  s_waitcnt lgkmcnt(6)
  v_fmac_f32 v149, v151, v70
  v_cvt_pk_bf16_f32 v28, v148, v149
  s_waitcnt lgkmcnt(5)
  v_fmac_f32 v152, v154, v72
  s_waitcnt lgkmcnt(4)
  v_fmac_f32 v153, v155, v74
  v_cvt_pk_bf16_f32 v29, v152, v153
  v_fmac_f32 v156, v158, v69
  v_fmac_f32 v157, v159, v71
  v_cvt_pk_bf16_f32 v30, v156, v157
  v_fmac_f32 v160, v162, v73
  v_fmac_f32 v161, v163, v75
  v_cvt_pk_bf16_f32 v31, v160, v161
  s_add_u32 s40, s19, 8192
  buffer_store_dwordx4 v[28:31], v4, s[36:39], s40 offen sc1
  s_waitcnt lgkmcnt(3)
  v_fmac_f32 v164, v166, v76
  s_waitcnt lgkmcnt(2)
  v_fmac_f32 v165, v167, v78
  v_cvt_pk_bf16_f32 v32, v164, v165
  s_waitcnt lgkmcnt(1)
  v_fmac_f32 v168, v170, v80
  s_waitcnt lgkmcnt(0)
  v_fmac_f32 v169, v171, v82
  v_cvt_pk_bf16_f32 v33, v168, v169
  v_fmac_f32 v172, v174, v77
  v_fmac_f32 v173, v175, v79
  v_cvt_pk_bf16_f32 v34, v172, v173
  v_fmac_f32 v176, v178, v81
  v_fmac_f32 v177, v179, v83
  v_cvt_pk_bf16_f32 v35, v176, v177
  s_add_u32 s40, s19, 12288
  buffer_store_dwordx4 v[32:35], v4, s[36:39], s40 offen sc1
  s_endpgm
cv_hopret:
  s_setpc_b64 s[90:91]
pre_wln:
  s_mov_b32 s87, 0x40000
pre_wls:
  buffer_load_dword v245, v244, s[52:55], 0 offen sc1
  s_sub_u32 s87, s87, 1
  s_cbranch_scc1 pre_wlb
  s_waitcnt vmcnt(0)
  v_cmp_ne_u32 vcc, s50, v245
  s_cbranch_vccnz pre_wls
  s_branch pre_wlb
pre_wl2:
  s_mov_b32 s87, 0x400000
pre_wl2s:
  ds_read_b32 v245, v14 offset:16
  s_sub_u32 s87, s87, 1
  s_cbranch_scc1 pre_wl2b
  s_waitcnt lgkmcnt(0)
  v_cmp_ne_u32 vcc, 4, v245
  s_cbranch_vccnz pre_wl2s
  s_branch pre_wl2b
.section .rodata,"a"
.p2align 6
.amdhsa_kernel pre_kernel
  .amdhsa_next_free_vgpr 248
  .amdhsa_next_free_sgpr 96
  .amdhsa_accum_offset 248
  .amdhsa_group_segment_fixed_size 0
  .amdhsa_kernarg_size 104
  .amdhsa_user_sgpr_count 2
  .amdhsa_user_sgpr_kernarg_segment_ptr 1
  .amdhsa_system_sgpr_workgroup_id_x 1
  .amdhsa_float_denorm_mode_32 3
.end_amdhsa_kernel
.text
.p2align 8
ffn_kernel:
  s_load_dwordx4 s[4:7], s[0:1], 56
  s_load_dwordx2 s[14:15], s[0:1], 96
  s_load_dwordx2 s[8:9], s[0:1], 72
  ffn_hopq0:
  s_cbranch_execz ffn_hop0
  s_cmp_ge_u32 s2, 256
  s_cbranch_scc1 ffn_end
  s_branch ffn_body
.p2align 9
ffn_body:
ffn_hop0:
  s_cbranch_execz ffn_hop1
  v_lshrrev_b32 v16, 6, v0
  v_and_b32 v17, 63, v0
  v_readfirstlane_b32 s16, v16
  s_and_b32 s18, s2, 7
  s_bfe_u32 s17, s2, 0x10003
  s_lshr_b32 s19, s2, 4
  s_mul_i32 s64, s16, 38944
  v_lshrrev_b32 v22, 4, v17
  v_and_b32 v23, 15, v17
  s_lshl_b32 s3, s19, 2
  s_add_u32 s3, s3, s16
  s_lshl_b32 s3, s3, 8
  v_lshlrev_b32 v24, 14, v22
  v_lshl_add_u32 v24, v23, 4, v24
  v_add_u32 v8, s3, v24
  v_bfe_u32 v18, v17, 3, 1
  v_lshl_add_u32 v18, v22, 3, v18
  s_lshl_b32 s3, s16, 1
  v_add_u32 v18, s3, v18
  v_and_b32 v19, 7, v17
  v_lshlrev_b32 v19, 4, v19
  v_add_u32 v19, 4096, v19
  v_mul_u32_u24 v20, 9216, v18
  v_add_u32 v5, v19, v20
  v_add_u32 v6, -1920, v5
  v_and_b32 v19, 3, v17
  s_mul_i32 s65, s18, 1152
  s_mul_i32 s3, s17, 640
  s_add_u32 s65, s65, s3
  s_waitcnt lgkmcnt(0)
  s_add_u32 s40, s14, 7077888
  s_addc_u32 s41, s15, 0
  s_mov_b32 s42, 2359296
  s_mov_b32 s43, 0x20000
  s_mov_b32 s73, 0
  buffer_load_dwordx4 v[208:211], v8, s[40:43], s73 offen
  s_mov_b32 s73, 65536
  buffer_load_dwordx4 v[212:215], v8, s[40:43], s73 offen
  s_sub_u32 s20, s4, 4096
  s_subb_u32 s21, s5, 0
  s_mov_b32 s22, 5312512
  s_mov_b32 s23, 0x20000
  s_sub_u32 s24, s6, 5120
  s_subb_u32 s25, s7, 0
  s_mov_b32 s26, 5313536
  s_mov_b32 s27, 0x20000
  s_add_u32 s72, s65, 0
  s_add_u32 m0, s64, 0
  s_nop 0
  buffer_load_dwordx4 v5, s[20:23], s72 offen offset:0 lds
  buffer_load_dwordx4 v5, s[24:27], s72 offen offset:1024 lds
  buffer_load_dwordx4 v6, s[20:23], s72 offen offset:2048 lds
  buffer_load_dwordx4 v6, s[24:27], s72 offen offset:3072 lds
  v_bfe_u32 v20, v17, 3, 2
  v_mul_u32_u24 v20, 38944, v20
  v_lshrrev_b32 v21, 5, v17
  v_lshlrev_b32 v21, 8, v21
  v_lshl_add_u32 v21, v19, 3, v21
  v_add_u32 v20, v20, v21
  v_bfe_u32 v27, v17, 2, 1
  v_lshl_add_u32 v1, v27, 7, v20
  v_mov_b32 v64, 0x3f803f80
  v_mov_b32 v65, 0x3f803f80
  v_mov_b32 v66, 0x3f803f80
  v_mov_b32 v67, 0x3f803f80
  v_mov_b32 v68, v17
  v_mov_b32 v69, v18
  v_mov_b32 v70, v21
  s_mov_b32 s73, 131072
  buffer_load_dwordx4 v[216:219], v8, s[40:43], s73 offen
  s_mov_b32 s73, 196608
  buffer_load_dwordx4 v[220:223], v8, s[40:43], s73 offen
  s_add_u32 s72, s65, 294912
  s_add_u32 m0, s64, 4096
  s_nop 0
  buffer_load_dwordx4 v5, s[20:23], s72 offen offset:0 lds
  buffer_load_dwordx4 v5, s[24:27], s72 offen offset:1024 lds
  buffer_load_dwordx4 v6, s[20:23], s72 offen offset:2048 lds
  buffer_load_dwordx4 v6, s[24:27], s72 offen offset:3072 lds
  s_mov_b32 s73, 262144
  buffer_load_dwordx4 v[224:227], v8, s[40:43], s73 offen
ffn_hop1:
  s_cbranch_execz ffn_hop2
  s_mov_b32 s73, 327680
  buffer_load_dwordx4 v[228:231], v8, s[40:43], s73 offen
  s_mov_b32 s73, 393216
  buffer_load_dwordx4 v[232:235], v8, s[40:43], s73 offen
  s_mov_b32 s73, 458752
  buffer_load_dwordx4 v[236:239], v8, s[40:43], s73 offen
  s_waitcnt vmcnt(15)
  v_accvgpr_write_b32 a0, v208
  v_accvgpr_write_b32 a1, v209
  v_accvgpr_write_b32 a4, v210
  v_accvgpr_write_b32 a5, v211
  s_waitcnt vmcnt(14)
  v_accvgpr_write_b32 a2, v212
  v_accvgpr_write_b32 a3, v213
  v_accvgpr_write_b32 a6, v214
  v_accvgpr_write_b32 a7, v215
  s_waitcnt vmcnt(10)
  s_barrier
  ds_read_b64_tr_b16 v[16:17], v1 offset:0
  ds_read_b64_tr_b16 v[18:19], v1 offset:512
  ds_read_b64_tr_b16 v[20:21], v1 offset:32
  ds_read_b64_tr_b16 v[22:23], v1 offset:544
  ds_read_b64_tr_b16 v[24:25], v1 offset:64
  ds_read_b64_tr_b16 v[26:27], v1 offset:576
  ds_read_b64_tr_b16 v[28:29], v1 offset:96
  ds_read_b64_tr_b16 v[30:31], v1 offset:608
  ds_read_b64_tr_b16 v[32:33], v1 offset:1024
  ds_read_b64_tr_b16 v[34:35], v1 offset:1536
  ds_read_b64_tr_b16 v[36:37], v1 offset:1056
  ds_read_b64_tr_b16 v[38:39], v1 offset:1568
  ds_read_b64_tr_b16 v[40:41], v1 offset:1088
  ds_read_b64_tr_b16 v[42:43], v1 offset:1600
  s_waitcnt lgkmcnt(6)
  v_mfma_f32_16x16x32_bf16 v[80:83], v[16:19], a[0:3], 0
  ds_read_b64_tr_b16 v[44:45], v1 offset:1120
  s_add_u32 s72, s65, 589824
  v_mfma_f32_16x16x32_bf16 v[84:87], v[16:19], a[4:7], 0
  ds_read_b64_tr_b16 v[46:47], v1 offset:1632
  s_add_u32 m0, s64, 8192
  v_mfma_f32_16x16x32_bf16 v[120:123], v[20:23], a[0:3], 0
  ds_read_b64_tr_b16 v[16:17], v1 offset:2048
  s_mov_b32 s73, 524288
  v_mfma_f32_16x16x32_bf16 v[128:131], v[20:23], a[4:7], 0
  buffer_load_dwordx4 v5, s[20:23], s72 offen offset:0 lds
  buffer_load_dwordx4 v[240:243], v8, s[40:43], s73 offen
  v_mfma_f32_16x16x32_bf16 v[88:91], v[24:27], a[0:3], 0
  ds_read_b64_tr_b16 v[18:19], v1 offset:2560
  ds_read_b64_tr_b16 v[20:21], v1 offset:2080
  s_mov_b32 s73, 589824
  s_waitcnt vmcnt(10)
  v_mfma_f32_16x16x32_bf16 v[92:95], v[24:27], a[4:7], 0
  buffer_load_dwordx4 v5, s[24:27], s72 offen offset:1024 lds
  buffer_load_dwordx4 v[244:247], v8, s[40:43], s73 offen
  v_accvgpr_write_b32 a8, v216
  v_mfma_f32_16x16x32_bf16 v[144:147], v[28:31], a[0:3], 0
  ds_read_b64_tr_b16 v[22:23], v1 offset:2592
  ds_read_b64_tr_b16 v[24:25], v1 offset:2112
  v_accvgpr_write_b32 a9, v217
  v_mfma_f32_16x16x32_bf16 v[152:155], v[28:31], a[4:7], 0
  buffer_load_dwordx4 v6, s[20:23], s72 offen offset:2048 lds
  s_mov_b32 s73, 655360
  v_accvgpr_write_b32 a12, v218
  v_mfma_f32_16x16x32_bf16 v[60:63], a[4:7], a[4:7], 0
  ds_read_b64_tr_b16 v[26:27], v1 offset:2624
  buffer_load_dwordx4 v[248:251], v8, s[40:43], s73 offen
  v_accvgpr_write_b32 a13, v219
  s_waitcnt lgkmcnt(6)
  v_mfma_f32_16x16x32_bf16 v[112:115], v[32:35], a[0:3], 0
  buffer_load_dwordx4 v6, s[24:27], s72 offen offset:3072 lds
  s_mov_b32 s73, 720896
  v_accvgpr_write_b32 a10, v220
ffn_hop2:
  s_cbranch_execz ffn_hop3
  v_mfma_f32_16x16x32_bf16 v[116:119], v[32:35], a[4:7], 0
  ds_read_b64_tr_b16 v[28:29], v1 offset:2144
  ds_read_b64_tr_b16 v[30:31], v1 offset:2656
  buffer_load_dwordx4 v[252:255], v8, s[40:43], s73 offen
  v_accvgpr_write_b32 a11, v221
  v_mfma_f32_16x16x32_bf16 v[124:127], v[36:39], a[0:3], 0
  ds_read_b64_tr_b16 v[32:33], v1 offset:3072
  s_add_u32 s72, s65, 884736
  v_accvgpr_write_b32 a14, v222
  v_mfma_f32_16x16x32_bf16 v[132:135], v[36:39], a[4:7], 0
  ds_read_b64_tr_b16 v[34:35], v1 offset:3584
  s_add_u32 m0, s64, 12288
  v_mfma_f32_16x16x32_bf16 v[136:139], v[40:43], a[0:3], 0
  buffer_load_dwordx4 v5, s[20:23], s72 offen offset:0 lds
  v_mfma_f32_16x16x32_bf16 v[140:143], v[40:43], a[4:7], 0
  ds_read_b64_tr_b16 v[36:37], v1 offset:3104
  ds_read_b64_tr_b16 v[38:39], v1 offset:3616
  v_mfma_f32_16x16x32_bf16 v[148:151], v[44:47], a[0:3], 0
  buffer_load_dwordx4 v5, s[24:27], s72 offen offset:1024 lds
  v_mfma_f32_16x16x32_bf16 v[156:159], v[44:47], a[4:7], 0
  ds_read_b64_tr_b16 v[40:41], v1 offset:3136
  ds_read_b64_tr_b16 v[42:43], v1 offset:3648
  v_mfma_f32_16x16x32_bf16 v[56:59], v[64:67], a[4:7], 0
  v_accvgpr_write_b32 a15, v223
  s_waitcnt lgkmcnt(6)
  v_mfma_f32_16x16x32_bf16 v[96:99], v[16:19], a[0:3], 0
  buffer_load_dwordx4 v6, s[20:23], s72 offen offset:2048 lds
  v_mfma_f32_16x16x32_bf16 v[100:103], v[16:19], a[4:7], 0
  ds_read_b64_tr_b16 v[44:45], v1 offset:3168
  ds_read_b64_tr_b16 v[46:47], v1 offset:3680
  v_mfma_f32_16x16x32_bf16 v[168:171], v[20:23], a[0:3], 0
  s_waitcnt vmcnt(15)
  s_barrier
  ds_read_b64_tr_b16 v[16:17], v1 offset:4096
  v_mfma_f32_16x16x32_bf16 v[176:179], v[20:23], a[4:7], 0
  buffer_load_dwordx4 v6, s[24:27], s72 offen offset:3072 lds
  v_mfma_f32_16x16x32_bf16 v[104:107], v[24:27], a[0:3], 0
  ds_read_b64_tr_b16 v[18:19], v1 offset:4608
  ds_read_b64_tr_b16 v[20:21], v1 offset:4128
  v_mfma_f32_16x16x32_bf16 v[108:111], v[24:27], a[4:7], 0
  ds_read_b64_tr_b16 v[22:23], v1 offset:4640
  s_add_u32 s72, s65, 1179648
  v_mfma_f32_16x16x32_bf16 v[192:195], v[28:31], a[0:3], 0
  ds_read_b64_tr_b16 v[24:25], v1 offset:4160
  s_add_u32 m0, s64, 16384
  v_mfma_f32_16x16x32_bf16 v[200:203], v[28:31], a[4:7], 0
  s_add_u32 s44, s14, 9437184
  s_addc_u32 s45, s15, 0
  v_mfma_f32_16x16x32_bf16 v[52:55], a[0:3], a[0:3], 0
  ds_read_b64_tr_b16 v[26:27], v1 offset:4672
  s_waitcnt lgkmcnt(6)
  v_mfma_f32_16x16x32_bf16 v[160:163], v[32:35], a[0:3], 0
  buffer_load_dwordx4 v5, s[20:23], s72 offen offset:0 lds
  v_mfma_f32_16x16x32_bf16 v[164:167], v[32:35], a[4:7], 0
  ds_read_b64_tr_b16 v[28:29], v1 offset:4192
  ds_read_b64_tr_b16 v[30:31], v1 offset:4704
  v_mfma_f32_16x16x32_bf16 v[172:175], v[36:39], a[0:3], 0
  buffer_load_dwordx4 v5, s[24:27], s72 offen offset:1024 lds
  v_mfma_f32_16x16x32_bf16 v[180:183], v[36:39], a[4:7], 0
  ds_read_b64_tr_b16 v[32:33], v1 offset:5120
  ds_read_b64_tr_b16 v[34:35], v1 offset:5632
  v_mfma_f32_16x16x32_bf16 v[184:187], v[40:43], a[0:3], 0
  ds_read_b64_tr_b16 v[36:37], v1 offset:5152
  s_mov_b32 s46, 73728
  v_mfma_f32_16x16x32_bf16 v[188:191], v[40:43], a[4:7], 0
  buffer_load_dwordx4 v6, s[20:23], s72 offen offset:2048 lds
ffn_hop3:
  s_cbranch_execz ffn_hop4
  v_mfma_f32_16x16x32_bf16 v[196:199], v[44:47], a[0:3], 0
  ds_read_b64_tr_b16 v[38:39], v1 offset:5664
  ds_read_b64_tr_b16 v[40:41], v1 offset:5184
  v_mfma_f32_16x16x32_bf16 v[204:207], v[44:47], a[4:7], 0
  buffer_load_dwordx4 v6, s[24:27], s72 offen offset:3072 lds
  v_mfma_f32_16x16x32_bf16 v[48:51], v[64:67], a[0:3], 0
  ds_read_b64_tr_b16 v[42:43], v1 offset:5696
  s_waitcnt lgkmcnt(6)
  v_mfma_f32_16x16x32_bf16 v[80:83], v[16:19], a[8:11], v[80:83]
  ds_read_b64_tr_b16 v[44:45], v1 offset:5216
  s_mov_b32 s73, 786432
  v_mfma_f32_16x16x32_bf16 v[84:87], v[16:19], a[12:15], v[84:87]
  ds_read_b64_tr_b16 v[46:47], v1 offset:5728
  s_add_u32 s72, s65, 1474560
  v_mfma_f32_16x16x32_bf16 v[120:123], v[20:23], a[8:11], v[120:123]
  buffer_load_dwordx4 v[208:211], v8, s[40:43], s73 offen
  v_mfma_f32_16x16x32_bf16 v[128:131], v[20:23], a[12:15], v[128:131]
  ds_read_b64_tr_b16 v[16:17], v1 offset:6144
  ds_read_b64_tr_b16 v[18:19], v1 offset:6656
  v_mfma_f32_16x16x32_bf16 v[88:91], v[24:27], a[8:11], v[88:91]
  ds_read_b64_tr_b16 v[20:21], v1 offset:6176
  s_add_u32 m0, s64, 20480
  s_waitcnt vmcnt(19)
  v_mfma_f32_16x16x32_bf16 v[92:95], v[24:27], a[12:15], v[92:95]
  ds_read_b64_tr_b16 v[22:23], v1 offset:6688
  s_mov_b32 s73, 851968
  v_accvgpr_write_b32 a16, v224
  v_mfma_f32_16x16x32_bf16 v[144:147], v[28:31], a[8:11], v[144:147]
  ds_read_b64_tr_b16 v[24:25], v1 offset:6208
  buffer_load_dwordx4 v[212:215], v8, s[40:43], s73 offen
  v_mfma_f32_16x16x32_bf16 v[152:155], v[28:31], a[12:15], v[152:155]
  buffer_load_dwordx4 v5, s[20:23], s72 offen offset:0 lds
  v_mfma_f32_16x16x32_bf16 v[60:63], a[12:15], a[12:15], v[60:63]
  ds_read_b64_tr_b16 v[26:27], v1 offset:6720
  s_waitcnt lgkmcnt(6)
  v_mfma_f32_16x16x32_bf16 v[112:115], v[32:35], a[8:11], v[112:115]
  buffer_load_dwordx4 v5, s[24:27], s72 offen offset:1024 lds
  v_mfma_f32_16x16x32_bf16 v[116:119], v[32:35], a[12:15], v[116:119]
  ds_read_b64_tr_b16 v[28:29], v1 offset:6240
  ds_read_b64_tr_b16 v[30:31], v1 offset:6752
  v_mfma_f32_16x16x32_bf16 v[124:127], v[36:39], a[8:11], v[124:127]
  ds_read_b64_tr_b16 v[32:33], v1 offset:7168
  v_accvgpr_write_b32 a17, v225
  v_mfma_f32_16x16x32_bf16 v[132:135], v[36:39], a[12:15], v[132:135]
  buffer_load_dwordx4 v6, s[20:23], s72 offen offset:2048 lds
  v_mfma_f32_16x16x32_bf16 v[136:139], v[40:43], a[8:11], v[136:139]
  ds_read_b64_tr_b16 v[34:35], v1 offset:7680
  ds_read_b64_tr_b16 v[36:37], v1 offset:7200
  v_mfma_f32_16x16x32_bf16 v[140:143], v[40:43], a[12:15], v[140:143]
  ds_read_b64_tr_b16 v[38:39], v1 offset:7712
  v_accvgpr_write_b32 a20, v226
  v_mfma_f32_16x16x32_bf16 v[148:151], v[44:47], a[8:11], v[148:151]
  buffer_load_dwordx4 v6, s[24:27], s72 offen offset:3072 lds
  v_mfma_f32_16x16x32_bf16 v[156:159], v[44:47], a[12:15], v[156:159]
  ds_read_b64_tr_b16 v[40:41], v1 offset:7232
  ds_read_b64_tr_b16 v[42:43], v1 offset:7744
  v_mfma_f32_16x16x32_bf16 v[56:59], v[64:67], a[12:15], v[56:59]
  v_accvgpr_write_b32 a21, v227
  s_waitcnt lgkmcnt(6)
  v_mfma_f32_16x16x32_bf16 v[96:99], v[16:19], a[8:11], v[96:99]
  ds_read_b64_tr_b16 v[44:45], v1 offset:7264
ffn_hop4:
  s_cbranch_execz ffn_hop5
  v_accvgpr_write_b32 a18, v228
  v_mfma_f32_16x16x32_bf16 v[100:103], v[16:19], a[12:15], v[100:103]
  ds_read_b64_tr_b16 v[46:47], v1 offset:7776
  v_accvgpr_write_b32 a19, v229
  v_mfma_f32_16x16x32_bf16 v[168:171], v[20:23], a[8:11], v[168:171]
  s_waitcnt vmcnt(10)
  s_barrier
  ds_read_b64_tr_b16 v[16:17], v1 offset:8192
  v_mfma_f32_16x16x32_bf16 v[176:179], v[20:23], a[12:15], v[176:179]
  ds_read_b64_tr_b16 v[18:19], v1 offset:8704
  s_add_u32 s72, s65, 1769472
  v_mfma_f32_16x16x32_bf16 v[104:107], v[24:27], a[8:11], v[104:107]
  ds_read_b64_tr_b16 v[20:21], v1 offset:8224
  v_accvgpr_write_b32 a22, v230
  v_mfma_f32_16x16x32_bf16 v[108:111], v[24:27], a[12:15], v[108:111]
  ds_read_b64_tr_b16 v[22:23], v1 offset:8736
  v_accvgpr_write_b32 a23, v231
  v_mfma_f32_16x16x32_bf16 v[192:195], v[28:31], a[8:11], v[192:195]
  ds_read_b64_tr_b16 v[24:25], v1 offset:8256
  s_mov_b32 s47, 0x20000
  v_mfma_f32_16x16x32_bf16 v[200:203], v[28:31], a[12:15], v[200:203]
  ds_read_b64_tr_b16 v[26:27], v1 offset:8768
  s_lshr_b32 s10, s16, 1
  v_mfma_f32_16x16x32_bf16 v[52:55], a[8:11], a[8:11], v[52:55]
  s_add_u32 m0, s64, 24576
  s_waitcnt lgkmcnt(6)
  v_mfma_f32_16x16x32_bf16 v[160:163], v[32:35], a[8:11], v[160:163]
  ds_read_b64_tr_b16 v[28:29], v1 offset:8288
  s_mul_i32 s10, s10, 18432
  v_mfma_f32_16x16x32_bf16 v[164:167], v[32:35], a[12:15], v[164:167]
  ds_read_b64_tr_b16 v[30:31], v1 offset:8800
  s_and_b32 s11, s16, 1
  v_mfma_f32_16x16x32_bf16 v[172:175], v[36:39], a[8:11], v[172:175]
  ds_read_b64_tr_b16 v[32:33], v1 offset:9216
  s_lshl_b32 s11, s11, 10
  v_mfma_f32_16x16x32_bf16 v[180:183], v[36:39], a[12:15], v[180:183]
  ds_read_b64_tr_b16 v[34:35], v1 offset:9728
  s_add_u32 s10, s10, s11
  v_mfma_f32_16x16x32_bf16 v[184:187], v[40:43], a[8:11], v[184:187]
  ds_read_b64_tr_b16 v[36:37], v1 offset:9248
  s_lshl_b32 s11, s18, 1
  v_mfma_f32_16x16x32_bf16 v[188:191], v[40:43], a[12:15], v[188:191]
  buffer_load_dwordx4 v5, s[20:23], s72 offen offset:0 lds
  v_mfma_f32_16x16x32_bf16 v[196:199], v[44:47], a[8:11], v[196:199]
  ds_read_b64_tr_b16 v[38:39], v1 offset:9760
  ds_read_b64_tr_b16 v[40:41], v1 offset:9280
  v_mfma_f32_16x16x32_bf16 v[204:207], v[44:47], a[12:15], v[204:207]
  ds_read_b64_tr_b16 v[42:43], v1 offset:9792
  s_add_u32 s11, s11, s17
  v_mfma_f32_16x16x32_bf16 v[48:51], v[64:67], a[8:11], v[48:51]
  s_mul_i32 s11, s11, 1152
  s_waitcnt lgkmcnt(6)
  v_mfma_f32_16x16x32_bf16 v[80:83], v[16:19], a[16:19], v[80:83]
  ds_read_b64_tr_b16 v[44:45], v1 offset:9312
  s_mov_b32 s73, 917504
  v_mfma_f32_16x16x32_bf16 v[84:87], v[16:19], a[20:23], v[84:87]
  ds_read_b64_tr_b16 v[46:47], v1 offset:9824
  s_add_u32 s10, s10, s11
  v_mfma_f32_16x16x32_bf16 v[120:123], v[20:23], a[16:19], v[120:123]
  buffer_load_dwordx4 v5, s[24:27], s72 offen offset:1024 lds
  v_mfma_f32_16x16x32_bf16 v[128:131], v[20:23], a[20:23], v[128:131]
  ds_read_b64_tr_b16 v[16:17], v1 offset:10240
  ds_read_b64_tr_b16 v[18:19], v1 offset:10752
  v_mfma_f32_16x16x32_bf16 v[88:91], v[24:27], a[16:19], v[88:91]
  buffer_load_dwordx4 v[216:219], v8, s[40:43], s73 offen
  v_mfma_f32_16x16x32_bf16 v[92:95], v[24:27], a[20:23], v[92:95]
  ds_read_b64_tr_b16 v[20:21], v1 offset:10272
  ds_read_b64_tr_b16 v[22:23], v1 offset:10784
  v_accvgpr_write_b32 a24, v232
ffn_hop5:
  s_cbranch_execz ffn_hop6
  v_mfma_f32_16x16x32_bf16 v[144:147], v[28:31], a[16:19], v[144:147]
  ds_read_b64_tr_b16 v[24:25], v1 offset:10304
  s_mov_b32 s73, 983040
  v_mfma_f32_16x16x32_bf16 v[152:155], v[28:31], a[20:23], v[152:155]
  buffer_load_dwordx4 v[220:223], v8, s[40:43], s73 offen
  v_mfma_f32_16x16x32_bf16 v[60:63], a[20:23], a[20:23], v[60:63]
  ds_read_b64_tr_b16 v[26:27], v1 offset:10816
  s_waitcnt lgkmcnt(6)
  v_mfma_f32_16x16x32_bf16 v[112:115], v[32:35], a[16:19], v[112:115]
  buffer_load_dwordx4 v6, s[20:23], s72 offen offset:2048 lds
  v_mfma_f32_16x16x32_bf16 v[116:119], v[32:35], a[20:23], v[116:119]
  ds_read_b64_tr_b16 v[28:29], v1 offset:10336
  ds_read_b64_tr_b16 v[30:31], v1 offset:10848
  v_mfma_f32_16x16x32_bf16 v[124:127], v[36:39], a[16:19], v[124:127]
  ds_read_b64_tr_b16 v[32:33], v1 offset:11264
  v_accvgpr_write_b32 a25, v233
  v_mfma_f32_16x16x32_bf16 v[132:135], v[36:39], a[20:23], v[132:135]
  ds_read_b64_tr_b16 v[34:35], v1 offset:11776
  v_accvgpr_write_b32 a28, v234
  v_mfma_f32_16x16x32_bf16 v[136:139], v[40:43], a[16:19], v[136:139]
  buffer_load_dwordx4 v6, s[24:27], s72 offen offset:3072 lds
  v_mfma_f32_16x16x32_bf16 v[140:143], v[40:43], a[20:23], v[140:143]
  ds_read_b64_tr_b16 v[36:37], v1 offset:11296
  ds_read_b64_tr_b16 v[38:39], v1 offset:11808
  v_mfma_f32_16x16x32_bf16 v[148:151], v[44:47], a[16:19], v[148:151]
  ds_read_b64_tr_b16 v[40:41], v1 offset:11328
  v_accvgpr_write_b32 a29, v235
  v_mfma_f32_16x16x32_bf16 v[156:159], v[44:47], a[20:23], v[156:159]
  ds_read_b64_tr_b16 v[42:43], v1 offset:11840
  v_accvgpr_write_b32 a26, v236
  v_mfma_f32_16x16x32_bf16 v[56:59], v[64:67], a[20:23], v[56:59]
  v_accvgpr_write_b32 a27, v237
  s_waitcnt lgkmcnt(6)
  v_mfma_f32_16x16x32_bf16 v[96:99], v[16:19], a[16:19], v[96:99]
  ds_read_b64_tr_b16 v[44:45], v1 offset:11360
  v_accvgpr_write_b32 a30, v238
  v_mfma_f32_16x16x32_bf16 v[100:103], v[16:19], a[20:23], v[100:103]
  ds_read_b64_tr_b16 v[46:47], v1 offset:11872
  s_add_u32 s72, s65, 2064384
  v_mfma_f32_16x16x32_bf16 v[168:171], v[20:23], a[16:19], v[168:171]
  ds_read_b64_tr_b16 v[16:17], v1 offset:12288
  v_accvgpr_write_b32 a31, v239
  v_mfma_f32_16x16x32_bf16 v[176:179], v[20:23], a[20:23], v[176:179]
  ds_read_b64_tr_b16 v[18:19], v1 offset:12800
  v_lshlrev_b32 v9, 4, v68
  v_mfma_f32_16x16x32_bf16 v[104:107], v[24:27], a[16:19], v[104:107]
  buffer_load_dwordx4 v[72:75], v9, s[44:47], s10 offen
  v_mfma_f32_16x16x32_bf16 v[108:111], v[24:27], a[20:23], v[108:111]
  ds_read_b64_tr_b16 v[20:21], v1 offset:12320
  ds_read_b64_tr_b16 v[22:23], v1 offset:12832
  v_mfma_f32_16x16x32_bf16 v[192:195], v[28:31], a[16:19], v[192:195]
  ds_read_b64_tr_b16 v[24:25], v1 offset:12352
  s_add_u32 s10, s10, 36864
  v_mfma_f32_16x16x32_bf16 v[200:203], v[28:31], a[20:23], v[200:203]
  ds_read_b64_tr_b16 v[26:27], v1 offset:12864
  s_add_u32 m0, s64, 28672
  v_mfma_f32_16x16x32_bf16 v[52:55], a[16:19], a[16:19], v[52:55]
  buffer_load_dwordx4 v[76:79], v9, s[44:47], s10 offen
  s_waitcnt lgkmcnt(6)
  v_mfma_f32_16x16x32_bf16 v[160:163], v[32:35], a[16:19], v[160:163]
  ds_read_b64_tr_b16 v[28:29], v1 offset:12384
  s_lshl_b32 s11, s16, 10
  v_mfma_f32_16x16x32_bf16 v[164:167], v[32:35], a[20:23], v[164:167]
  ds_read_b64_tr_b16 v[30:31], v1 offset:12896
  s_add_u32 s11, s11, 155776
  v_mfma_f32_16x16x32_bf16 v[172:175], v[36:39], a[16:19], v[172:175]
  ds_read_b64_tr_b16 v[32:33], v1 offset:13312
  v_add_u32 v0, s11, v9
  v_mfma_f32_16x16x32_bf16 v[180:183], v[36:39], a[20:23], v[180:183]
  ds_read_b64_tr_b16 v[34:35], v1 offset:13824
  s_sub_u32 s32, s8, 4096
ffn_hop6:
  s_cbranch_execz ffn_hop7
  s_subb_u32 s33, s9, 0
  v_mfma_f32_16x16x32_bf16 v[184:187], v[40:43], a[16:19], v[184:187]
  buffer_load_dwordx4 v5, s[20:23], s72 offen offset:0 lds
  v_mfma_f32_16x16x32_bf16 v[188:191], v[40:43], a[20:23], v[188:191]
  ds_read_b64_tr_b16 v[36:37], v1 offset:13344
  ds_read_b64_tr_b16 v[38:39], v1 offset:13856
  v_mfma_f32_16x16x32_bf16 v[196:199], v[44:47], a[16:19], v[196:199]
  ds_read_b64_tr_b16 v[40:41], v1 offset:13376
  s_mov_b32 s34, 5312512
  v_mfma_f32_16x16x32_bf16 v[204:207], v[44:47], a[20:23], v[204:207]
  ds_read_b64_tr_b16 v[42:43], v1 offset:13888
  s_mov_b32 s35, 0x20000
  v_mfma_f32_16x16x32_bf16 v[48:51], v[64:67], a[16:19], v[48:51]
  v_mul_u32_u24 v71, 8064, v69
  s_waitcnt lgkmcnt(6)
  v_mfma_f32_16x16x32_bf16 v[80:83], v[16:19], a[24:27], v[80:83]
  buffer_load_dwordx4 v5, s[24:27], s72 offen offset:1024 lds
  v_mfma_f32_16x16x32_bf16 v[84:87], v[16:19], a[28:31], v[84:87]
  ds_read_b64_tr_b16 v[44:45], v1 offset:13408
  ds_read_b64_tr_b16 v[46:47], v1 offset:13920
  v_mfma_f32_16x16x32_bf16 v[120:123], v[20:23], a[24:27], v[120:123]
  ds_read_b64_tr_b16 v[16:17], v1 offset:14336
  s_mov_b32 s73, 1048576
  v_mfma_f32_16x16x32_bf16 v[128:131], v[20:23], a[28:31], v[128:131]
  buffer_load_dwordx4 v[224:227], v8, s[40:43], s73 offen
  v_mfma_f32_16x16x32_bf16 v[88:91], v[24:27], a[24:27], v[88:91]
  ds_read_b64_tr_b16 v[18:19], v1 offset:14848
  ds_read_b64_tr_b16 v[20:21], v1 offset:14368
  v_mfma_f32_16x16x32_bf16 v[92:95], v[24:27], a[28:31], v[92:95]
  ds_read_b64_tr_b16 v[22:23], v1 offset:14880
  s_mov_b32 s73, 1114112
  v_mfma_f32_16x16x32_bf16 v[144:147], v[28:31], a[24:27], v[144:147]
  buffer_load_dwordx4 v6, s[20:23], s72 offen offset:2048 lds
  v_mfma_f32_16x16x32_bf16 v[152:155], v[28:31], a[28:31], v[152:155]
  ds_read_b64_tr_b16 v[24:25], v1 offset:14400
  ds_read_b64_tr_b16 v[26:27], v1 offset:14912
  v_mfma_f32_16x16x32_bf16 v[60:63], a[28:31], a[28:31], v[60:63]
  v_accvgpr_write_b32 a32, v240
  s_waitcnt lgkmcnt(6)
  v_mfma_f32_16x16x32_bf16 v[112:115], v[32:35], a[24:27], v[112:115]
  buffer_load_dwordx4 v[228:231], v8, s[40:43], s73 offen
  v_mfma_f32_16x16x32_bf16 v[116:119], v[32:35], a[28:31], v[116:119]
  ds_read_b64_tr_b16 v[28:29], v1 offset:14432
  ds_read_b64_tr_b16 v[30:31], v1 offset:14944
  v_mfma_f32_16x16x32_bf16 v[124:127], v[36:39], a[24:27], v[124:127]
  ds_read_b64_tr_b16 v[32:33], v1 offset:15360
  v_accvgpr_write_b32 a33, v241
  v_mfma_f32_16x16x32_bf16 v[132:135], v[36:39], a[28:31], v[132:135]
  buffer_load_dwordx4 v6, s[24:27], s72 offen offset:3072 lds
  v_mfma_f32_16x16x32_bf16 v[136:139], v[40:43], a[24:27], v[136:139]
  ds_read_b64_tr_b16 v[34:35], v1 offset:15872
  ds_read_b64_tr_b16 v[36:37], v1 offset:15392
  v_mfma_f32_16x16x32_bf16 v[140:143], v[40:43], a[28:31], v[140:143]
  ds_read_b64_tr_b16 v[38:39], v1 offset:15904
  v_accvgpr_write_b32 a36, v242
  v_mfma_f32_16x16x32_bf16 v[148:151], v[44:47], a[24:27], v[148:151]
  ds_read_b64_tr_b16 v[40:41], v1 offset:15424
  v_accvgpr_write_b32 a37, v243
  v_mfma_f32_16x16x32_bf16 v[156:159], v[44:47], a[28:31], v[156:159]
  ds_read_b64_tr_b16 v[42:43], v1 offset:15936
  v_accvgpr_write_b32 a34, v244
ffn_hop7:
  s_cbranch_execz ffn_hop8
  v_mfma_f32_16x16x32_bf16 v[56:59], v[64:67], a[28:31], v[56:59]
  v_accvgpr_write_b32 a35, v245
  s_waitcnt lgkmcnt(6)
  v_mfma_f32_16x16x32_bf16 v[96:99], v[16:19], a[24:27], v[96:99]
  ds_read_b64_tr_b16 v[44:45], v1 offset:15456
  v_accvgpr_write_b32 a38, v246
  v_mfma_f32_16x16x32_bf16 v[100:103], v[16:19], a[28:31], v[100:103]
  ds_read_b64_tr_b16 v[46:47], v1 offset:15968
  v_accvgpr_write_b32 a39, v247
  v_mfma_f32_16x16x32_bf16 v[168:171], v[20:23], a[24:27], v[168:171]
  s_waitcnt vmcnt(14)
  s_barrier
  ds_read_b64_tr_b16 v[16:17], v1 offset:16384
  v_mfma_f32_16x16x32_bf16 v[176:179], v[20:23], a[28:31], v[176:179]
  ds_read_b64_tr_b16 v[18:19], v1 offset:16896
  s_add_u32 s72, s65, 2359296
  v_mfma_f32_16x16x32_bf16 v[104:107], v[24:27], a[24:27], v[104:107]
  ds_read_b64_tr_b16 v[20:21], v1 offset:16416
  v_sub_u32 v14, v5, v71
  v_mfma_f32_16x16x32_bf16 v[108:111], v[24:27], a[28:31], v[108:111]
  ds_read_b64_tr_b16 v[22:23], v1 offset:16928
  v_bfe_u32 v71, v68, 4, 1
  v_mfma_f32_16x16x32_bf16 v[192:195], v[28:31], a[24:27], v[192:195]
  ds_read_b64_tr_b16 v[24:25], v1 offset:16448
  v_mul_u32_u24 v71, 38944, v71
  v_mfma_f32_16x16x32_bf16 v[200:203], v[28:31], a[28:31], v[200:203]
  ds_read_b64_tr_b16 v[26:27], v1 offset:16960
  v_add_u32 v71, v71, v70
  v_mfma_f32_16x16x32_bf16 v[52:55], a[24:27], a[24:27], v[52:55]
  s_add_u32 m0, s64, 32768
  s_waitcnt lgkmcnt(6)
  v_mfma_f32_16x16x32_bf16 v[160:163], v[32:35], a[24:27], v[160:163]
  ds_read_b64_tr_b16 v[28:29], v1 offset:16480
  v_bfe_u32 v2, v68, 2, 2
  v_mfma_f32_16x16x32_bf16 v[164:167], v[32:35], a[28:31], v[164:167]
  ds_read_b64_tr_b16 v[30:31], v1 offset:16992
  v_lshl_add_u32 v2, v2, 6, v71
  v_mfma_f32_16x16x32_bf16 v[172:175], v[36:39], a[24:27], v[172:175]
  ds_read_b64_tr_b16 v[32:33], v1 offset:17408
  v_add_u32 v3, 77888, v2
  v_mfma_f32_16x16x32_bf16 v[180:183], v[36:39], a[28:31], v[180:183]
  ds_read_b64_tr_b16 v[34:35], v1 offset:17920
  v_bfe_u32 v71, v68, 2, 2
  v_mfma_f32_16x16x32_bf16 v[184:187], v[40:43], a[24:27], v[184:187]
  ds_read_b64_tr_b16 v[36:37], v1 offset:17440
  v_lshrrev_b32 v70, 4, v68
  v_mfma_f32_16x16x32_bf16 v[188:191], v[40:43], a[28:31], v[188:191]
  buffer_load_dwordx4 v5, s[20:23], s72 offen offset:0 lds
  v_mfma_f32_16x16x32_bf16 v[196:199], v[44:47], a[24:27], v[196:199]
  ds_read_b64_tr_b16 v[38:39], v1 offset:17952
  ds_read_b64_tr_b16 v[40:41], v1 offset:17472
  v_mfma_f32_16x16x32_bf16 v[204:207], v[44:47], a[28:31], v[204:207]
  ds_read_b64_tr_b16 v[42:43], v1 offset:17984
  v_lshl_add_u32 v71, v70, 3, v71
  v_mfma_f32_16x16x32_bf16 v[48:51], v[64:67], a[24:27], v[48:51]
  s_and_b32 s3, s16, 1
  s_waitcnt lgkmcnt(6)
  v_mfma_f32_16x16x32_bf16 v[80:83], v[16:19], a[32:35], v[80:83]
  ds_read_b64_tr_b16 v[44:45], v1 offset:17504
  s_mov_b32 s73, 1179648
  v_mfma_f32_16x16x32_bf16 v[84:87], v[16:19], a[36:39], v[84:87]
  ds_read_b64_tr_b16 v[46:47], v1 offset:18016
  s_lshl_b32 s3, s3, 2
  v_mfma_f32_16x16x32_bf16 v[120:123], v[20:23], a[32:35], v[120:123]
  buffer_load_dwordx4 v5, s[24:27], s72 offen offset:1024 lds
  v_mfma_f32_16x16x32_bf16 v[128:131], v[20:23], a[36:39], v[128:131]
  ds_read_b64_tr_b16 v[16:17], v1 offset:18432
  ds_read_b64_tr_b16 v[18:19], v1 offset:18944
ffn_hop8:
  s_cbranch_execz ffn_hop9
  v_mfma_f32_16x16x32_bf16 v[88:91], v[24:27], a[32:35], v[88:91]
  buffer_load_dwordx4 v[232:235], v8, s[40:43], s73 offen
  v_mfma_f32_16x16x32_bf16 v[92:95], v[24:27], a[36:39], v[92:95]
  ds_read_b64_tr_b16 v[20:21], v1 offset:18464
  ds_read_b64_tr_b16 v[22:23], v1 offset:18976
  v_accvgpr_write_b32 a40, v248
  v_mfma_f32_16x16x32_bf16 v[144:147], v[28:31], a[32:35], v[144:147]
  ds_read_b64_tr_b16 v[24:25], v1 offset:18496
  s_mov_b32 s73, 1245184
  v_mfma_f32_16x16x32_bf16 v[152:155], v[28:31], a[36:39], v[152:155]
  buffer_load_dwordx4 v[236:239], v8, s[40:43], s73 offen
  v_mfma_f32_16x16x32_bf16 v[60:63], a[36:39], a[36:39], v[60:63]
  ds_read_b64_tr_b16 v[26:27], v1 offset:19008
  s_waitcnt lgkmcnt(6)
  v_mfma_f32_16x16x32_bf16 v[112:115], v[32:35], a[32:35], v[112:115]
  buffer_load_dwordx4 v6, s[20:23], s72 offen offset:2048 lds
  v_mfma_f32_16x16x32_bf16 v[116:119], v[32:35], a[36:39], v[116:119]
  ds_read_b64_tr_b16 v[28:29], v1 offset:18528
  ds_read_b64_tr_b16 v[30:31], v1 offset:19040
  v_mfma_f32_16x16x32_bf16 v[124:127], v[36:39], a[32:35], v[124:127]
  ds_read_b64_tr_b16 v[32:33], v1 offset:19456
  v_accvgpr_write_b32 a41, v249
  v_mfma_f32_16x16x32_bf16 v[132:135], v[36:39], a[36:39], v[132:135]
  ds_read_b64_tr_b16 v[34:35], v1 offset:19968
  v_accvgpr_write_b32 a44, v250
  v_mfma_f32_16x16x32_bf16 v[136:139], v[40:43], a[32:35], v[136:139]
  buffer_load_dwordx4 v6, s[24:27], s72 offen offset:3072 lds
  v_mfma_f32_16x16x32_bf16 v[140:143], v[40:43], a[36:39], v[140:143]
  ds_read_b64_tr_b16 v[36:37], v1 offset:19488
  ds_read_b64_tr_b16 v[38:39], v1 offset:20000
  v_mfma_f32_16x16x32_bf16 v[148:151], v[44:47], a[32:35], v[148:151]
  ds_read_b64_tr_b16 v[40:41], v1 offset:19520
  v_accvgpr_write_b32 a45, v251
  v_mfma_f32_16x16x32_bf16 v[156:159], v[44:47], a[36:39], v[156:159]
  ds_read_b64_tr_b16 v[42:43], v1 offset:20032
  v_accvgpr_write_b32 a42, v252
  v_mfma_f32_16x16x32_bf16 v[56:59], v[64:67], a[36:39], v[56:59]
  v_accvgpr_write_b32 a43, v253
  s_waitcnt lgkmcnt(6)
  v_mfma_f32_16x16x32_bf16 v[96:99], v[16:19], a[32:35], v[96:99]
  ds_read_b64_tr_b16 v[44:45], v1 offset:19552
  v_accvgpr_write_b32 a46, v254
  v_mfma_f32_16x16x32_bf16 v[100:103], v[16:19], a[36:39], v[100:103]
  ds_read_b64_tr_b16 v[46:47], v1 offset:20064
  s_add_u32 s72, s65, 2654208
  v_mfma_f32_16x16x32_bf16 v[168:171], v[20:23], a[32:35], v[168:171]
  ds_read_b64_tr_b16 v[16:17], v1 offset:20480
  v_accvgpr_write_b32 a47, v255
  v_mfma_f32_16x16x32_bf16 v[176:179], v[20:23], a[36:39], v[176:179]
  ds_read_b64_tr_b16 v[18:19], v1 offset:20992
  v_add_u32 v70, s3, v71
  v_mfma_f32_16x16x32_bf16 v[104:107], v[24:27], a[32:35], v[104:107]
  ds_read_b64_tr_b16 v[20:21], v1 offset:20512
  v_and_b32 v71, 3, v68
  v_mfma_f32_16x16x32_bf16 v[108:111], v[24:27], a[36:39], v[108:111]
  ds_read_b64_tr_b16 v[22:23], v1 offset:21024
  v_mul_u32_u24 v7, 9216, v70
  v_mfma_f32_16x16x32_bf16 v[192:195], v[28:31], a[32:35], v[192:195]
  ds_read_b64_tr_b16 v[24:25], v1 offset:20544
  v_lshl_add_u32 v7, v71, 4, v7
  v_mfma_f32_16x16x32_bf16 v[200:203], v[28:31], a[36:39], v[200:203]
  ds_read_b64_tr_b16 v[26:27], v1 offset:21056
  s_add_u32 m0, s64, 0
  v_mfma_f32_16x16x32_bf16 v[52:55], a[32:35], a[32:35], v[52:55]
  s_mul_i32 s3, s17, -576
  s_waitcnt lgkmcnt(6)
  v_mfma_f32_16x16x32_bf16 v[160:163], v[32:35], a[32:35], v[160:163]
  ds_read_b64_tr_b16 v[28:29], v1 offset:20576
  s_add_u32 s3, s3, 2304
  v_mfma_f32_16x16x32_bf16 v[164:167], v[32:35], a[36:39], v[164:167]
  ds_read_b64_tr_b16 v[30:31], v1 offset:21088
ffn_hop9:
  s_cbranch_execz ffn_hop10
  v_add_u32 v7, s3, v7
  v_mfma_f32_16x16x32_bf16 v[172:175], v[36:39], a[32:35], v[172:175]
  ds_read_b64_tr_b16 v[32:33], v1 offset:21504
  v_mul_u32_u24 v15, 1152, v70
  v_mfma_f32_16x16x32_bf16 v[180:183], v[36:39], a[36:39], v[180:183]
  ds_read_b64_tr_b16 v[34:35], v1 offset:22016
  v_lshl_add_u32 v15, v71, 4, v15
  v_mfma_f32_16x16x32_bf16 v[184:187], v[40:43], a[32:35], v[184:187]
  buffer_load_dwordx4 v5, s[20:23], s72 offen offset:0 lds
  v_mfma_f32_16x16x32_bf16 v[188:191], v[40:43], a[36:39], v[188:191]
  ds_read_b64_tr_b16 v[36:37], v1 offset:21536
  ds_read_b64_tr_b16 v[38:39], v1 offset:22048
  v_mfma_f32_16x16x32_bf16 v[196:199], v[44:47], a[32:35], v[196:199]
  ds_read_b64_tr_b16 v[40:41], v1 offset:21568
  v_add_u32 v15, 4096, v15
  v_mfma_f32_16x16x32_bf16 v[204:207], v[44:47], a[36:39], v[204:207]
  ds_read_b64_tr_b16 v[42:43], v1 offset:22080
  s_cmp_lt_u32 s16, 2
  s_cselect_b32 s28, s4, s6
  s_cselect_b32 s29, s5, s7
  v_mfma_f32_16x16x32_bf16 v[48:51], v[64:67], a[32:35], v[48:51]
  s_sub_u32 s28, s28, 4096
  s_subb_u32 s29, s29, 0
  s_waitcnt lgkmcnt(6)
  v_mfma_f32_16x16x32_bf16 v[80:83], v[16:19], a[40:43], v[80:83]
  buffer_load_dwordx4 v5, s[24:27], s72 offen offset:1024 lds
  v_mfma_f32_16x16x32_bf16 v[84:87], v[16:19], a[44:47], v[84:87]
  ds_read_b64_tr_b16 v[44:45], v1 offset:21600
  ds_read_b64_tr_b16 v[46:47], v1 offset:22112
  v_mfma_f32_16x16x32_bf16 v[120:123], v[20:23], a[40:43], v[120:123]
  ds_read_b64_tr_b16 v[16:17], v1 offset:22528
  s_mov_b32 s73, 1310720
  v_mfma_f32_16x16x32_bf16 v[128:131], v[20:23], a[44:47], v[128:131]
  buffer_load_dwordx4 v[240:243], v8, s[40:43], s73 offen
  v_mfma_f32_16x16x32_bf16 v[88:91], v[24:27], a[40:43], v[88:91]
  ds_read_b64_tr_b16 v[18:19], v1 offset:23040
  ds_read_b64_tr_b16 v[20:21], v1 offset:22560
  v_mfma_f32_16x16x32_bf16 v[92:95], v[24:27], a[44:47], v[92:95]
  ds_read_b64_tr_b16 v[22:23], v1 offset:23072
  s_mov_b32 s73, 1376256
  v_mfma_f32_16x16x32_bf16 v[144:147], v[28:31], a[40:43], v[144:147]
  buffer_load_dwordx4 v6, s[20:23], s72 offen offset:2048 lds
  v_mfma_f32_16x16x32_bf16 v[152:155], v[28:31], a[44:47], v[152:155]
  ds_read_b64_tr_b16 v[24:25], v1 offset:22592
  ds_read_b64_tr_b16 v[26:27], v1 offset:23104
  v_mfma_f32_16x16x32_bf16 v[60:63], a[44:47], a[44:47], v[60:63]
  v_accvgpr_write_b32 a48, v208
  s_waitcnt lgkmcnt(6)
  v_mfma_f32_16x16x32_bf16 v[112:115], v[32:35], a[40:43], v[112:115]
  buffer_load_dwordx4 v[244:247], v8, s[40:43], s73 offen
  v_mfma_f32_16x16x32_bf16 v[116:119], v[32:35], a[44:47], v[116:119]
  ds_read_b64_tr_b16 v[28:29], v1 offset:22624
  ds_read_b64_tr_b16 v[30:31], v1 offset:23136
  v_mfma_f32_16x16x32_bf16 v[124:127], v[36:39], a[40:43], v[124:127]
  ds_read_b64_tr_b16 v[32:33], v1 offset:23552
  v_accvgpr_write_b32 a49, v209
  v_mfma_f32_16x16x32_bf16 v[132:135], v[36:39], a[44:47], v[132:135]
  buffer_load_dwordx4 v6, s[24:27], s72 offen offset:3072 lds
  v_mfma_f32_16x16x32_bf16 v[136:139], v[40:43], a[40:43], v[136:139]
  ds_read_b64_tr_b16 v[34:35], v1 offset:24064
  ds_read_b64_tr_b16 v[36:37], v1 offset:23584
  v_mfma_f32_16x16x32_bf16 v[140:143], v[40:43], a[44:47], v[140:143]
  ds_read_b64_tr_b16 v[38:39], v1 offset:24096
ffn_hop10:
  s_cbranch_execz ffn_hop11
  v_accvgpr_write_b32 a52, v210
  v_mfma_f32_16x16x32_bf16 v[148:151], v[44:47], a[40:43], v[148:151]
  ds_read_b64_tr_b16 v[40:41], v1 offset:23616
  v_accvgpr_write_b32 a53, v211
  v_mfma_f32_16x16x32_bf16 v[156:159], v[44:47], a[44:47], v[156:159]
  ds_read_b64_tr_b16 v[42:43], v1 offset:24128
  v_accvgpr_write_b32 a50, v212
  v_mfma_f32_16x16x32_bf16 v[56:59], v[64:67], a[44:47], v[56:59]
  v_accvgpr_write_b32 a51, v213
  s_waitcnt lgkmcnt(6)
  v_mfma_f32_16x16x32_bf16 v[96:99], v[16:19], a[40:43], v[96:99]
  ds_read_b64_tr_b16 v[44:45], v1 offset:23648
  v_accvgpr_write_b32 a54, v214
  v_mfma_f32_16x16x32_bf16 v[100:103], v[16:19], a[44:47], v[100:103]
  ds_read_b64_tr_b16 v[46:47], v1 offset:24160
  v_accvgpr_write_b32 a55, v215
  v_mfma_f32_16x16x32_bf16 v[168:171], v[20:23], a[40:43], v[168:171]
  s_waitcnt vmcnt(12)
  s_barrier
  ds_read_b64_tr_b16 v[16:17], v1 offset:24576
  v_mfma_f32_16x16x32_bf16 v[176:179], v[20:23], a[44:47], v[176:179]
  ds_read_b64_tr_b16 v[18:19], v1 offset:25088
  s_add_u32 s72, s65, 2949120
  v_mfma_f32_16x16x32_bf16 v[104:107], v[24:27], a[40:43], v[104:107]
  ds_read_b64_tr_b16 v[20:21], v1 offset:24608
  s_mov_b32 s30, 5312512
  v_mfma_f32_16x16x32_bf16 v[108:111], v[24:27], a[44:47], v[108:111]
  ds_read_b64_tr_b16 v[22:23], v1 offset:25120
  s_mov_b32 s31, 0x20000
  v_mfma_f32_16x16x32_bf16 v[192:195], v[28:31], a[40:43], v[192:195]
  ds_read_b64_tr_b16 v[24:25], v1 offset:24640
  v_cmp_eq_u32 s[74:75], 1, v71
  v_mfma_f32_16x16x32_bf16 v[200:203], v[28:31], a[44:47], v[200:203]
  ds_read_b64_tr_b16 v[26:27], v1 offset:25152
  v_cmp_eq_u32 s[76:77], 2, v71
  v_mfma_f32_16x16x32_bf16 v[52:55], a[40:43], a[40:43], v[52:55]
  s_add_u32 m0, s64, 4096
  s_waitcnt lgkmcnt(6)
  v_mfma_f32_16x16x32_bf16 v[160:163], v[32:35], a[40:43], v[160:163]
  ds_read_b64_tr_b16 v[28:29], v1 offset:24672
  v_cmp_eq_u32 s[78:79], 3, v71
  v_mfma_f32_16x16x32_bf16 v[164:167], v[32:35], a[44:47], v[164:167]
  ds_read_b64_tr_b16 v[30:31], v1 offset:25184
  v_lshrrev_b32 v71, 4, v68
  v_mfma_f32_16x16x32_bf16 v[172:175], v[36:39], a[40:43], v[172:175]
  ds_read_b64_tr_b16 v[32:33], v1 offset:25600
  v_lshlrev_b32 v9, 4, v71
  v_mfma_f32_16x16x32_bf16 v[180:183], v[36:39], a[44:47], v[180:183]
  ds_read_b64_tr_b16 v[34:35], v1 offset:26112
  s_mul_i32 s3, s17, 128
  v_mfma_f32_16x16x32_bf16 v[184:187], v[40:43], a[40:43], v[184:187]
  ds_read_b64_tr_b16 v[36:37], v1 offset:25632
  s_add_u32 s3, s3, 155776
  v_mfma_f32_16x16x32_bf16 v[188:191], v[40:43], a[44:47], v[188:191]
  buffer_load_dwordx4 v5, s[20:23], s72 offen offset:0 lds
  v_mfma_f32_16x16x32_bf16 v[196:199], v[44:47], a[40:43], v[196:199]
  ds_read_b64_tr_b16 v[38:39], v1 offset:26144
  ds_read_b64_tr_b16 v[40:41], v1 offset:25664
  v_mfma_f32_16x16x32_bf16 v[204:207], v[44:47], a[44:47], v[204:207]
  ds_read_b64_tr_b16 v[42:43], v1 offset:26176
  v_add_u32 v9, s3, v9
  v_mfma_f32_16x16x32_bf16 v[48:51], v[64:67], a[40:43], v[48:51]
  s_mov_b32 s80, 4096
  s_waitcnt lgkmcnt(6)
  v_mfma_f32_16x16x32_bf16 v[80:83], v[16:19], a[48:51], v[80:83]
  ds_read_b64_tr_b16 v[44:45], v1 offset:25696
  s_mov_b32 s73, 1441792
ffn_hop11:
  s_cbranch_execz ffn_hop12
  v_mfma_f32_16x16x32_bf16 v[84:87], v[16:19], a[52:55], v[84:87]
  ds_read_b64_tr_b16 v[46:47], v1 offset:26208
  s_mov_b32 s81, 8192
  v_mfma_f32_16x16x32_bf16 v[120:123], v[20:23], a[48:51], v[120:123]
  buffer_load_dwordx4 v5, s[24:27], s72 offen offset:1024 lds
  v_mfma_f32_16x16x32_bf16 v[128:131], v[20:23], a[52:55], v[128:131]
  ds_read_b64_tr_b16 v[16:17], v1 offset:26624
  ds_read_b64_tr_b16 v[18:19], v1 offset:27136
  v_mfma_f32_16x16x32_bf16 v[88:91], v[24:27], a[48:51], v[88:91]
  buffer_load_dwordx4 v[248:251], v8, s[40:43], s73 offen
  v_mfma_f32_16x16x32_bf16 v[92:95], v[24:27], a[52:55], v[92:95]
  ds_read_b64_tr_b16 v[20:21], v1 offset:26656
  ds_read_b64_tr_b16 v[22:23], v1 offset:27168
  v_accvgpr_write_b32 a56, v216
  v_mfma_f32_16x16x32_bf16 v[144:147], v[28:31], a[48:51], v[144:147]
  ds_read_b64_tr_b16 v[24:25], v1 offset:26688
  s_mov_b32 s73, 1507328
  v_mfma_f32_16x16x32_bf16 v[152:155], v[28:31], a[52:55], v[152:155]
  buffer_load_dwordx4 v[252:255], v8, s[40:43], s73 offen
  v_mfma_f32_16x16x32_bf16 v[60:63], a[52:55], a[52:55], v[60:63]
  ds_read_b64_tr_b16 v[26:27], v1 offset:27200
  s_waitcnt lgkmcnt(6)
  v_mfma_f32_16x16x32_bf16 v[112:115], v[32:35], a[48:51], v[112:115]
  buffer_load_dwordx4 v6, s[20:23], s72 offen offset:2048 lds
  v_mfma_f32_16x16x32_bf16 v[116:119], v[32:35], a[52:55], v[116:119]
  ds_read_b64_tr_b16 v[28:29], v1 offset:26720
  ds_read_b64_tr_b16 v[30:31], v1 offset:27232
  v_mfma_f32_16x16x32_bf16 v[124:127], v[36:39], a[48:51], v[124:127]
  ds_read_b64_tr_b16 v[32:33], v1 offset:27648
  v_accvgpr_write_b32 a57, v217
  v_mfma_f32_16x16x32_bf16 v[132:135], v[36:39], a[52:55], v[132:135]
  ds_read_b64_tr_b16 v[34:35], v1 offset:28160
  v_accvgpr_write_b32 a60, v218
  v_mfma_f32_16x16x32_bf16 v[136:139], v[40:43], a[48:51], v[136:139]
  buffer_load_dwordx4 v6, s[24:27], s72 offen offset:3072 lds
  v_mfma_f32_16x16x32_bf16 v[140:143], v[40:43], a[52:55], v[140:143]
  ds_read_b64_tr_b16 v[36:37], v1 offset:27680
  ds_read_b64_tr_b16 v[38:39], v1 offset:28192
  v_mfma_f32_16x16x32_bf16 v[148:151], v[44:47], a[48:51], v[148:151]
  ds_read_b64_tr_b16 v[40:41], v1 offset:27712
  v_accvgpr_write_b32 a61, v219
  v_mfma_f32_16x16x32_bf16 v[156:159], v[44:47], a[52:55], v[156:159]
  ds_read_b64_tr_b16 v[42:43], v1 offset:28224
  v_accvgpr_write_b32 a58, v220
  v_mfma_f32_16x16x32_bf16 v[56:59], v[64:67], a[52:55], v[56:59]
  v_accvgpr_write_b32 a59, v221
  s_waitcnt lgkmcnt(6)
  v_mfma_f32_16x16x32_bf16 v[96:99], v[16:19], a[48:51], v[96:99]
  ds_read_b64_tr_b16 v[44:45], v1 offset:27744
  v_accvgpr_write_b32 a62, v222
  v_mfma_f32_16x16x32_bf16 v[100:103], v[16:19], a[52:55], v[100:103]
  ds_read_b64_tr_b16 v[46:47], v1 offset:28256
  s_add_u32 s72, s65, 3244032
  v_mfma_f32_16x16x32_bf16 v[168:171], v[20:23], a[48:51], v[168:171]
  ds_read_b64_tr_b16 v[16:17], v1 offset:28672
  v_accvgpr_write_b32 a63, v223
  v_mfma_f32_16x16x32_bf16 v[176:179], v[20:23], a[52:55], v[176:179]
  ds_read_b64_tr_b16 v[18:19], v1 offset:29184
  s_mov_b32 s82, 12288
  v_mfma_f32_16x16x32_bf16 v[104:107], v[24:27], a[48:51], v[104:107]
  ds_read_b64_tr_b16 v[20:21], v1 offset:28704
  s_mov_b32 s83, 16384
  v_mfma_f32_16x16x32_bf16 v[108:111], v[24:27], a[52:55], v[108:111]
  ds_read_b64_tr_b16 v[22:23], v1 offset:29216
  s_mul_i32 s3, s18, 663552
ffn_hop12:
  s_cbranch_execz ffn_hop13
  v_mfma_f32_16x16x32_bf16 v[192:195], v[28:31], a[48:51], v[192:195]
  ds_read_b64_tr_b16 v[24:25], v1 offset:28736
  s_mul_i32 s66, s17, 369280
  v_mfma_f32_16x16x32_bf16 v[200:203], v[28:31], a[52:55], v[200:203]
  ds_read_b64_tr_b16 v[26:27], v1 offset:29248
  s_add_u32 m0, s64, 8192
  v_mfma_f32_16x16x32_bf16 v[52:55], a[48:51], a[48:51], v[52:55]
  s_add_u32 s66, s66, 0
  s_waitcnt lgkmcnt(6)
  v_mfma_f32_16x16x32_bf16 v[160:163], v[32:35], a[48:51], v[160:163]
  ds_read_b64_tr_b16 v[28:29], v1 offset:28768
  s_add_u32 s66, s66, s3
  v_mfma_f32_16x16x32_bf16 v[164:167], v[32:35], a[52:55], v[164:167]
  ds_read_b64_tr_b16 v[30:31], v1 offset:29280
  s_mul_i32 s67, s17, -368000
  v_mfma_f32_16x16x32_bf16 v[172:175], v[36:39], a[48:51], v[172:175]
  ds_read_b64_tr_b16 v[32:33], v1 offset:29696
  s_add_u32 s67, s67, 368640
  v_mfma_f32_16x16x32_bf16 v[180:183], v[36:39], a[52:55], v[180:183]
  ds_read_b64_tr_b16 v[34:35], v1 offset:30208
  s_add_u32 s67, s67, s3
  v_mfma_f32_16x16x32_bf16 v[184:187], v[40:43], a[48:51], v[184:187]
  buffer_load_dwordx4 v5, s[20:23], s72 offen offset:0 lds
  v_mfma_f32_16x16x32_bf16 v[188:191], v[40:43], a[52:55], v[188:191]
  ds_read_b64_tr_b16 v[36:37], v1 offset:29728
  ds_read_b64_tr_b16 v[38:39], v1 offset:30240
  v_mfma_f32_16x16x32_bf16 v[196:199], v[44:47], a[48:51], v[196:199]
  ds_read_b64_tr_b16 v[40:41], v1 offset:29760
  s_mul_i32 s68, s17, 37504
  v_mfma_f32_16x16x32_bf16 v[204:207], v[44:47], a[52:55], v[204:207]
  ds_read_b64_tr_b16 v[42:43], v1 offset:30272
  s_add_u32 s68, s68, 294912
  v_mfma_f32_16x16x32_bf16 v[48:51], v[64:67], a[48:51], v[48:51]
  s_add_u32 s68, s68, s3
  s_waitcnt lgkmcnt(6)
  v_mfma_f32_16x16x32_bf16 v[80:83], v[16:19], a[56:59], v[80:83]
  buffer_load_dwordx4 v5, s[24:27], s72 offen offset:1024 lds
  v_mfma_f32_16x16x32_bf16 v[84:87], v[16:19], a[60:63], v[84:87]
  ds_read_b64_tr_b16 v[44:45], v1 offset:29792
  ds_read_b64_tr_b16 v[46:47], v1 offset:30304
  v_mfma_f32_16x16x32_bf16 v[120:123], v[20:23], a[56:59], v[120:123]
  ds_read_b64_tr_b16 v[16:17], v1 offset:30720
  s_mov_b32 s73, 1572864
  v_mfma_f32_16x16x32_bf16 v[128:131], v[20:23], a[60:63], v[128:131]
  buffer_load_dwordx4 v[208:211], v8, s[40:43], s73 offen
  v_mfma_f32_16x16x32_bf16 v[88:91], v[24:27], a[56:59], v[88:91]
  ds_read_b64_tr_b16 v[18:19], v1 offset:31232
  ds_read_b64_tr_b16 v[20:21], v1 offset:30752
  v_mfma_f32_16x16x32_bf16 v[92:95], v[24:27], a[60:63], v[92:95]
  ds_read_b64_tr_b16 v[22:23], v1 offset:31264
  s_mov_b32 s73, 1638400
  v_mfma_f32_16x16x32_bf16 v[144:147], v[28:31], a[56:59], v[144:147]
  buffer_load_dwordx4 v6, s[20:23], s72 offen offset:2048 lds
  v_mfma_f32_16x16x32_bf16 v[152:155], v[28:31], a[60:63], v[152:155]
  ds_read_b64_tr_b16 v[24:25], v1 offset:30784
  ds_read_b64_tr_b16 v[26:27], v1 offset:31296
  v_mfma_f32_16x16x32_bf16 v[60:63], a[60:63], a[60:63], v[60:63]
  v_accvgpr_write_b32 a64, v224
  s_waitcnt lgkmcnt(6)
  v_mfma_f32_16x16x32_bf16 v[112:115], v[32:35], a[56:59], v[112:115]
  buffer_load_dwordx4 v[212:215], v8, s[40:43], s73 offen
  v_mfma_f32_16x16x32_bf16 v[116:119], v[32:35], a[60:63], v[116:119]
  ds_read_b64_tr_b16 v[28:29], v1 offset:30816
  ds_read_b64_tr_b16 v[30:31], v1 offset:31328
  v_mfma_f32_16x16x32_bf16 v[124:127], v[36:39], a[56:59], v[124:127]
  ds_read_b64_tr_b16 v[32:33], v1 offset:31744
  v_accvgpr_write_b32 a65, v225
ffn_hop13:
  s_cbranch_execz ffn_hop14
  v_mfma_f32_16x16x32_bf16 v[132:135], v[36:39], a[60:63], v[132:135]
  buffer_load_dwordx4 v6, s[24:27], s72 offen offset:3072 lds
  v_mfma_f32_16x16x32_bf16 v[136:139], v[40:43], a[56:59], v[136:139]
  ds_read_b64_tr_b16 v[34:35], v1 offset:32256
  ds_read_b64_tr_b16 v[36:37], v1 offset:31776
  v_mfma_f32_16x16x32_bf16 v[140:143], v[40:43], a[60:63], v[140:143]
  ds_read_b64_tr_b16 v[38:39], v1 offset:32288
  v_accvgpr_write_b32 a68, v226
  v_mfma_f32_16x16x32_bf16 v[148:151], v[44:47], a[56:59], v[148:151]
  ds_read_b64_tr_b16 v[40:41], v1 offset:31808
  v_accvgpr_write_b32 a69, v227
  v_mfma_f32_16x16x32_bf16 v[156:159], v[44:47], a[60:63], v[156:159]
  ds_read_b64_tr_b16 v[42:43], v1 offset:32320
  v_accvgpr_write_b32 a66, v228
  v_mfma_f32_16x16x32_bf16 v[56:59], v[64:67], a[60:63], v[56:59]
  v_accvgpr_write_b32 a67, v229
  s_waitcnt lgkmcnt(6)
  v_mfma_f32_16x16x32_bf16 v[96:99], v[16:19], a[56:59], v[96:99]
  ds_read_b64_tr_b16 v[44:45], v1 offset:31840
  v_accvgpr_write_b32 a70, v230
  v_mfma_f32_16x16x32_bf16 v[100:103], v[16:19], a[60:63], v[100:103]
  ds_read_b64_tr_b16 v[46:47], v1 offset:32352
  v_accvgpr_write_b32 a71, v231
  v_mfma_f32_16x16x32_bf16 v[168:171], v[20:23], a[56:59], v[168:171]
  s_waitcnt vmcnt(12)
  s_barrier
  ds_read_b64_tr_b16 v[16:17], v1 offset:32768
  v_mfma_f32_16x16x32_bf16 v[176:179], v[20:23], a[60:63], v[176:179]
  ds_read_b64_tr_b16 v[18:19], v1 offset:33280
  s_add_u32 s72, s65, 3538944
  v_mfma_f32_16x16x32_bf16 v[104:107], v[24:27], a[56:59], v[104:107]
  ds_read_b64_tr_b16 v[20:21], v1 offset:32800
  s_mul_i32 s69, s17, -36224
  v_mfma_f32_16x16x32_bf16 v[108:111], v[24:27], a[60:63], v[108:111]
  ds_read_b64_tr_b16 v[22:23], v1 offset:33312
  s_add_u32 s69, s69, 331776
  v_mfma_f32_16x16x32_bf16 v[192:195], v[28:31], a[56:59], v[192:195]
  ds_read_b64_tr_b16 v[24:25], v1 offset:32832
  s_add_u32 s69, s69, s3
  v_mfma_f32_16x16x32_bf16 v[200:203], v[28:31], a[60:63], v[200:203]
  ds_read_b64_tr_b16 v[26:27], v1 offset:33344
  s_cmp_lt_u32 s16, 2
  s_cselect_b32 s71, s68, s69
  s_cselect_b32 s3, 0, 36864
  v_mfma_f32_16x16x32_bf16 v[52:55], a[56:59], a[56:59], v[52:55]
  s_add_u32 m0, s64, 12288
  s_waitcnt lgkmcnt(6)
  v_mfma_f32_16x16x32_bf16 v[160:163], v[32:35], a[56:59], v[160:163]
  ds_read_b64_tr_b16 v[28:29], v1 offset:32864
  s_sub_u32 s71, s71, s3
  v_mfma_f32_16x16x32_bf16 v[164:167], v[32:35], a[60:63], v[164:167]
  ds_read_b64_tr_b16 v[30:31], v1 offset:33376
  s_mul_i32 s39, s17, -576
  v_mfma_f32_16x16x32_bf16 v[172:175], v[36:39], a[56:59], v[172:175]
  ds_read_b64_tr_b16 v[32:33], v1 offset:33792
  s_add_u32 s39, s39, 512
  v_mfma_f32_16x16x32_bf16 v[180:183], v[36:39], a[60:63], v[180:183]
  ds_read_b64_tr_b16 v[34:35], v1 offset:34304
  s_xor_b32 s70, s18, 1
  v_mfma_f32_16x16x32_bf16 v[184:187], v[40:43], a[56:59], v[184:187]
  ds_read_b64_tr_b16 v[36:37], v1 offset:33824
  s_lshl_b32 s70, s70, 6
  v_mfma_f32_16x16x32_bf16 v[188:191], v[40:43], a[60:63], v[188:191]
  buffer_load_dwordx4 v5, s[20:23], s72 offen offset:0 lds
  v_mfma_f32_16x16x32_bf16 v[196:199], v[44:47], a[56:59], v[196:199]
  ds_read_b64_tr_b16 v[38:39], v1 offset:34336
  ds_read_b64_tr_b16 v[40:41], v1 offset:33856
  v_mfma_f32_16x16x32_bf16 v[204:207], v[44:47], a[60:63], v[204:207]
ffn_hop14:
  s_cbranch_execz ffn_hop15
  ds_read_b64_tr_b16 v[42:43], v1 offset:34368
  s_lshl_b32 s47, s18, 6
  v_mfma_f32_16x16x32_bf16 v[48:51], v[64:67], a[56:59], v[48:51]
  s_add_u32 s39, s39, s3
  s_waitcnt lgkmcnt(6)
  v_mfma_f32_16x16x32_bf16 v[80:83], v[16:19], a[64:67], v[80:83]
  ds_read_b64_tr_b16 v[44:45], v1 offset:33888
  s_mov_b32 s73, 1703936
  v_mfma_f32_16x16x32_bf16 v[84:87], v[16:19], a[68:71], v[84:87]
  ds_read_b64_tr_b16 v[46:47], v1 offset:34400
  s_add_u32 s70, s70, s3
  v_mfma_f32_16x16x32_bf16 v[120:123], v[20:23], a[64:67], v[120:123]
  buffer_load_dwordx4 v5, s[24:27], s72 offen offset:1024 lds
  v_mfma_f32_16x16x32_bf16 v[128:131], v[20:23], a[68:71], v[128:131]
  ds_read_b64_tr_b16 v[16:17], v1 offset:34816
  ds_read_b64_tr_b16 v[18:19], v1 offset:35328
  v_mfma_f32_16x16x32_bf16 v[88:91], v[24:27], a[64:67], v[88:91]
  buffer_load_dwordx4 v[216:219], v8, s[40:43], s73 offen
  v_mfma_f32_16x16x32_bf16 v[92:95], v[24:27], a[68:71], v[92:95]
  ds_read_b64_tr_b16 v[20:21], v1 offset:34848
  ds_read_b64_tr_b16 v[22:23], v1 offset:35360
  v_accvgpr_write_b32 a72, v232
  v_mfma_f32_16x16x32_bf16 v[144:147], v[28:31], a[64:67], v[144:147]
  ds_read_b64_tr_b16 v[24:25], v1 offset:34880
  s_mov_b32 s73, 1769472
  v_mfma_f32_16x16x32_bf16 v[152:155], v[28:31], a[68:71], v[152:155]
  buffer_load_dwordx4 v[220:223], v8, s[40:43], s73 offen
  v_mfma_f32_16x16x32_bf16 v[60:63], a[68:71], a[68:71], v[60:63]
  ds_read_b64_tr_b16 v[26:27], v1 offset:35392
  s_waitcnt lgkmcnt(6)
  v_mfma_f32_16x16x32_bf16 v[112:115], v[32:35], a[64:67], v[112:115]
  buffer_load_dwordx4 v6, s[20:23], s72 offen offset:2048 lds
  v_mfma_f32_16x16x32_bf16 v[116:119], v[32:35], a[68:71], v[116:119]
  ds_read_b64_tr_b16 v[28:29], v1 offset:34912
  ds_read_b64_tr_b16 v[30:31], v1 offset:35424
  v_mfma_f32_16x16x32_bf16 v[124:127], v[36:39], a[64:67], v[124:127]
  ds_read_b64_tr_b16 v[32:33], v1 offset:35840
  v_accvgpr_write_b32 a73, v233
  v_mfma_f32_16x16x32_bf16 v[132:135], v[36:39], a[68:71], v[132:135]
  ds_read_b64_tr_b16 v[34:35], v1 offset:36352
  v_accvgpr_write_b32 a76, v234
  v_mfma_f32_16x16x32_bf16 v[136:139], v[40:43], a[64:67], v[136:139]
  buffer_load_dwordx4 v6, s[24:27], s72 offen offset:3072 lds
  v_mfma_f32_16x16x32_bf16 v[140:143], v[40:43], a[68:71], v[140:143]
  ds_read_b64_tr_b16 v[36:37], v1 offset:35872
  ds_read_b64_tr_b16 v[38:39], v1 offset:36384
  v_mfma_f32_16x16x32_bf16 v[148:151], v[44:47], a[64:67], v[148:151]
  ds_read_b64_tr_b16 v[40:41], v1 offset:35904
  v_accvgpr_write_b32 a77, v235
  v_mfma_f32_16x16x32_bf16 v[156:159], v[44:47], a[68:71], v[156:159]
  ds_read_b64_tr_b16 v[42:43], v1 offset:36416
  v_accvgpr_write_b32 a74, v236
  v_mfma_f32_16x16x32_bf16 v[56:59], v[64:67], a[68:71], v[56:59]
  v_accvgpr_write_b32 a75, v237
  s_waitcnt lgkmcnt(6)
  v_mfma_f32_16x16x32_bf16 v[96:99], v[16:19], a[64:67], v[96:99]
  ds_read_b64_tr_b16 v[44:45], v1 offset:35936
  v_accvgpr_write_b32 a78, v238
  v_mfma_f32_16x16x32_bf16 v[100:103], v[16:19], a[68:71], v[100:103]
  ds_read_b64_tr_b16 v[46:47], v1 offset:36448
  s_add_u32 s72, s65, 3833856
  v_mfma_f32_16x16x32_bf16 v[168:171], v[20:23], a[64:67], v[168:171]
  ds_read_b64_tr_b16 v[16:17], v1 offset:0
  v_accvgpr_write_b32 a79, v239
  v_mfma_f32_16x16x32_bf16 v[176:179], v[20:23], a[68:71], v[176:179]
  ds_read_b64_tr_b16 v[18:19], v1 offset:512
  s_add_u32 s47, s47, s3
ffn_hop15:
  s_cbranch_execz ffn_hop16
  v_mfma_f32_16x16x32_bf16 v[104:107], v[24:27], a[64:67], v[104:107]
  ds_read_b64_tr_b16 v[20:21], v1 offset:32
  s_lshr_b32 s3, s18, 1
  v_mfma_f32_16x16x32_bf16 v[108:111], v[24:27], a[68:71], v[108:111]
  ds_read_b64_tr_b16 v[22:23], v1 offset:544
  s_xor_b32 s36, s3, 1
  v_mfma_f32_16x16x32_bf16 v[192:195], v[28:31], a[64:67], v[192:195]
  ds_read_b64_tr_b16 v[24:25], v1 offset:64
  s_lshl_b32 s36, s36, 7
  v_mfma_f32_16x16x32_bf16 v[200:203], v[28:31], a[68:71], v[200:203]
  ds_read_b64_tr_b16 v[26:27], v1 offset:576
  s_add_u32 m0, s64, 16384
  v_mfma_f32_16x16x32_bf16 v[52:55], a[64:67], a[64:67], v[52:55]
  s_xor_b32 s37, s3, 2
  s_waitcnt lgkmcnt(6)
  v_mfma_f32_16x16x32_bf16 v[160:163], v[32:35], a[64:67], v[160:163]
  ds_read_b64_tr_b16 v[28:29], v1 offset:96
  s_lshl_b32 s37, s37, 7
  v_mfma_f32_16x16x32_bf16 v[164:167], v[32:35], a[68:71], v[164:167]
  ds_read_b64_tr_b16 v[30:31], v1 offset:608
  s_xor_b32 s38, s3, 3
  v_mfma_f32_16x16x32_bf16 v[172:175], v[36:39], a[64:67], v[172:175]
  ds_read_b64_tr_b16 v[32:33], v1 offset:1024
  s_lshl_b32 s38, s38, 7
  v_mfma_f32_16x16x32_bf16 v[180:183], v[36:39], a[68:71], v[180:183]
  ds_read_b64_tr_b16 v[34:35], v1 offset:1536
  s_lshl_b32 s3, s2, 2
  v_mfma_f32_16x16x32_bf16 v[184:187], v[40:43], a[64:67], v[184:187]
  buffer_load_dwordx4 v5, s[20:23], s72 offen offset:0 lds
  v_mfma_f32_16x16x32_bf16 v[188:191], v[40:43], a[68:71], v[188:191]
  ds_read_b64_tr_b16 v[36:37], v1 offset:1056
  ds_read_b64_tr_b16 v[38:39], v1 offset:1568
  v_mfma_f32_16x16x32_bf16 v[196:199], v[44:47], a[64:67], v[196:199]
  ds_read_b64_tr_b16 v[40:41], v1 offset:1088
  s_add_u32 s3, s3, s16
  v_mfma_f32_16x16x32_bf16 v[204:207], v[44:47], a[68:71], v[204:207]
  ds_read_b64_tr_b16 v[42:43], v1 offset:1600
  s_lshl_b32 s84, s3, 6
  v_mfma_f32_16x16x32_bf16 v[48:51], v[64:67], a[64:67], v[48:51]
  s_mul_i32 s86, s3, 18432
  s_waitcnt lgkmcnt(6)
  v_mfma_f32_16x16x32_bf16 v[80:83], v[16:19], a[72:75], v[80:83]
  buffer_load_dwordx4 v5, s[24:27], s72 offen offset:1024 lds
  v_mfma_f32_16x16x32_bf16 v[84:87], v[16:19], a[76:79], v[84:87]
  ds_read_b64_tr_b16 v[44:45], v1 offset:1120
  ds_read_b64_tr_b16 v[46:47], v1 offset:1632
  v_mfma_f32_16x16x32_bf16 v[120:123], v[20:23], a[72:75], v[120:123]
  ds_read_b64_tr_b16 v[16:17], v1 offset:2048
  s_mov_b32 s73, 1835008
  v_mfma_f32_16x16x32_bf16 v[128:131], v[20:23], a[76:79], v[128:131]
  buffer_load_dwordx4 v[224:227], v8, s[40:43], s73 offen
  v_mfma_f32_16x16x32_bf16 v[88:91], v[24:27], a[72:75], v[88:91]
  ds_read_b64_tr_b16 v[18:19], v1 offset:2560
  ds_read_b64_tr_b16 v[20:21], v1 offset:2080
  v_mfma_f32_16x16x32_bf16 v[92:95], v[24:27], a[76:79], v[92:95]
  ds_read_b64_tr_b16 v[22:23], v1 offset:2592
  s_mov_b32 s73, 1900544
  v_mfma_f32_16x16x32_bf16 v[144:147], v[28:31], a[72:75], v[144:147]
  buffer_load_dwordx4 v6, s[20:23], s72 offen offset:2048 lds
  v_mfma_f32_16x16x32_bf16 v[152:155], v[28:31], a[76:79], v[152:155]
  ds_read_b64_tr_b16 v[24:25], v1 offset:2112
  ds_read_b64_tr_b16 v[26:27], v1 offset:2624
  v_mfma_f32_16x16x32_bf16 v[60:63], a[76:79], a[76:79], v[60:63]
  v_accvgpr_write_b32 a80, v240
  s_waitcnt lgkmcnt(6)
  v_mfma_f32_16x16x32_bf16 v[112:115], v[32:35], a[72:75], v[112:115]
  buffer_load_dwordx4 v[228:231], v8, s[40:43], s73 offen
  v_mfma_f32_16x16x32_bf16 v[116:119], v[32:35], a[76:79], v[116:119]
  ds_read_b64_tr_b16 v[28:29], v1 offset:2144
  ds_read_b64_tr_b16 v[30:31], v1 offset:2656
ffn_hop16:
  s_cbranch_execz ffn_hop17
  v_mfma_f32_16x16x32_bf16 v[124:127], v[36:39], a[72:75], v[124:127]
  ds_read_b64_tr_b16 v[32:33], v1 offset:3072
  v_accvgpr_write_b32 a81, v241
  v_mfma_f32_16x16x32_bf16 v[132:135], v[36:39], a[76:79], v[132:135]
  buffer_load_dwordx4 v6, s[24:27], s72 offen offset:3072 lds
  v_mfma_f32_16x16x32_bf16 v[136:139], v[40:43], a[72:75], v[136:139]
  ds_read_b64_tr_b16 v[34:35], v1 offset:3584
  ds_read_b64_tr_b16 v[36:37], v1 offset:3104
  v_mfma_f32_16x16x32_bf16 v[140:143], v[40:43], a[76:79], v[140:143]
  ds_read_b64_tr_b16 v[38:39], v1 offset:3616
  v_accvgpr_write_b32 a84, v242
  v_mfma_f32_16x16x32_bf16 v[148:151], v[44:47], a[72:75], v[148:151]
  ds_read_b64_tr_b16 v[40:41], v1 offset:3136
  v_accvgpr_write_b32 a85, v243
  v_mfma_f32_16x16x32_bf16 v[156:159], v[44:47], a[76:79], v[156:159]
  ds_read_b64_tr_b16 v[42:43], v1 offset:3648
  v_accvgpr_write_b32 a82, v244
  v_mfma_f32_16x16x32_bf16 v[56:59], v[64:67], a[76:79], v[56:59]
  v_accvgpr_write_b32 a83, v245
  s_waitcnt lgkmcnt(6)
  v_mfma_f32_16x16x32_bf16 v[96:99], v[16:19], a[72:75], v[96:99]
  ds_read_b64_tr_b16 v[44:45], v1 offset:3168
  v_accvgpr_write_b32 a86, v246
  v_mfma_f32_16x16x32_bf16 v[100:103], v[16:19], a[76:79], v[100:103]
  ds_read_b64_tr_b16 v[46:47], v1 offset:3680
  v_accvgpr_write_b32 a87, v247
  v_mfma_f32_16x16x32_bf16 v[168:171], v[20:23], a[72:75], v[168:171]
  s_waitcnt vmcnt(12)
  s_barrier
  ds_read_b64_tr_b16 v[16:17], v1 offset:4096
  v_mfma_f32_16x16x32_bf16 v[176:179], v[20:23], a[76:79], v[176:179]
  ds_read_b64_tr_b16 v[18:19], v1 offset:4608
  s_add_u32 s72, s65, 4128768
  v_mfma_f32_16x16x32_bf16 v[104:107], v[24:27], a[72:75], v[104:107]
  ds_read_b64_tr_b16 v[20:21], v1 offset:4128
  s_add_u32 s86, s86, 50331648
  v_mfma_f32_16x16x32_bf16 v[108:111], v[24:27], a[76:79], v[108:111]
  s_add_u32 s48, s14, s86
  s_addc_u32 s49, s15, 0
  v_mfma_f32_16x16x32_bf16 v[192:195], v[28:31], a[72:75], v[192:195]
  ds_read_b64_tr_b16 v[22:23], v1 offset:4640
  ds_read_b64_tr_b16 v[24:25], v1 offset:4160
  v_mfma_f32_16x16x32_bf16 v[200:203], v[28:31], a[76:79], v[200:203]
  ds_read_b64_tr_b16 v[26:27], v1 offset:4672
  s_mov_b32 s50, 18432
  v_mfma_f32_16x16x32_bf16 v[52:55], a[72:75], a[72:75], v[52:55]
  s_add_u32 m0, s64, 20480
  s_waitcnt lgkmcnt(6)
  v_mfma_f32_16x16x32_bf16 v[160:163], v[32:35], a[72:75], v[160:163]
  ds_read_b64_tr_b16 v[28:29], v1 offset:4192
  s_mov_b32 s51, 0x20000
  v_mfma_f32_16x16x32_bf16 v[164:167], v[32:35], a[76:79], v[164:167]
  ds_read_b64_tr_b16 v[30:31], v1 offset:4704
  s_xor_b32 s3, s3, 32
  v_mfma_f32_16x16x32_bf16 v[172:175], v[36:39], a[72:75], v[172:175]
  ds_read_b64_tr_b16 v[32:33], v1 offset:5120
  s_lshl_b32 s85, s3, 6
  v_mfma_f32_16x16x32_bf16 v[180:183], v[36:39], a[76:79], v[180:183]
  ds_read_b64_tr_b16 v[34:35], v1 offset:5632
  s_mul_i32 s86, s3, 18432
  v_mfma_f32_16x16x32_bf16 v[184:187], v[40:43], a[72:75], v[184:187]
  ds_read_b64_tr_b16 v[36:37], v1 offset:5152
  s_add_u32 s86, s86, 50331648
  v_mfma_f32_16x16x32_bf16 v[188:191], v[40:43], a[76:79], v[188:191]
  buffer_load_dwordx4 v5, s[20:23], s72 offen offset:0 lds
  v_mfma_f32_16x16x32_bf16 v[196:199], v[44:47], a[72:75], v[196:199]
  ds_read_b64_tr_b16 v[38:39], v1 offset:5664
  ds_read_b64_tr_b16 v[40:41], v1 offset:5184
ffn_hop17:
  s_cbranch_execz ffn_hop18
  v_mfma_f32_16x16x32_bf16 v[204:207], v[44:47], a[76:79], v[204:207]
  s_add_u32 s52, s14, s86
  s_addc_u32 s53, s15, 0
  v_mfma_f32_16x16x32_bf16 v[48:51], v[64:67], a[72:75], v[48:51]
  ds_read_b64_tr_b16 v[42:43], v1 offset:5696
  s_waitcnt lgkmcnt(6)
  v_mfma_f32_16x16x32_bf16 v[80:83], v[16:19], a[80:83], v[80:83]
  ds_read_b64_tr_b16 v[44:45], v1 offset:5216
  s_mov_b32 s73, 1966080
  v_mfma_f32_16x16x32_bf16 v[84:87], v[16:19], a[84:87], v[84:87]
  ds_read_b64_tr_b16 v[46:47], v1 offset:5728
  s_mov_b32 s54, 18432
  v_mfma_f32_16x16x32_bf16 v[120:123], v[20:23], a[80:83], v[120:123]
  buffer_load_dwordx4 v5, s[24:27], s72 offen offset:1024 lds
  v_mfma_f32_16x16x32_bf16 v[128:131], v[20:23], a[84:87], v[128:131]
  ds_read_b64_tr_b16 v[16:17], v1 offset:6144
  ds_read_b64_tr_b16 v[18:19], v1 offset:6656
  v_mfma_f32_16x16x32_bf16 v[88:91], v[24:27], a[80:83], v[88:91]
  buffer_load_dwordx4 v[232:235], v8, s[40:43], s73 offen
  v_mfma_f32_16x16x32_bf16 v[92:95], v[24:27], a[84:87], v[92:95]
  ds_read_b64_tr_b16 v[20:21], v1 offset:6176
  ds_read_b64_tr_b16 v[22:23], v1 offset:6688
  v_accvgpr_write_b32 a88, v248
  v_mfma_f32_16x16x32_bf16 v[144:147], v[28:31], a[80:83], v[144:147]
  ds_read_b64_tr_b16 v[24:25], v1 offset:6208
  s_mov_b32 s73, 2031616
  v_mfma_f32_16x16x32_bf16 v[152:155], v[28:31], a[84:87], v[152:155]
  buffer_load_dwordx4 v[236:239], v8, s[40:43], s73 offen
  v_mfma_f32_16x16x32_bf16 v[60:63], a[84:87], a[84:87], v[60:63]
  ds_read_b64_tr_b16 v[26:27], v1 offset:6720
  s_waitcnt lgkmcnt(6)
  v_mfma_f32_16x16x32_bf16 v[112:115], v[32:35], a[80:83], v[112:115]
  buffer_load_dwordx4 v6, s[20:23], s72 offen offset:2048 lds
  v_mfma_f32_16x16x32_bf16 v[116:119], v[32:35], a[84:87], v[116:119]
  ds_read_b64_tr_b16 v[28:29], v1 offset:6240
  ds_read_b64_tr_b16 v[30:31], v1 offset:6752
  v_mfma_f32_16x16x32_bf16 v[124:127], v[36:39], a[80:83], v[124:127]
  ds_read_b64_tr_b16 v[32:33], v1 offset:7168
  v_accvgpr_write_b32 a89, v249
  v_mfma_f32_16x16x32_bf16 v[132:135], v[36:39], a[84:87], v[132:135]
  ds_read_b64_tr_b16 v[34:35], v1 offset:7680
  v_accvgpr_write_b32 a92, v250
  v_mfma_f32_16x16x32_bf16 v[136:139], v[40:43], a[80:83], v[136:139]
  buffer_load_dwordx4 v6, s[24:27], s72 offen offset:3072 lds
  v_mfma_f32_16x16x32_bf16 v[140:143], v[40:43], a[84:87], v[140:143]
  ds_read_b64_tr_b16 v[36:37], v1 offset:7200
  ds_read_b64_tr_b16 v[38:39], v1 offset:7712
  v_mfma_f32_16x16x32_bf16 v[148:151], v[44:47], a[80:83], v[148:151]
  ds_read_b64_tr_b16 v[40:41], v1 offset:7232
  v_accvgpr_write_b32 a93, v251
  v_mfma_f32_16x16x32_bf16 v[156:159], v[44:47], a[84:87], v[156:159]
  ds_read_b64_tr_b16 v[42:43], v1 offset:7744
  v_accvgpr_write_b32 a90, v252
  v_mfma_f32_16x16x32_bf16 v[56:59], v[64:67], a[84:87], v[56:59]
  v_accvgpr_write_b32 a91, v253
  s_waitcnt lgkmcnt(6)
  v_mfma_f32_16x16x32_bf16 v[96:99], v[16:19], a[80:83], v[96:99]
  ds_read_b64_tr_b16 v[44:45], v1 offset:7264
  v_accvgpr_write_b32 a94, v254
  v_mfma_f32_16x16x32_bf16 v[100:103], v[16:19], a[84:87], v[100:103]
  ds_read_b64_tr_b16 v[46:47], v1 offset:7776
  s_add_u32 s72, s65, 4423680
  v_mfma_f32_16x16x32_bf16 v[168:171], v[20:23], a[80:83], v[168:171]
  ds_read_b64_tr_b16 v[16:17], v1 offset:8192
  v_accvgpr_write_b32 a95, v255
  v_mfma_f32_16x16x32_bf16 v[176:179], v[20:23], a[84:87], v[176:179]
  ds_read_b64_tr_b16 v[18:19], v1 offset:8704
  s_mov_b32 s55, 0x20000
  v_mfma_f32_16x16x32_bf16 v[104:107], v[24:27], a[80:83], v[104:107]
  ds_read_b64_tr_b16 v[20:21], v1 offset:8224
ffn_hop18:
  s_cbranch_execz ffn_hop19
  s_lshr_b32 s3, s2, 3
  v_mfma_f32_16x16x32_bf16 v[108:111], v[24:27], a[84:87], v[108:111]
  ds_read_b64_tr_b16 v[22:23], v1 offset:8736
  s_lshl_b32 s3, s3, 2
  v_mfma_f32_16x16x32_bf16 v[192:195], v[28:31], a[80:83], v[192:195]
  ds_read_b64_tr_b16 v[24:25], v1 offset:8256
  s_add_u32 s3, s3, s16
  v_mfma_f32_16x16x32_bf16 v[200:203], v[28:31], a[84:87], v[200:203]
  ds_read_b64_tr_b16 v[26:27], v1 offset:8768
  s_add_u32 m0, s64, 24576
  v_mfma_f32_16x16x32_bf16 v[52:55], a[80:83], a[80:83], v[52:55]
  s_mul_i32 s3, s3, 18432
  s_waitcnt lgkmcnt(6)
  v_mfma_f32_16x16x32_bf16 v[160:163], v[32:35], a[80:83], v[160:163]
  ds_read_b64_tr_b16 v[28:29], v1 offset:8288
  s_mul_i32 s86, s18, 2359296
  v_mfma_f32_16x16x32_bf16 v[164:167], v[32:35], a[84:87], v[164:167]
  ds_read_b64_tr_b16 v[30:31], v1 offset:8800
  s_add_u32 s3, s3, s86
  v_mfma_f32_16x16x32_bf16 v[172:175], v[36:39], a[80:83], v[172:175]
  ds_read_b64_tr_b16 v[32:33], v1 offset:9216
  s_add_u32 s3, s3, 16777216
  v_mfma_f32_16x16x32_bf16 v[180:183], v[36:39], a[84:87], v[180:183]
  ds_read_b64_tr_b16 v[34:35], v1 offset:9728
  s_add_u32 s56, s14, s3
  s_addc_u32 s57, s15, 0
  v_mfma_f32_16x16x32_bf16 v[184:187], v[40:43], a[80:83], v[184:187]
  buffer_load_dwordx4 v5, s[20:23], s72 offen offset:0 lds
  v_mfma_f32_16x16x32_bf16 v[188:191], v[40:43], a[84:87], v[188:191]
  ds_read_b64_tr_b16 v[36:37], v1 offset:9248
  ds_read_b64_tr_b16 v[38:39], v1 offset:9760
  v_mfma_f32_16x16x32_bf16 v[196:199], v[44:47], a[80:83], v[196:199]
  ds_read_b64_tr_b16 v[40:41], v1 offset:9280
  s_mov_b32 s58, 18432
  v_mfma_f32_16x16x32_bf16 v[204:207], v[44:47], a[84:87], v[204:207]
  ds_read_b64_tr_b16 v[42:43], v1 offset:9792
  s_mov_b32 s59, 0x20000
  v_mfma_f32_16x16x32_bf16 v[48:51], v[64:67], a[80:83], v[48:51]
  s_add_u32 s60, s14, 9568256
  s_addc_u32 s61, s15, 0
  s_waitcnt lgkmcnt(6)
  v_mfma_f32_16x16x32_bf16 v[80:83], v[16:19], a[88:91], v[80:83]
  buffer_load_dwordx4 v5, s[24:27], s72 offen offset:1024 lds
  v_mfma_f32_16x16x32_bf16 v[84:87], v[16:19], a[92:95], v[84:87]
  ds_read_b64_tr_b16 v[44:45], v1 offset:9312
  ds_read_b64_tr_b16 v[46:47], v1 offset:9824
  v_mfma_f32_16x16x32_bf16 v[120:123], v[20:23], a[88:91], v[120:123]
  ds_read_b64_tr_b16 v[16:17], v1 offset:10240
  s_mov_b32 s73, 2097152
  v_mfma_f32_16x16x32_bf16 v[128:131], v[20:23], a[92:95], v[128:131]
  buffer_load_dwordx4 v[240:243], v8, s[40:43], s73 offen
  v_mfma_f32_16x16x32_bf16 v[88:91], v[24:27], a[88:91], v[88:91]
  ds_read_b64_tr_b16 v[18:19], v1 offset:10752
  ds_read_b64_tr_b16 v[20:21], v1 offset:10272
  v_mfma_f32_16x16x32_bf16 v[92:95], v[24:27], a[92:95], v[92:95]
  ds_read_b64_tr_b16 v[22:23], v1 offset:10784
  s_mov_b32 s73, 2162688
  v_mfma_f32_16x16x32_bf16 v[144:147], v[28:31], a[88:91], v[144:147]
  buffer_load_dwordx4 v6, s[20:23], s72 offen offset:2048 lds
  v_mfma_f32_16x16x32_bf16 v[152:155], v[28:31], a[92:95], v[152:155]
  ds_read_b64_tr_b16 v[24:25], v1 offset:10304
  ds_read_b64_tr_b16 v[26:27], v1 offset:10816
  v_mfma_f32_16x16x32_bf16 v[60:63], a[92:95], a[92:95], v[60:63]
  v_accvgpr_write_b32 a96, v208
ffn_hop19:
  s_cbranch_execz ffn_hop20
  s_waitcnt lgkmcnt(6)
  v_mfma_f32_16x16x32_bf16 v[112:115], v[32:35], a[88:91], v[112:115]
  buffer_load_dwordx4 v[244:247], v8, s[40:43], s73 offen
  v_mfma_f32_16x16x32_bf16 v[116:119], v[32:35], a[92:95], v[116:119]
  ds_read_b64_tr_b16 v[28:29], v1 offset:10336
  ds_read_b64_tr_b16 v[30:31], v1 offset:10848
  v_mfma_f32_16x16x32_bf16 v[124:127], v[36:39], a[88:91], v[124:127]
  ds_read_b64_tr_b16 v[32:33], v1 offset:11264
  v_accvgpr_write_b32 a97, v209
  v_mfma_f32_16x16x32_bf16 v[132:135], v[36:39], a[92:95], v[132:135]
  buffer_load_dwordx4 v6, s[24:27], s72 offen offset:3072 lds
  v_mfma_f32_16x16x32_bf16 v[136:139], v[40:43], a[88:91], v[136:139]
  ds_read_b64_tr_b16 v[34:35], v1 offset:11776
  ds_read_b64_tr_b16 v[36:37], v1 offset:11296
  v_mfma_f32_16x16x32_bf16 v[140:143], v[40:43], a[92:95], v[140:143]
  ds_read_b64_tr_b16 v[38:39], v1 offset:11808
  v_accvgpr_write_b32 a100, v210
  v_mfma_f32_16x16x32_bf16 v[148:151], v[44:47], a[88:91], v[148:151]
  ds_read_b64_tr_b16 v[40:41], v1 offset:11328
  v_accvgpr_write_b32 a101, v211
  v_mfma_f32_16x16x32_bf16 v[156:159], v[44:47], a[92:95], v[156:159]
  ds_read_b64_tr_b16 v[42:43], v1 offset:11840
  v_accvgpr_write_b32 a98, v212
  v_mfma_f32_16x16x32_bf16 v[56:59], v[64:67], a[92:95], v[56:59]
  v_accvgpr_write_b32 a99, v213
  s_waitcnt lgkmcnt(6)
  v_mfma_f32_16x16x32_bf16 v[96:99], v[16:19], a[88:91], v[96:99]
  ds_read_b64_tr_b16 v[44:45], v1 offset:11360
  v_accvgpr_write_b32 a102, v214
  v_mfma_f32_16x16x32_bf16 v[100:103], v[16:19], a[92:95], v[100:103]
  ds_read_b64_tr_b16 v[46:47], v1 offset:11872
  v_accvgpr_write_b32 a103, v215
  v_mfma_f32_16x16x32_bf16 v[168:171], v[20:23], a[88:91], v[168:171]
  s_waitcnt vmcnt(12)
  s_barrier
  ds_read_b64_tr_b16 v[16:17], v1 offset:12288
  v_mfma_f32_16x16x32_bf16 v[176:179], v[20:23], a[92:95], v[176:179]
  ds_read_b64_tr_b16 v[18:19], v1 offset:12800
  s_add_u32 s72, s65, 4718592
  v_mfma_f32_16x16x32_bf16 v[104:107], v[24:27], a[88:91], v[104:107]
  ds_read_b64_tr_b16 v[20:21], v1 offset:12320
  s_mov_b32 s62, 65536
  v_mfma_f32_16x16x32_bf16 v[108:111], v[24:27], a[92:95], v[108:111]
  ds_read_b64_tr_b16 v[22:23], v1 offset:12832
  s_mov_b32 s63, 0x20000
  v_mfma_f32_16x16x32_bf16 v[192:195], v[28:31], a[88:91], v[192:195]
  ds_read_b64_tr_b16 v[24:25], v1 offset:12352
  v_add_f32 v72, v72, v76
  v_mfma_f32_16x16x32_bf16 v[200:203], v[28:31], a[92:95], v[200:203]
  ds_read_b64_tr_b16 v[26:27], v1 offset:12864
  v_add_f32 v73, v73, v77
  v_mfma_f32_16x16x32_bf16 v[52:55], a[88:91], a[88:91], v[52:55]
  s_add_u32 m0, s64, 28672
  s_waitcnt lgkmcnt(6)
  v_mfma_f32_16x16x32_bf16 v[160:163], v[32:35], a[88:91], v[160:163]
  ds_read_b64_tr_b16 v[28:29], v1 offset:12384
  v_add_f32 v74, v74, v78
  v_mfma_f32_16x16x32_bf16 v[164:167], v[32:35], a[92:95], v[164:167]
  ds_read_b64_tr_b16 v[30:31], v1 offset:12896
  v_add_f32 v75, v75, v79
  v_mfma_f32_16x16x32_bf16 v[172:175], v[36:39], a[88:91], v[172:175]
  ds_read_b64_tr_b16 v[32:33], v1 offset:13312
  ds_write_b128 v0, v[72:75]
  v_mfma_f32_16x16x32_bf16 v[180:183], v[36:39], a[92:95], v[180:183]
  ds_read_b64_tr_b16 v[34:35], v1 offset:13824
  v_mfma_f32_16x16x32_bf16 v[184:187], v[40:43], a[88:91], v[184:187]
  ds_read_b64_tr_b16 v[36:37], v1 offset:13344
  v_mfma_f32_16x16x32_bf16 v[188:191], v[40:43], a[92:95], v[188:191]
  buffer_load_dwordx4 v5, s[20:23], s72 offen offset:0 lds
  v_mfma_f32_16x16x32_bf16 v[196:199], v[44:47], a[88:91], v[196:199]
  ds_read_b64_tr_b16 v[38:39], v1 offset:13856
  ds_read_b64_tr_b16 v[40:41], v1 offset:13376
ffn_hop20:
  s_cbranch_execz ffn_hop21
  v_mfma_f32_16x16x32_bf16 v[204:207], v[44:47], a[92:95], v[204:207]
  ds_read_b64_tr_b16 v[42:43], v1 offset:13888
  v_mfma_f32_16x16x32_bf16 v[48:51], v[64:67], a[88:91], v[48:51]
  s_waitcnt lgkmcnt(7)
  v_mfma_f32_16x16x32_bf16 v[80:83], v[16:19], a[96:99], v[80:83]
  ds_read_b64_tr_b16 v[44:45], v1 offset:13408
  s_mov_b32 s73, 2228224
  v_mfma_f32_16x16x32_bf16 v[84:87], v[16:19], a[100:103], v[84:87]
  ds_read_b64_tr_b16 v[46:47], v1 offset:13920
  v_mfma_f32_16x16x32_bf16 v[120:123], v[20:23], a[96:99], v[120:123]
  buffer_load_dwordx4 v5, s[24:27], s72 offen offset:1024 lds
  v_mfma_f32_16x16x32_bf16 v[128:131], v[20:23], a[100:103], v[128:131]
  ds_read_b64_tr_b16 v[16:17], v1 offset:14336
  ds_read_b64_tr_b16 v[18:19], v1 offset:14848
  v_mfma_f32_16x16x32_bf16 v[88:91], v[24:27], a[96:99], v[88:91]
  buffer_load_dwordx4 v[248:251], v8, s[40:43], s73 offen
  v_mfma_f32_16x16x32_bf16 v[92:95], v[24:27], a[100:103], v[92:95]
  ds_read_b64_tr_b16 v[20:21], v1 offset:14368
  ds_read_b64_tr_b16 v[22:23], v1 offset:14880
  v_accvgpr_write_b32 a104, v216
  v_mfma_f32_16x16x32_bf16 v[144:147], v[28:31], a[96:99], v[144:147]
  ds_read_b64_tr_b16 v[24:25], v1 offset:14400
  s_mov_b32 s73, 2293760
  v_mfma_f32_16x16x32_bf16 v[152:155], v[28:31], a[100:103], v[152:155]
  buffer_load_dwordx4 v[252:255], v8, s[40:43], s73 offen
  v_mfma_f32_16x16x32_bf16 v[60:63], a[100:103], a[100:103], v[60:63]
  ds_read_b64_tr_b16 v[26:27], v1 offset:14912
  s_waitcnt lgkmcnt(6)
  v_mfma_f32_16x16x32_bf16 v[112:115], v[32:35], a[96:99], v[112:115]
  buffer_load_dwordx4 v6, s[20:23], s72 offen offset:2048 lds
  v_mfma_f32_16x16x32_bf16 v[116:119], v[32:35], a[100:103], v[116:119]
  ds_read_b64_tr_b16 v[28:29], v1 offset:14432
  ds_read_b64_tr_b16 v[30:31], v1 offset:14944
  v_mfma_f32_16x16x32_bf16 v[124:127], v[36:39], a[96:99], v[124:127]
  ds_read_b64_tr_b16 v[32:33], v1 offset:15360
  v_accvgpr_write_b32 a105, v217
  v_mfma_f32_16x16x32_bf16 v[132:135], v[36:39], a[100:103], v[132:135]
  ds_read_b64_tr_b16 v[34:35], v1 offset:15872
  v_accvgpr_write_b32 a108, v218
  v_mfma_f32_16x16x32_bf16 v[136:139], v[40:43], a[96:99], v[136:139]
  buffer_load_dwordx4 v6, s[24:27], s72 offen offset:3072 lds
  v_mfma_f32_16x16x32_bf16 v[140:143], v[40:43], a[100:103], v[140:143]
  ds_read_b64_tr_b16 v[36:37], v1 offset:15392
  ds_read_b64_tr_b16 v[38:39], v1 offset:15904
  v_mfma_f32_16x16x32_bf16 v[148:151], v[44:47], a[96:99], v[148:151]
  ds_read_b64_tr_b16 v[40:41], v1 offset:15424
  v_accvgpr_write_b32 a109, v219
  v_mfma_f32_16x16x32_bf16 v[156:159], v[44:47], a[100:103], v[156:159]
  ds_read_b64_tr_b16 v[42:43], v1 offset:15936
  v_accvgpr_write_b32 a106, v220
  v_mfma_f32_16x16x32_bf16 v[56:59], v[64:67], a[100:103], v[56:59]
  v_accvgpr_write_b32 a107, v221
  s_waitcnt lgkmcnt(6)
  v_mfma_f32_16x16x32_bf16 v[96:99], v[16:19], a[96:99], v[96:99]
  ds_read_b64_tr_b16 v[44:45], v1 offset:15456
  v_accvgpr_write_b32 a110, v222
  v_mfma_f32_16x16x32_bf16 v[100:103], v[16:19], a[100:103], v[100:103]
  ds_read_b64_tr_b16 v[46:47], v1 offset:15968
  s_add_u32 s72, s65, 5013504
  v_mfma_f32_16x16x32_bf16 v[168:171], v[20:23], a[96:99], v[168:171]
  ds_read_b64_tr_b16 v[16:17], v1 offset:16384
  v_accvgpr_write_b32 a111, v223
  v_mfma_f32_16x16x32_bf16 v[176:179], v[20:23], a[100:103], v[176:179]
  ds_read_b64_tr_b16 v[18:19], v1 offset:16896
  v_mfma_f32_16x16x32_bf16 v[104:107], v[24:27], a[96:99], v[104:107]
ffn_hop21:
  s_cbranch_execz ffn_hop22
  ds_read_b64_tr_b16 v[20:21], v1 offset:16416
  v_mfma_f32_16x16x32_bf16 v[108:111], v[24:27], a[100:103], v[108:111]
  ds_read_b64_tr_b16 v[22:23], v1 offset:16928
  v_mfma_f32_16x16x32_bf16 v[192:195], v[28:31], a[96:99], v[192:195]
  ds_read_b64_tr_b16 v[24:25], v1 offset:16448
  v_mfma_f32_16x16x32_bf16 v[200:203], v[28:31], a[100:103], v[200:203]
  ds_read_b64_tr_b16 v[26:27], v1 offset:16960
  s_add_u32 m0, s64, 32768
  v_mfma_f32_16x16x32_bf16 v[52:55], a[96:99], a[96:99], v[52:55]
  s_waitcnt lgkmcnt(6)
  v_mfma_f32_16x16x32_bf16 v[160:163], v[32:35], a[96:99], v[160:163]
  ds_read_b64_tr_b16 v[28:29], v1 offset:16480
  v_mfma_f32_16x16x32_bf16 v[164:167], v[32:35], a[100:103], v[164:167]
  ds_read_b64_tr_b16 v[30:31], v1 offset:16992
  v_mfma_f32_16x16x32_bf16 v[172:175], v[36:39], a[96:99], v[172:175]
  ds_read_b64_tr_b16 v[32:33], v1 offset:17408
  v_mfma_f32_16x16x32_bf16 v[180:183], v[36:39], a[100:103], v[180:183]
  ds_read_b64_tr_b16 v[34:35], v1 offset:17920
  v_mfma_f32_16x16x32_bf16 v[184:187], v[40:43], a[96:99], v[184:187]
  buffer_load_dwordx4 v5, s[20:23], s72 offen offset:0 lds
  v_mfma_f32_16x16x32_bf16 v[188:191], v[40:43], a[100:103], v[188:191]
  ds_read_b64_tr_b16 v[36:37], v1 offset:17440
  ds_read_b64_tr_b16 v[38:39], v1 offset:17952
  v_mfma_f32_16x16x32_bf16 v[196:199], v[44:47], a[96:99], v[196:199]
  ds_read_b64_tr_b16 v[40:41], v1 offset:17472
  v_mfma_f32_16x16x32_bf16 v[204:207], v[44:47], a[100:103], v[204:207]
  ds_read_b64_tr_b16 v[42:43], v1 offset:17984
  v_mfma_f32_16x16x32_bf16 v[48:51], v[64:67], a[96:99], v[48:51]
  s_waitcnt lgkmcnt(6)
  v_mfma_f32_16x16x32_bf16 v[80:83], v[16:19], a[104:107], v[80:83]
  buffer_load_dwordx4 v5, s[24:27], s72 offen offset:1024 lds
  v_mfma_f32_16x16x32_bf16 v[84:87], v[16:19], a[108:111], v[84:87]
  ds_read_b64_tr_b16 v[44:45], v1 offset:17504
  ds_read_b64_tr_b16 v[46:47], v1 offset:18016
  v_mfma_f32_16x16x32_bf16 v[120:123], v[20:23], a[104:107], v[120:123]
  ds_read_b64_tr_b16 v[16:17], v1 offset:18432
  v_mfma_f32_16x16x32_bf16 v[128:131], v[20:23], a[108:111], v[128:131]
  ds_read_b64_tr_b16 v[18:19], v1 offset:18944
  v_mfma_f32_16x16x32_bf16 v[88:91], v[24:27], a[104:107], v[88:91]
  ds_read_b64_tr_b16 v[20:21], v1 offset:18464
  v_mfma_f32_16x16x32_bf16 v[92:95], v[24:27], a[108:111], v[92:95]
  ds_read_b64_tr_b16 v[22:23], v1 offset:18976
  v_accvgpr_write_b32 a112, v224
  v_mfma_f32_16x16x32_bf16 v[144:147], v[28:31], a[104:107], v[144:147]
  buffer_load_dwordx4 v6, s[20:23], s72 offen offset:2048 lds
  v_mfma_f32_16x16x32_bf16 v[152:155], v[28:31], a[108:111], v[152:155]
  ds_read_b64_tr_b16 v[24:25], v1 offset:18496
  ds_read_b64_tr_b16 v[26:27], v1 offset:19008
  v_mfma_f32_16x16x32_bf16 v[60:63], a[108:111], a[108:111], v[60:63]
  v_accvgpr_write_b32 a113, v225
  s_waitcnt lgkmcnt(6)
  v_mfma_f32_16x16x32_bf16 v[112:115], v[32:35], a[104:107], v[112:115]
  ds_read_b64_tr_b16 v[28:29], v1 offset:18528
  v_accvgpr_write_b32 a116, v226
  v_mfma_f32_16x16x32_bf16 v[116:119], v[32:35], a[108:111], v[116:119]
  ds_read_b64_tr_b16 v[30:31], v1 offset:19040
  v_accvgpr_write_b32 a117, v227
  v_mfma_f32_16x16x32_bf16 v[124:127], v[36:39], a[104:107], v[124:127]
  ds_read_b64_tr_b16 v[32:33], v1 offset:19456
  v_accvgpr_write_b32 a114, v228
  v_mfma_f32_16x16x32_bf16 v[132:135], v[36:39], a[108:111], v[132:135]
  buffer_load_dwordx4 v6, s[24:27], s72 offen offset:3072 lds
  v_mfma_f32_16x16x32_bf16 v[136:139], v[40:43], a[104:107], v[136:139]
  ds_read_b64_tr_b16 v[34:35], v1 offset:19968
  ds_read_b64_tr_b16 v[36:37], v1 offset:19488
ffn_hop22:
  s_cbranch_execz ffn_hop23
  v_mfma_f32_16x16x32_bf16 v[140:143], v[40:43], a[108:111], v[140:143]
  ds_read_b64_tr_b16 v[38:39], v1 offset:20000
  v_accvgpr_write_b32 a115, v229
  v_mfma_f32_16x16x32_bf16 v[148:151], v[44:47], a[104:107], v[148:151]
  ds_read_b64_tr_b16 v[40:41], v1 offset:19520
  v_accvgpr_write_b32 a118, v230
  v_mfma_f32_16x16x32_bf16 v[156:159], v[44:47], a[108:111], v[156:159]
  ds_read_b64_tr_b16 v[42:43], v1 offset:20032
  v_accvgpr_write_b32 a119, v231
  v_mfma_f32_16x16x32_bf16 v[56:59], v[64:67], a[108:111], v[56:59]
  s_waitcnt lgkmcnt(6)
  v_mfma_f32_16x16x32_bf16 v[96:99], v[16:19], a[104:107], v[96:99]
  ds_read_b64_tr_b16 v[44:45], v1 offset:19552
  v_mfma_f32_16x16x32_bf16 v[100:103], v[16:19], a[108:111], v[100:103]
  ds_read_b64_tr_b16 v[46:47], v1 offset:20064
  v_mfma_f32_16x16x32_bf16 v[168:171], v[20:23], a[104:107], v[168:171]
  s_waitcnt vmcnt(10)
  s_barrier
  ds_read_b64_tr_b16 v[16:17], v1 offset:20480
  v_mfma_f32_16x16x32_bf16 v[176:179], v[20:23], a[108:111], v[176:179]
  ds_read_b64_tr_b16 v[18:19], v1 offset:20992
  s_add_u32 s72, s65, 256
  v_mfma_f32_16x16x32_bf16 v[104:107], v[24:27], a[104:107], v[104:107]
  ds_read_b64_tr_b16 v[20:21], v1 offset:20512
  v_mfma_f32_16x16x32_bf16 v[108:111], v[24:27], a[108:111], v[108:111]
  ds_read_b64_tr_b16 v[22:23], v1 offset:21024
  v_mfma_f32_16x16x32_bf16 v[192:195], v[28:31], a[104:107], v[192:195]
  ds_read_b64_tr_b16 v[24:25], v1 offset:20544
  s_add_u32 m0, s64, 0
  v_mfma_f32_16x16x32_bf16 v[200:203], v[28:31], a[108:111], v[200:203]
  ds_read_b64_tr_b16 v[26:27], v1 offset:21056
  v_mfma_f32_16x16x32_bf16 v[52:55], a[104:107], a[104:107], v[52:55]
  s_waitcnt lgkmcnt(6)
  v_mfma_f32_16x16x32_bf16 v[160:163], v[32:35], a[104:107], v[160:163]
  buffer_load_dwordx4 v5, s[20:23], s72 offen offset:0 lds
  v_mfma_f32_16x16x32_bf16 v[164:167], v[32:35], a[108:111], v[164:167]
  ds_read_b64_tr_b16 v[28:29], v1 offset:20576
  ds_read_b64_tr_b16 v[30:31], v1 offset:21088
  v_mfma_f32_16x16x32_bf16 v[172:175], v[36:39], a[104:107], v[172:175]
  ds_read_b64_tr_b16 v[32:33], v1 offset:21504
  v_mfma_f32_16x16x32_bf16 v[180:183], v[36:39], a[108:111], v[180:183]
  ds_read_b64_tr_b16 v[34:35], v1 offset:22016
  v_mfma_f32_16x16x32_bf16 v[184:187], v[40:43], a[104:107], v[184:187]
  buffer_load_dwordx4 v5, s[24:27], s72 offen offset:1024 lds
  v_mfma_f32_16x16x32_bf16 v[188:191], v[40:43], a[108:111], v[188:191]
  ds_read_b64_tr_b16 v[36:37], v1 offset:21536
  ds_read_b64_tr_b16 v[38:39], v1 offset:22048
  v_mfma_f32_16x16x32_bf16 v[196:199], v[44:47], a[104:107], v[196:199]
  ds_read_b64_tr_b16 v[40:41], v1 offset:21568
  v_mfma_f32_16x16x32_bf16 v[204:207], v[44:47], a[108:111], v[204:207]
  buffer_load_dwordx4 v7, s[28:31], s72 offen offset:2048 lds
  v_mfma_f32_16x16x32_bf16 v[48:51], v[64:67], a[104:107], v[48:51]
  ds_read_b64_tr_b16 v[42:43], v1 offset:22080
  s_waitcnt lgkmcnt(6)
  v_mfma_f32_16x16x32_bf16 v[80:83], v[16:19], a[112:115], v[80:83]
  ds_read_b64_tr_b16 v[44:45], v1 offset:21600
  v_mfma_f32_16x16x32_bf16 v[84:87], v[16:19], a[116:119], v[84:87]
  ds_read_b64_tr_b16 v[46:47], v1 offset:22112
  v_mfma_f32_16x16x32_bf16 v[120:123], v[20:23], a[112:115], v[120:123]
  ds_read_b64_tr_b16 v[16:17], v1 offset:22528
  s_add_u32 s72, s65, 295168
  v_mfma_f32_16x16x32_bf16 v[128:131], v[20:23], a[116:119], v[128:131]
ffn_hop23:
  s_cbranch_execz ffn_hopret
  ds_read_b64_tr_b16 v[18:19], v1 offset:23040
  v_mfma_f32_16x16x32_bf16 v[88:91], v[24:27], a[112:115], v[88:91]
  ds_read_b64_tr_b16 v[20:21], v1 offset:22560
  v_mfma_f32_16x16x32_bf16 v[92:95], v[24:27], a[116:119], v[92:95]
  ds_read_b64_tr_b16 v[22:23], v1 offset:23072
  s_add_u32 m0, s64, 3072
  v_mfma_f32_16x16x32_bf16 v[144:147], v[28:31], a[112:115], v[144:147]
  ds_read_b64_tr_b16 v[24:25], v1 offset:22592
  v_accvgpr_write_b32 a120, v232
  v_mfma_f32_16x16x32_bf16 v[152:155], v[28:31], a[116:119], v[152:155]
  ds_read_b64_tr_b16 v[26:27], v1 offset:23104
  v_accvgpr_write_b32 a121, v233
  v_mfma_f32_16x16x32_bf16 v[60:63], a[116:119], a[116:119], v[60:63]
  v_accvgpr_write_b32 a124, v234
  s_waitcnt lgkmcnt(6)
  v_mfma_f32_16x16x32_bf16 v[112:115], v[32:35], a[112:115], v[112:115]
  buffer_load_dwordx4 v5, s[20:23], s72 offen offset:0 lds
  v_mfma_f32_16x16x32_bf16 v[116:119], v[32:35], a[116:119], v[116:119]
  ds_read_b64_tr_b16 v[28:29], v1 offset:22624
  ds_read_b64_tr_b16 v[30:31], v1 offset:23136
  v_mfma_f32_16x16x32_bf16 v[124:127], v[36:39], a[112:115], v[124:127]
  ds_read_b64_tr_b16 v[32:33], v1 offset:23552
  v_accvgpr_write_b32 a125, v235
  v_mfma_f32_16x16x32_bf16 v[132:135], v[36:39], a[116:119], v[132:135]
  buffer_load_dwordx4 v5, s[24:27], s72 offen offset:1024 lds
  v_mfma_f32_16x16x32_bf16 v[136:139], v[40:43], a[112:115], v[136:139]
  ds_read_b64_tr_b16 v[34:35], v1 offset:24064
  ds_read_b64_tr_b16 v[36:37], v1 offset:23584
  v_mfma_f32_16x16x32_bf16 v[140:143], v[40:43], a[116:119], v[140:143]
  ds_read_b64_tr_b16 v[38:39], v1 offset:24096
  v_accvgpr_write_b32 a122, v236
  v_mfma_f32_16x16x32_bf16 v[148:151], v[44:47], a[112:115], v[148:151]
  ds_read_b64_tr_b16 v[40:41], v1 offset:23616
  v_accvgpr_write_b32 a123, v237
  v_mfma_f32_16x16x32_bf16 v[156:159], v[44:47], a[116:119], v[156:159]
  buffer_load_dwordx4 v7, s[28:31], s72 offen offset:2048 lds
  v_mfma_f32_16x16x32_bf16 v[56:59], v[64:67], a[116:119], v[56:59]
  ds_read_b64_tr_b16 v[42:43], v1 offset:24128
  s_waitcnt lgkmcnt(6)
  v_mfma_f32_16x16x32_bf16 v[96:99], v[16:19], a[112:115], v[96:99]
  ds_read_b64_tr_b16 v[44:45], v1 offset:23648
  v_accvgpr_write_b32 a126, v238
  v_mfma_f32_16x16x32_bf16 v[100:103], v[16:19], a[116:119], v[100:103]
  ds_read_b64_tr_b16 v[46:47], v1 offset:24160
  s_add_u32 s72, s65, 590080
  v_mfma_f32_16x16x32_bf16 v[168:171], v[20:23], a[112:115], v[168:171]
  ds_read_b64_tr_b16 v[16:17], v1 offset:24576
  v_accvgpr_write_b32 a127, v239
  v_mfma_f32_16x16x32_bf16 v[176:179], v[20:23], a[116:119], v[176:179]
  ds_read_b64_tr_b16 v[18:19], v1 offset:25088
  v_mfma_f32_16x16x32_bf16 v[104:107], v[24:27], a[112:115], v[104:107]
  ds_read_b64_tr_b16 v[20:21], v1 offset:24608
  s_add_u32 m0, s64, 6144
  v_mfma_f32_16x16x32_bf16 v[108:111], v[24:27], a[116:119], v[108:111]
  ds_read_b64_tr_b16 v[22:23], v1 offset:25120
  v_mfma_f32_16x16x32_bf16 v[192:195], v[28:31], a[112:115], v[192:195]
  ds_read_b64_tr_b16 v[24:25], v1 offset:24640
  v_mfma_f32_16x16x32_bf16 v[200:203], v[28:31], a[116:119], v[200:203]
  ds_read_b64_tr_b16 v[26:27], v1 offset:25152
  v_mfma_f32_16x16x32_bf16 v[52:55], a[112:115], a[112:115], v[52:55]
  s_waitcnt lgkmcnt(6)
  v_mfma_f32_16x16x32_bf16 v[160:163], v[32:35], a[112:115], v[160:163]
  buffer_load_dwordx4 v5, s[20:23], s72 offen offset:0 lds
  v_mfma_f32_16x16x32_bf16 v[164:167], v[32:35], a[116:119], v[164:167]
  ds_read_b64_tr_b16 v[28:29], v1 offset:24672
ffn_hopq1:
ffn_hop24:
  s_cbranch_execz ffn_hop25
  ds_read_b64_tr_b16 v[30:31], v1 offset:25184
  v_mfma_f32_16x16x32_bf16 v[172:175], v[36:39], a[112:115], v[172:175]
  buffer_load_dwordx4 v5, s[24:27], s72 offen offset:1024 lds
  v_mfma_f32_16x16x32_bf16 v[180:183], v[36:39], a[116:119], v[180:183]
  ds_read_b64_tr_b16 v[32:33], v1 offset:25600
  ds_read_b64_tr_b16 v[34:35], v1 offset:26112
  v_mfma_f32_16x16x32_bf16 v[184:187], v[40:43], a[112:115], v[184:187]
  ds_read_b64_tr_b16 v[36:37], v1 offset:25632
  v_mfma_f32_16x16x32_bf16 v[188:191], v[40:43], a[116:119], v[188:191]
  ds_read_b64_tr_b16 v[38:39], v1 offset:26144
  v_mfma_f32_16x16x32_bf16 v[196:199], v[44:47], a[112:115], v[196:199]
  buffer_load_dwordx4 v7, s[28:31], s72 offen offset:2048 lds
  v_mfma_f32_16x16x32_bf16 v[204:207], v[44:47], a[116:119], v[204:207]
  ds_read_b64_tr_b16 v[40:41], v1 offset:25664
  ds_read_b64_tr_b16 v[42:43], v1 offset:26176
  v_mfma_f32_16x16x32_bf16 v[48:51], v[64:67], a[112:115], v[48:51]
  s_waitcnt lgkmcnt(6)
  v_mfma_f32_16x16x32_bf16 v[80:83], v[16:19], a[120:123], v[80:83]
  ds_read_b64_tr_b16 v[44:45], v1 offset:25696
  s_add_u32 s72, s65, 884992
  v_mfma_f32_16x16x32_bf16 v[84:87], v[16:19], a[124:127], v[84:87]
  ds_read_b64_tr_b16 v[46:47], v1 offset:26208
  v_mfma_f32_16x16x32_bf16 v[120:123], v[20:23], a[120:123], v[120:123]
  ds_read_b64_tr_b16 v[16:17], v1 offset:26624
  v_mfma_f32_16x16x32_bf16 v[128:131], v[20:23], a[124:127], v[128:131]
  ds_read_b64_tr_b16 v[18:19], v1 offset:27136
  v_mfma_f32_16x16x32_bf16 v[88:91], v[24:27], a[120:123], v[88:91]
  ds_read_b64_tr_b16 v[20:21], v1 offset:26656
  s_add_u32 m0, s64, 9216
  v_mfma_f32_16x16x32_bf16 v[92:95], v[24:27], a[124:127], v[92:95]
  ds_read_b64_tr_b16 v[22:23], v1 offset:27168
  v_mfma_f32_16x16x32_bf16 v[144:147], v[28:31], a[120:123], v[144:147]
  ds_read_b64_tr_b16 v[24:25], v1 offset:26688
  v_accvgpr_write_b32 a128, v240
  v_mfma_f32_16x16x32_bf16 v[152:155], v[28:31], a[124:127], v[152:155]
  buffer_load_dwordx4 v5, s[20:23], s72 offen offset:0 lds
  v_mfma_f32_16x16x32_bf16 v[60:63], a[124:127], a[124:127], v[60:63]
  ds_read_b64_tr_b16 v[26:27], v1 offset:27200
  s_waitcnt lgkmcnt(6)
  v_mfma_f32_16x16x32_bf16 v[112:115], v[32:35], a[120:123], v[112:115]
  ds_read_b64_tr_b16 v[28:29], v1 offset:26720
  v_accvgpr_write_b32 a129, v241
  v_mfma_f32_16x16x32_bf16 v[116:119], v[32:35], a[124:127], v[116:119]
  ds_read_b64_tr_b16 v[30:31], v1 offset:27232
  v_accvgpr_write_b32 a132, v242
  v_mfma_f32_16x16x32_bf16 v[124:127], v[36:39], a[120:123], v[124:127]
  buffer_load_dwordx4 v5, s[24:27], s72 offen offset:1024 lds
  v_mfma_f32_16x16x32_bf16 v[132:135], v[36:39], a[124:127], v[132:135]
  ds_read_b64_tr_b16 v[32:33], v1 offset:27648
  ds_read_b64_tr_b16 v[34:35], v1 offset:28160
  v_mfma_f32_16x16x32_bf16 v[136:139], v[40:43], a[120:123], v[136:139]
  ds_read_b64_tr_b16 v[36:37], v1 offset:27680
  v_accvgpr_write_b32 a133, v243
  v_mfma_f32_16x16x32_bf16 v[140:143], v[40:43], a[124:127], v[140:143]
  buffer_load_dwordx4 v7, s[28:31], s72 offen offset:2048 lds
  v_mfma_f32_16x16x32_bf16 v[148:151], v[44:47], a[120:123], v[148:151]
  ds_read_b64_tr_b16 v[38:39], v1 offset:28192
  ds_read_b64_tr_b16 v[40:41], v1 offset:27712
  v_mfma_f32_16x16x32_bf16 v[156:159], v[44:47], a[124:127], v[156:159]
  ds_read_b64_tr_b16 v[42:43], v1 offset:28224
  v_accvgpr_write_b32 a130, v244
  v_mfma_f32_16x16x32_bf16 v[56:59], v[64:67], a[124:127], v[56:59]
  v_accvgpr_write_b32 a131, v245
  s_waitcnt lgkmcnt(6)
  v_mfma_f32_16x16x32_bf16 v[96:99], v[16:19], a[120:123], v[96:99]
  ds_read_b64_tr_b16 v[44:45], v1 offset:27744
  v_accvgpr_write_b32 a134, v246
  v_mfma_f32_16x16x32_bf16 v[100:103], v[16:19], a[124:127], v[100:103]
  ds_read_b64_tr_b16 v[46:47], v1 offset:28256
ffn_hop25:
  s_cbranch_execz ffn_hop26
  v_accvgpr_write_b32 a135, v247
  v_mfma_f32_16x16x32_bf16 v[168:171], v[20:23], a[120:123], v[168:171]
  s_waitcnt vmcnt(12)
  s_barrier
  ds_read_b64_tr_b16 v[16:17], v1 offset:28672
  v_mfma_f32_16x16x32_bf16 v[176:179], v[20:23], a[124:127], v[176:179]
  ds_read_b64_tr_b16 v[18:19], v1 offset:29184
  s_add_u32 s72, s65, 1179904
  v_mfma_f32_16x16x32_bf16 v[104:107], v[24:27], a[120:123], v[104:107]
  ds_read_b64_tr_b16 v[20:21], v1 offset:28704
  v_mfma_f32_16x16x32_bf16 v[108:111], v[24:27], a[124:127], v[108:111]
  ds_read_b64_tr_b16 v[22:23], v1 offset:29216
  v_mfma_f32_16x16x32_bf16 v[192:195], v[28:31], a[120:123], v[192:195]
  ds_read_b64_tr_b16 v[24:25], v1 offset:28736
  v_mfma_f32_16x16x32_bf16 v[200:203], v[28:31], a[124:127], v[200:203]
  ds_read_b64_tr_b16 v[26:27], v1 offset:29248
  v_mfma_f32_16x16x32_bf16 v[52:55], a[120:123], a[120:123], v[52:55]
  s_waitcnt lgkmcnt(6)
  v_mfma_f32_16x16x32_bf16 v[160:163], v[32:35], a[120:123], v[160:163]
  ds_read_b64_tr_b16 v[28:29], v1 offset:28768
  s_add_u32 m0, s64, 12288
  v_mfma_f32_16x16x32_bf16 v[164:167], v[32:35], a[124:127], v[164:167]
  ds_read_b64_tr_b16 v[30:31], v1 offset:29280
  v_mfma_f32_16x16x32_bf16 v[172:175], v[36:39], a[120:123], v[172:175]
  ds_read_b64_tr_b16 v[32:33], v1 offset:29696
  v_mfma_f32_16x16x32_bf16 v[180:183], v[36:39], a[124:127], v[180:183]
  ds_read_b64_tr_b16 v[34:35], v1 offset:30208
  v_mfma_f32_16x16x32_bf16 v[184:187], v[40:43], a[120:123], v[184:187]
  ds_read_b64_tr_b16 v[36:37], v1 offset:29728
  v_mfma_f32_16x16x32_bf16 v[188:191], v[40:43], a[124:127], v[188:191]
  ds_read_b64_tr_b16 v[38:39], v1 offset:30240
  v_mfma_f32_16x16x32_bf16 v[196:199], v[44:47], a[120:123], v[196:199]
  ds_read_b64_tr_b16 v[40:41], v1 offset:29760
  v_mfma_f32_16x16x32_bf16 v[204:207], v[44:47], a[124:127], v[204:207]
  buffer_load_dwordx4 v5, s[20:23], s72 offen offset:0 lds
  v_mfma_f32_16x16x32_bf16 v[48:51], v[64:67], a[120:123], v[48:51]
  ds_read_b64_tr_b16 v[42:43], v1 offset:30272
  s_waitcnt lgkmcnt(6)
  v_mfma_f32_16x16x32_bf16 v[80:83], v[16:19], a[128:131], v[80:83]
  ds_read_b64_tr_b16 v[44:45], v1 offset:29792
  v_mfma_f32_16x16x32_bf16 v[84:87], v[16:19], a[132:135], v[84:87]
  ds_read_b64_tr_b16 v[46:47], v1 offset:30304
  v_mfma_f32_16x16x32_bf16 v[120:123], v[20:23], a[128:131], v[120:123]
  ds_read_b64_tr_b16 v[16:17], v1 offset:30720
  v_mfma_f32_16x16x32_bf16 v[128:131], v[20:23], a[132:135], v[128:131]
  ds_read_b64_tr_b16 v[18:19], v1 offset:31232
  v_mfma_f32_16x16x32_bf16 v[88:91], v[24:27], a[128:131], v[88:91]
  ds_read_b64_tr_b16 v[20:21], v1 offset:30752
  v_mfma_f32_16x16x32_bf16 v[92:95], v[24:27], a[132:135], v[92:95]
  buffer_load_dwordx4 v5, s[24:27], s72 offen offset:1024 lds
  v_mfma_f32_16x16x32_bf16 v[144:147], v[28:31], a[128:131], v[144:147]
  ds_read_b64_tr_b16 v[22:23], v1 offset:31264
  ds_read_b64_tr_b16 v[24:25], v1 offset:30784
  v_mfma_f32_16x16x32_bf16 v[152:155], v[28:31], a[132:135], v[152:155]
  ds_read_b64_tr_b16 v[26:27], v1 offset:31296
  v_accvgpr_write_b32 a136, v248
  v_mfma_f32_16x16x32_bf16 v[60:63], a[132:135], a[132:135], v[60:63]
  v_accvgpr_write_b32 a137, v249
  s_waitcnt lgkmcnt(6)
  v_mfma_f32_16x16x32_bf16 v[112:115], v[32:35], a[128:131], v[112:115]
  ds_read_b64_tr_b16 v[28:29], v1 offset:30816
  v_accvgpr_write_b32 a140, v250
ffn_hop26:
  s_cbranch_execz ffn_hop27
  v_mfma_f32_16x16x32_bf16 v[116:119], v[32:35], a[132:135], v[116:119]
  ds_read_b64_tr_b16 v[30:31], v1 offset:31328
  v_accvgpr_write_b32 a141, v251
  v_mfma_f32_16x16x32_bf16 v[124:127], v[36:39], a[128:131], v[124:127]
  ds_read_b64_tr_b16 v[32:33], v1 offset:31744
  v_accvgpr_write_b32 a138, v252
  v_mfma_f32_16x16x32_bf16 v[132:135], v[36:39], a[132:135], v[132:135]
  buffer_load_dwordx4 v7, s[28:31], s72 offen offset:2048 lds
  v_mfma_f32_16x16x32_bf16 v[136:139], v[40:43], a[128:131], v[136:139]
  ds_read_b64_tr_b16 v[34:35], v1 offset:32256
  ds_read_b64_tr_b16 v[36:37], v1 offset:31776
  v_mfma_f32_16x16x32_bf16 v[140:143], v[40:43], a[132:135], v[140:143]
  ds_read_b64_tr_b16 v[38:39], v1 offset:32288
  v_accvgpr_write_b32 a139, v253
  v_mfma_f32_16x16x32_bf16 v[148:151], v[44:47], a[128:131], v[148:151]
  ds_read_b64_tr_b16 v[40:41], v1 offset:31808
  v_accvgpr_write_b32 a142, v254
  v_mfma_f32_16x16x32_bf16 v[156:159], v[44:47], a[132:135], v[156:159]
  ds_read_b64_tr_b16 v[42:43], v1 offset:32320
  v_accvgpr_write_b32 a143, v255
  v_mfma_f32_16x16x32_bf16 v[56:59], v[64:67], a[132:135], v[56:59]
  s_waitcnt lgkmcnt(6)
  v_mfma_f32_16x16x32_bf16 v[96:99], v[16:19], a[128:131], v[96:99]
  ds_read_b64_tr_b16 v[44:45], v1 offset:31840
  v_mfma_f32_16x16x32_bf16 v[100:103], v[16:19], a[132:135], v[100:103]
  ds_read_b64_tr_b16 v[46:47], v1 offset:32352
  s_add_u32 s72, s65, 1474816
  v_mfma_f32_16x16x32_bf16 v[168:171], v[20:23], a[128:131], v[168:171]
  ds_read_b64_tr_b16 v[16:17], v1 offset:32768
  v_mfma_f32_16x16x32_bf16 v[176:179], v[20:23], a[132:135], v[176:179]
  ds_read_b64_tr_b16 v[18:19], v1 offset:33280
  v_mfma_f32_16x16x32_bf16 v[104:107], v[24:27], a[128:131], v[104:107]
  ds_read_b64_tr_b16 v[20:21], v1 offset:32800
  v_mfma_f32_16x16x32_bf16 v[108:111], v[24:27], a[132:135], v[108:111]
  ds_read_b64_tr_b16 v[22:23], v1 offset:33312
  v_mfma_f32_16x16x32_bf16 v[192:195], v[28:31], a[128:131], v[192:195]
  ds_read_b64_tr_b16 v[24:25], v1 offset:32832
  v_mfma_f32_16x16x32_bf16 v[200:203], v[28:31], a[132:135], v[200:203]
  ds_read_b64_tr_b16 v[26:27], v1 offset:33344
  v_mfma_f32_16x16x32_bf16 v[52:55], a[128:131], a[128:131], v[52:55]
  s_add_u32 m0, s64, 15360
  s_waitcnt lgkmcnt(6)
  v_mfma_f32_16x16x32_bf16 v[160:163], v[32:35], a[128:131], v[160:163]
  ds_read_b64_tr_b16 v[28:29], v1 offset:32864
  v_mfma_f32_16x16x32_bf16 v[164:167], v[32:35], a[132:135], v[164:167]
  ds_read_b64_tr_b16 v[30:31], v1 offset:33376
  v_mfma_f32_16x16x32_bf16 v[172:175], v[36:39], a[128:131], v[172:175]
  ds_read_b64_tr_b16 v[32:33], v1 offset:33792
  v_mfma_f32_16x16x32_bf16 v[180:183], v[36:39], a[132:135], v[180:183]
  ds_read_b64_tr_b16 v[34:35], v1 offset:34304
  v_mfma_f32_16x16x32_bf16 v[184:187], v[40:43], a[128:131], v[184:187]
  ds_read_b64_tr_b16 v[36:37], v1 offset:33824
  v_mfma_f32_16x16x32_bf16 v[188:191], v[40:43], a[132:135], v[188:191]
  ds_read_b64_tr_b16 v[38:39], v1 offset:34336
  v_mfma_f32_16x16x32_bf16 v[196:199], v[44:47], a[128:131], v[196:199]
  buffer_load_dwordx4 v5, s[20:23], s72 offen offset:0 lds
  v_mfma_f32_16x16x32_bf16 v[204:207], v[44:47], a[132:135], v[204:207]
  ds_read_b64_tr_b16 v[40:41], v1 offset:33856
  ds_read_b64_tr_b16 v[42:43], v1 offset:34368
  v_mfma_f32_16x16x32_bf16 v[48:51], v[64:67], a[128:131], v[48:51]
  s_waitcnt lgkmcnt(6)
  v_mfma_f32_16x16x32_bf16 v[80:83], v[16:19], a[136:139], v[80:83]
  ds_read_b64_tr_b16 v[44:45], v1 offset:33888
  v_mfma_f32_16x16x32_bf16 v[84:87], v[16:19], a[140:143], v[84:87]
  ds_read_b64_tr_b16 v[46:47], v1 offset:34400
ffn_hop27:
  s_cbranch_execz ffn_hop28
  v_mfma_f32_16x16x32_bf16 v[120:123], v[20:23], a[136:139], v[120:123]
  ds_read_b64_tr_b16 v[16:17], v1 offset:34816
  v_mfma_f32_16x16x32_bf16 v[128:131], v[20:23], a[140:143], v[128:131]
  ds_read_b64_tr_b16 v[18:19], v1 offset:35328
  v_mfma_f32_16x16x32_bf16 v[88:91], v[24:27], a[136:139], v[88:91]
  buffer_load_dwordx4 v5, s[24:27], s72 offen offset:1024 lds
  v_mfma_f32_16x16x32_bf16 v[92:95], v[24:27], a[140:143], v[92:95]
  ds_read_b64_tr_b16 v[20:21], v1 offset:34848
  ds_read_b64_tr_b16 v[22:23], v1 offset:35360
  v_mfma_f32_16x16x32_bf16 v[144:147], v[28:31], a[136:139], v[144:147]
  ds_read_b64_tr_b16 v[24:25], v1 offset:34880
  v_mfma_f32_16x16x32_bf16 v[152:155], v[28:31], a[140:143], v[152:155]
  ds_read_b64_tr_b16 v[26:27], v1 offset:35392
  v_mfma_f32_16x16x32_bf16 v[60:63], a[140:143], a[140:143], v[60:63]
  s_waitcnt lgkmcnt(6)
  v_mfma_f32_16x16x32_bf16 v[112:115], v[32:35], a[136:139], v[112:115]
  ds_read_b64_tr_b16 v[28:29], v1 offset:34912
  v_mfma_f32_16x16x32_bf16 v[116:119], v[32:35], a[140:143], v[116:119]
  ds_read_b64_tr_b16 v[30:31], v1 offset:35424
  v_mfma_f32_16x16x32_bf16 v[124:127], v[36:39], a[136:139], v[124:127]
  buffer_load_dwordx4 v7, s[28:31], s72 offen offset:2048 lds
  v_mfma_f32_16x16x32_bf16 v[132:135], v[36:39], a[140:143], v[132:135]
  ds_read_b64_tr_b16 v[32:33], v1 offset:35840
  ds_read_b64_tr_b16 v[34:35], v1 offset:36352
  v_mfma_f32_16x16x32_bf16 v[136:139], v[40:43], a[136:139], v[136:139]
  ds_read_b64_tr_b16 v[36:37], v1 offset:35872
  v_mfma_f32_16x16x32_bf16 v[140:143], v[40:43], a[140:143], v[140:143]
  ds_read_b64_tr_b16 v[38:39], v1 offset:36384
  v_mfma_f32_16x16x32_bf16 v[148:151], v[44:47], a[136:139], v[148:151]
  ds_read_b64_tr_b16 v[40:41], v1 offset:35904
  v_mfma_f32_16x16x32_bf16 v[156:159], v[44:47], a[140:143], v[156:159]
  ds_read_b64_tr_b16 v[42:43], v1 offset:36416
  v_lshlrev_b32 v8, 4, v68
  v_mfma_f32_16x16x32_bf16 v[56:59], v[64:67], a[140:143], v[56:59]
  s_waitcnt lgkmcnt(6)
  v_mfma_f32_16x16x32_bf16 v[96:99], v[16:19], a[136:139], v[96:99]
  ds_read_b64_tr_b16 v[44:45], v1 offset:35936
  v_mfma_f32_16x16x32_bf16 v[100:103], v[16:19], a[140:143], v[100:103]
  ds_read_b64_tr_b16 v[46:47], v1 offset:36448
  v_mfma_f32_16x16x32_bf16 v[168:171], v[20:23], a[136:139], v[168:171]
  s_waitcnt vmcnt(9)
  s_barrier
  ds_read_b64_tr_b16 v[16:17], v1 offset:0
  v_mfma_f32_16x16x32_bf16 v[176:179], v[20:23], a[140:143], v[176:179]
  ds_read_b64_tr_b16 v[18:19], v1 offset:512
  s_add_u32 s72, s65, 1769728
  v_mfma_f32_16x16x32_bf16 v[104:107], v[24:27], a[136:139], v[104:107]
  ds_read_b64_tr_b16 v[20:21], v1 offset:32
  v_mfma_f32_16x16x32_bf16 v[108:111], v[24:27], a[140:143], v[108:111]
  ds_read_b64_tr_b16 v[22:23], v1 offset:544
  v_mfma_f32_16x16x32_bf16 v[192:195], v[28:31], a[136:139], v[192:195]
  ds_read_b64_tr_b16 v[24:25], v1 offset:64
  v_mfma_f32_16x16x32_bf16 v[200:203], v[28:31], a[140:143], v[200:203]
  ds_read_b64_tr_b16 v[26:27], v1 offset:576
  s_add_u32 m0, s64, 18432
  v_mfma_f32_16x16x32_bf16 v[52:55], a[136:139], a[136:139], v[52:55]
  s_waitcnt lgkmcnt(6)
  v_mfma_f32_16x16x32_bf16 v[160:163], v[32:35], a[136:139], v[160:163]
  ds_read_b64_tr_b16 v[28:29], v1 offset:96
  v_mfma_f32_16x16x32_bf16 v[164:167], v[32:35], a[140:143], v[164:167]
  ds_read_b64_tr_b16 v[30:31], v1 offset:608
  v_mfma_f32_16x16x32_bf16 v[172:175], v[36:39], a[136:139], v[172:175]
  ds_read_b64_tr_b16 v[32:33], v1 offset:1024
  v_mfma_f32_16x16x32_bf16 v[180:183], v[36:39], a[140:143], v[180:183]
  buffer_load_dwordx4 v5, s[20:23], s72 offen offset:0 lds
  v_mfma_f32_16x16x32_bf16 v[184:187], v[40:43], a[136:139], v[184:187]
  ds_read_b64_tr_b16 v[34:35], v1 offset:1536
  ds_read_b64_tr_b16 v[36:37], v1 offset:1056
  v_mfma_f32_16x16x32_bf16 v[188:191], v[40:43], a[140:143], v[188:191]
  ds_read_b64_tr_b16 v[38:39], v1 offset:1568
  v_mfma_f32_16x16x32_bf16 v[196:199], v[44:47], a[136:139], v[196:199]
ffn_hop28:
  s_cbranch_execz ffn_hop29
  ds_read_b64_tr_b16 v[40:41], v1 offset:1088
  v_mfma_f32_16x16x32_bf16 v[204:207], v[44:47], a[140:143], v[204:207]
  ds_read_b64_tr_b16 v[42:43], v1 offset:1600
  v_mfma_f32_16x16x32_bf16 v[48:51], v[64:67], a[136:139], v[48:51]
  s_waitcnt lgkmcnt(6)
  v_mfma_f32_16x16x32_bf16 v[216:219], v[16:19], a[0:3], 0
  buffer_load_dwordx4 v5, s[24:27], s72 offen offset:1024 lds
  v_mfma_f32_16x16x32_bf16 v[220:223], v[16:19], a[4:7], 0
  ds_read_b64_tr_b16 v[44:45], v1 offset:1120
  ds_read_b64_tr_b16 v[46:47], v1 offset:1632
  v_mfma_f32_16x16x32_bf16 a[152:155], v[20:23], a[0:3], 0
  ds_read_b64_tr_b16 v[16:17], v2 offset:2048
  s_lshr_b32 s87, s2, 3
  v_mfma_f32_16x16x32_bf16 a[160:163], v[20:23], a[4:7], 0
  buffer_load_dwordx4 v7, s[28:31], s72 offen offset:2048 lds
  v_mfma_f32_16x16x32_bf16 v[224:227], v[24:27], a[0:3], 0
  ds_read_b64_tr_b16 v[18:19], v2 offset:2560
  ds_read_b64_tr_b16 v[20:21], v2 offset:2080
  v_mfma_f32_16x16x32_bf16 v[228:231], v[24:27], a[4:7], 0
  ds_read_b64_tr_b16 v[22:23], v2 offset:2592
  s_lshl_b32 s87, s87, 2
  v_mfma_f32_16x16x32_bf16 a[176:179], v[28:31], a[0:3], 0
  ds_read_b64_tr_b16 v[24:25], v3 offset:2048
  s_add_u32 s87, s87, s16
  v_mfma_f32_16x16x32_bf16 a[184:187], v[28:31], a[4:7], 0
  ds_read_b64_tr_b16 v[26:27], v3 offset:2560
  s_waitcnt lgkmcnt(6)
  v_mfma_f32_16x16x32_bf16 a[144:147], v[32:35], a[0:3], 0
  ds_read_b64_tr_b16 v[28:29], v3 offset:2080
  s_add_u32 s72, s65, 2064640
  v_mfma_f32_16x16x32_bf16 a[148:151], v[32:35], a[4:7], 0
  ds_read_b64_tr_b16 v[30:31], v3 offset:2592
  s_mul_i32 s87, s87, 5184
  v_and_b32 v64, 15, v68
  v_mfma_f32_16x16x32_bf16 a[156:159], v[36:39], a[0:3], 0
  ds_read_b64_tr_b16 v[32:33], v1 offset:3072
  s_mul_i32 s13, s18, 663552
  v_lshrrev_b32 v65, 2, v64
  v_mfma_f32_16x16x32_bf16 a[164:167], v[36:39], a[4:7], 0
  ds_read_b64_tr_b16 v[34:35], v1 offset:3584
  s_add_u32 s87, s87, s13
  v_lshl_add_u32 v65, v65, 4, v64
  v_mfma_f32_16x16x32_bf16 a[168:171], v[40:43], a[0:3], 0
  ds_read_b64_tr_b16 v[36:37], v1 offset:3104
  s_add_u32 s87, s87, 4096
  v_lshlrev_b32 v65, 2, v65
  v_mfma_f32_16x16x32_bf16 a[172:175], v[40:43], a[4:7], 0
  ds_read_b64_tr_b16 v[38:39], v1 offset:3616
  s_add_u32 m0, s64, 21504
  v_mfma_f32_16x16x32_bf16 a[180:183], v[44:47], a[0:3], 0
  ds_read_b64_tr_b16 v[40:41], v1 offset:3136
  v_cndmask_b32 v52, v52, v53, s[74:75]
  v_cndmask_b32 v52, v52, v54, s[76:77]
  v_mfma_f32_16x16x32_bf16 a[188:191], v[44:47], a[4:7], 0
  ds_read_b64_tr_b16 v[42:43], v1 offset:3648
  v_cndmask_b32 v52, v52, v55, s[78:79]
  s_waitcnt lgkmcnt(6)
  v_mfma_f32_16x16x32_bf16 v[208:211], v[16:19], a[0:3], 0
  ds_read_b64_tr_b16 v[44:45], v1 offset:3168
  ds_bpermute_b32 v52, v65, v52
  v_cndmask_b32 v60, v60, v61, s[74:75]
  v_mfma_f32_16x16x32_bf16 v[212:215], v[16:19], a[4:7], 0
  ds_read_b64_tr_b16 v[46:47], v1 offset:3680
  v_cndmask_b32 v60, v60, v62, s[76:77]
ffn_hop29:
  s_cbranch_execz ffn_hop30
  v_cndmask_b32 v60, v60, v63, s[78:79]
  v_mfma_f32_16x16x32_bf16 v[240:243], v[20:23], a[0:3], 0
  buffer_load_dwordx4 v5, s[20:23], s72 offen offset:0 lds
  v_mfma_f32_16x16x32_bf16 v[248:251], v[20:23], a[4:7], 0
  ds_read_b64_tr_b16 v[16:17], v1 offset:4096
  ds_read_b64_tr_b16 v[18:19], v1 offset:4608
  ds_bpermute_b32 v60, v65, v60
  v_mfma_f32_16x16x32_bf16 v[232:235], v[24:27], a[0:3], 0
  ds_read_b64_tr_b16 v[20:21], v1 offset:4128
  v_mul_f32 v10, -0.001736111111111111, v48
  v_mov_b32 v66, 0x3727c5ac
  v_mfma_f32_16x16x32_bf16 v[236:239], v[24:27], a[4:7], 0
  ds_read_b64_tr_b16 v[22:23], v1 offset:4640
  v_mul_f32 v12, -0.001736111111111111, v56
  v_mov_b32 v67, 0x3727c5ac
  v_mfma_f32_16x16x32_bf16 v[244:247], v[28:31], a[0:3], 0
  ds_read_b64_tr_b16 v[24:25], v1 offset:4160
  s_waitcnt lgkmcnt(7)
  v_fmac_f32 v66, 0.001736111111111111, v52
  v_fma_f32 v66, -v10, v10, v66
  v_mfma_f32_16x16x32_bf16 v[252:255], v[28:31], a[4:7], 0
  ds_read_b64_tr_b16 v[26:27], v1 offset:4672
  s_waitcnt lgkmcnt(7)
  v_mfma_f32_16x16x32_bf16 v[216:219], v[32:35], a[8:11], v[216:219]
  buffer_load_dwordx4 v5, s[24:27], s72 offen offset:1024 lds
  v_max_f32 v66, 0x3727c5ac, v66
  v_mfma_f32_16x16x32_bf16 v[220:223], v[32:35], a[12:15], v[220:223]
  ds_read_b64_tr_b16 v[28:29], v1 offset:4192
  ds_read_b64_tr_b16 v[30:31], v1 offset:4704
  v_rsq_f32 v66, v66
  v_mfma_f32_16x16x32_bf16 a[152:155], v[36:39], a[8:11], a[152:155]
  ds_read_b64_tr_b16 v[32:33], v2 offset:5120
  s_waitcnt lgkmcnt(7)
  v_fmac_f32 v67, 0.001736111111111111, v60
  v_mfma_f32_16x16x32_bf16 a[160:163], v[36:39], a[12:15], a[160:163]
  buffer_load_dwordx4 v7, s[28:31], s72 offen offset:2048 lds
  v_fma_f32 v67, -v12, v12, v67
  v_mfma_f32_16x16x32_bf16 v[224:227], v[40:43], a[8:11], v[224:227]
  ds_read_b64_tr_b16 v[34:35], v2 offset:5632
  ds_read_b64_tr_b16 v[36:37], v2 offset:5152
  v_mfma_f32_16x16x32_bf16 v[228:231], v[40:43], a[12:15], v[228:231]
  buffer_load_dwordx4 a[224:227], v8, s[32:35], s87 offen offset:0
  v_max_f32 v67, 0x3727c5ac, v67
  v_mfma_f32_16x16x32_bf16 a[176:179], v[44:47], a[8:11], a[176:179]
  ds_read_b64_tr_b16 v[38:39], v2 offset:5664
  ds_read_b64_tr_b16 v[40:41], v3 offset:5120
  v_rsq_f32 v67, v67
  v_mfma_f32_16x16x32_bf16 a[184:187], v[44:47], a[12:15], a[184:187]
  ds_read_b64_tr_b16 v[42:43], v3 offset:5632
  s_waitcnt lgkmcnt(6)
  v_mfma_f32_16x16x32_bf16 a[144:147], v[16:19], a[8:11], a[144:147]
  ds_read_b64_tr_b16 v[44:45], v3 offset:5152
  s_add_u32 s72, s65, 2359552
  ds_read_b128 v[48:51], v9 offset:0
  v_mfma_f32_16x16x32_bf16 a[148:151], v[16:19], a[12:15], a[148:151]
  ds_read_b64_tr_b16 v[46:47], v3 offset:5664
  ds_read_b128 v[52:55], v9 offset:2048
  v_mul_f32 v11, -1.4426950408889634, v66
  v_mfma_f32_16x16x32_bf16 a[156:159], v[20:23], a[8:11], a[156:159]
  ds_read_b64_tr_b16 v[16:17], v1 offset:6144
  v_mul_f32 v13, -1.4426950408889634, v67
  v_mfma_f32_16x16x32_bf16 a[164:167], v[20:23], a[12:15], a[164:167]
  ds_read_b64_tr_b16 v[18:19], v1 offset:6656
  ds_read_b128 v[56:59], v9 offset:64
  v_mov_b32 v4, 1.0
  v_mfma_f32_16x16x32_bf16 a[168:171], v[24:27], a[8:11], a[168:171]
  ds_read_b64_tr_b16 v[20:21], v1 offset:6176
ffn_hop30:
  s_cbranch_execz ffn_hop31
  ds_read_b128 v[60:63], v9 offset:2112
  s_waitcnt lgkmcnt(7)
  v_pk_fma_f32 v[80:81], v[10:11], v[48:49], v[80:81] op_sel_hi:[0,1,1]
  v_pk_fma_f32 v[82:83], v[10:11], v[50:51], v[82:83] op_sel_hi:[0,1,1]
  s_waitcnt lgkmcnt(5)
  v_pk_fma_f32 v[112:113], v[10:11], v[52:53], v[112:113] op_sel_hi:[0,1,1]
  v_pk_fma_f32 v[114:115], v[10:11], v[54:55], v[114:115] op_sel_hi:[0,1,1]
  v_pk_mul_f32 v[68:69], v[10:11], v[80:81] op_sel:[1,0] op_sel_hi:[1,1]
  v_pk_mul_f32 v[70:71], v[10:11], v[82:83] op_sel:[1,0] op_sel_hi:[1,1]
  v_pk_mul_f32 v[112:113], v[80:81], v[112:113]
  v_pk_mul_f32 v[114:115], v[82:83], v[114:115]
  v_mfma_f32_16x16x32_bf16 a[172:175], v[24:27], a[12:15], a[172:175]
  ds_read_b64_tr_b16 v[22:23], v1 offset:6688
  s_add_u32 m0, s64, 24576
  v_mfma_f32_16x16x32_bf16 a[180:183], v[28:31], a[8:11], a[180:183]
  ds_read_b64_tr_b16 v[24:25], v1 offset:6208
  v_exp_f32 v68, v68
  v_mfma_f32_16x16x32_bf16 a[188:191], v[28:31], a[12:15], a[188:191]
  ds_read_b64_tr_b16 v[26:27], v1 offset:6720
  v_mfma_f32_16x16x32_bf16 v[208:211], v[32:35], a[8:11], v[208:211]
  ds_read_b64_tr_b16 v[28:29], v1 offset:6240
  v_exp_f32 v69, v69
  v_exp_f32 v70, v70
  v_exp_f32 v71, v71
  v_pk_fma_f32 v[84:85], v[12:13], v[48:49], v[84:85] op_sel_hi:[0,1,1]
  v_pk_fma_f32 v[86:87], v[12:13], v[50:51], v[86:87] op_sel_hi:[0,1,1]
  v_pk_fma_f32 v[116:117], v[12:13], v[52:53], v[116:117] op_sel_hi:[0,1,1]
  v_pk_fma_f32 v[118:119], v[12:13], v[54:55], v[118:119] op_sel_hi:[0,1,1]
  v_pk_mul_f32 v[72:73], v[12:13], v[84:85] op_sel:[1,0] op_sel_hi:[1,1]
  v_pk_mul_f32 v[74:75], v[12:13], v[86:87] op_sel:[1,0] op_sel_hi:[1,1]
  v_pk_mul_f32 v[116:117], v[84:85], v[116:117]
  v_pk_mul_f32 v[118:119], v[86:87], v[118:119]
  v_pk_add_f32 v[68:69], v[4:5], v[68:69] op_sel_hi:[0,1]
  v_pk_add_f32 v[70:71], v[4:5], v[70:71] op_sel_hi:[0,1]
  v_mfma_f32_16x16x32_bf16 v[212:215], v[32:35], a[12:15], v[212:215]
  buffer_load_dwordx4 v5, s[20:23], s72 offen offset:0 lds
  v_mfma_f32_16x16x32_bf16 v[240:243], v[36:39], a[8:11], v[240:243]
  ds_read_b64_tr_b16 v[30:31], v1 offset:6752
  ds_read_b64_tr_b16 v[32:33], v1 offset:7168
  v_mfma_f32_16x16x32_bf16 v[248:251], v[36:39], a[12:15], v[248:251]
  buffer_load_dwordx4 a[228:231], v8, s[32:35], s87 offen offset:1024
  v_mfma_f32_16x16x32_bf16 v[232:235], v[40:43], a[8:11], v[232:235]
  ds_read_b64_tr_b16 v[34:35], v1 offset:7680
  ds_read_b64_tr_b16 v[36:37], v1 offset:7200
  v_mfma_f32_16x16x32_bf16 v[236:239], v[40:43], a[12:15], v[236:239]
  ds_read_b64_tr_b16 v[38:39], v1 offset:7712
  ds_read_b128 v[48:51], v9 offset:128
  v_mfma_f32_16x16x32_bf16 v[244:247], v[44:47], a[8:11], v[244:247]
  ds_read_b64_tr_b16 v[40:41], v1 offset:7232
  ds_read_b128 v[52:55], v9 offset:2176
  v_mfma_f32_16x16x32_bf16 v[252:255], v[44:47], a[12:15], v[252:255]
  ds_read_b64_tr_b16 v[42:43], v1 offset:7744
  s_waitcnt lgkmcnt(8)
  v_mfma_f32_16x16x32_bf16 v[216:219], v[16:19], a[16:19], v[216:219]
  buffer_load_dwordx4 v5, s[24:27], s72 offen offset:1024 lds
  v_mfma_f32_16x16x32_bf16 v[220:223], v[16:19], a[20:23], v[220:223]
  ds_read_b64_tr_b16 v[44:45], v1 offset:7264
  ds_read_b64_tr_b16 v[46:47], v1 offset:7776
  v_mfma_f32_16x16x32_bf16 a[152:155], v[20:23], a[16:19], a[152:155]
  ds_read_b64_tr_b16 v[16:17], v2 offset:8192
  v_exp_f32 v72, v72
  v_mfma_f32_16x16x32_bf16 a[160:163], v[20:23], a[20:23], a[160:163]
  buffer_load_dwordx4 v7, s[28:31], s72 offen offset:2048 lds
  v_mfma_f32_16x16x32_bf16 v[224:227], v[24:27], a[16:19], v[224:227]
  ds_read_b64_tr_b16 v[18:19], v2 offset:8704
  ds_read_b64_tr_b16 v[20:21], v2 offset:8224
  v_mfma_f32_16x16x32_bf16 v[228:231], v[24:27], a[20:23], v[228:231]
  v_exp_f32 v73, v73
ffn_hop31:
  s_cbranch_execz ffn_hop32
  v_mfma_f32_16x16x32_bf16 a[176:179], v[28:31], a[16:19], a[176:179]
  ds_read_b64_tr_b16 v[22:23], v2 offset:8736
  ds_read_b64_tr_b16 v[24:25], v3 offset:8192
  v_mfma_f32_16x16x32_bf16 a[184:187], v[28:31], a[20:23], a[184:187]
  ds_read_b64_tr_b16 v[26:27], v3 offset:8704
  s_waitcnt lgkmcnt(6)
  v_mfma_f32_16x16x32_bf16 a[144:147], v[32:35], a[16:19], a[144:147]
  buffer_load_dwordx4 a[232:235], v8, s[32:35], s87 offen offset:2048
  v_mfma_f32_16x16x32_bf16 a[148:151], v[32:35], a[20:23], a[148:151]
  ds_read_b64_tr_b16 v[28:29], v3 offset:8224
  ds_read_b64_tr_b16 v[30:31], v3 offset:8736
  v_mfma_f32_16x16x32_bf16 a[156:159], v[36:39], a[16:19], a[156:159]
  s_waitcnt vmcnt(12)
  s_barrier
  ds_read_b64_tr_b16 v[32:33], v1 offset:9216
  v_mfma_f32_16x16x32_bf16 a[164:167], v[36:39], a[20:23], a[164:167]
  ds_read_b64_tr_b16 v[34:35], v1 offset:9728
  s_add_u32 s72, s65, 2654464
  v_mfma_f32_16x16x32_bf16 a[168:171], v[40:43], a[16:19], a[168:171]
  v_exp_f32 v74, v74
  v_mfma_f32_16x16x32_bf16 a[172:175], v[40:43], a[20:23], a[172:175]
  ds_read_b64_tr_b16 v[36:37], v1 offset:9248
  ds_read_b64_tr_b16 v[38:39], v1 offset:9760
  v_mfma_f32_16x16x32_bf16 a[180:183], v[44:47], a[16:19], a[180:183]
  ds_read_b64_tr_b16 v[40:41], v1 offset:9280
  v_exp_f32 v75, v75
  v_mfma_f32_16x16x32_bf16 a[188:191], v[44:47], a[20:23], a[188:191]
  ds_read_b64_tr_b16 v[42:43], v1 offset:9792
  s_waitcnt lgkmcnt(6)
  v_mfma_f32_16x16x32_bf16 v[208:211], v[16:19], a[16:19], v[208:211]
  ds_read_b64_tr_b16 v[44:45], v1 offset:9312
  s_add_u32 m0, s64, 27648
  v_mfma_f32_16x16x32_bf16 v[212:215], v[16:19], a[20:23], v[212:215]
  v_rcp_f32 v68, v68
  v_mfma_f32_16x16x32_bf16 v[240:243], v[20:23], a[16:19], v[240:243]
  ds_read_b64_tr_b16 v[46:47], v1 offset:9824
  ds_read_b64_tr_b16 v[16:17], v1 offset:10240
  v_mfma_f32_16x16x32_bf16 v[248:251], v[20:23], a[20:23], v[248:251]
  ds_read_b64_tr_b16 v[18:19], v1 offset:10752
  v_rcp_f32 v69, v69
  v_rcp_f32 v70, v70
  v_rcp_f32 v71, v71
  v_pk_fma_f32 v[120:121], v[10:11], v[56:57], v[120:121] op_sel_hi:[0,1,1]
  v_pk_fma_f32 v[122:123], v[10:11], v[58:59], v[122:123] op_sel_hi:[0,1,1]
  v_pk_fma_f32 v[124:125], v[10:11], v[60:61], v[124:125] op_sel_hi:[0,1,1]
  v_pk_fma_f32 v[126:127], v[10:11], v[62:63], v[126:127] op_sel_hi:[0,1,1]
  v_pk_mul_f32 v[76:77], v[10:11], v[120:121] op_sel:[1,0] op_sel_hi:[1,1]
  v_pk_mul_f32 v[78:79], v[10:11], v[122:123] op_sel:[1,0] op_sel_hi:[1,1]
  v_pk_mul_f32 v[124:125], v[120:121], v[124:125]
  v_pk_mul_f32 v[126:127], v[122:123], v[126:127]
  v_pk_add_f32 v[72:73], v[4:5], v[72:73] op_sel_hi:[0,1]
  v_pk_add_f32 v[74:75], v[4:5], v[74:75] op_sel_hi:[0,1]
  v_pk_mul_f32 v[112:113], v[112:113], v[68:69]
  v_pk_mul_f32 v[114:115], v[114:115], v[70:71]
  v_mfma_f32_16x16x32_bf16 v[232:235], v[24:27], a[16:19], v[232:235]
  buffer_load_dwordx4 v5, s[20:23], s72 offen offset:0 lds
  v_mfma_f32_16x16x32_bf16 v[236:239], v[24:27], a[20:23], v[236:239]
  ds_read_b64_tr_b16 v[20:21], v1 offset:10272
  ds_read_b64_tr_b16 v[22:23], v1 offset:10784
  v_mfma_f32_16x16x32_bf16 v[244:247], v[28:31], a[16:19], v[244:247]
  ds_read_b64_tr_b16 v[24:25], v1 offset:10304
  buffer_load_dwordx4 a[236:239], v8, s[32:35], s87 offen offset:3072
  v_mfma_f32_16x16x32_bf16 v[252:255], v[28:31], a[20:23], v[252:255]
  ds_read_b64_tr_b16 v[26:27], v1 offset:10816
  s_waitcnt lgkmcnt(6)
  v_mfma_f32_16x16x32_bf16 v[216:219], v[32:35], a[24:27], v[216:219]
  buffer_load_dwordx4 v5, s[24:27], s72 offen offset:1024 lds
  v_mfma_f32_16x16x32_bf16 v[220:223], v[32:35], a[28:31], v[220:223]
  ds_read_b64_tr_b16 v[28:29], v1 offset:10336
ffn_hop32:
  s_cbranch_execz ffn_hop33
  ds_read_b64_tr_b16 v[30:31], v1 offset:10848
  v_mfma_f32_16x16x32_bf16 a[152:155], v[36:39], a[24:27], a[152:155]
  ds_read_b64_tr_b16 v[32:33], v2 offset:11264
  s_add_u32 s87, s87, 4096
  v_mfma_f32_16x16x32_bf16 a[160:163], v[36:39], a[28:31], a[160:163]
  ds_read_b64_tr_b16 v[34:35], v2 offset:11776
  v_cvt_pk_bf16_f32 v80, v112, v113
  v_mfma_f32_16x16x32_bf16 v[224:227], v[40:43], a[24:27], v[224:227]
  ds_read_b64_tr_b16 v[36:37], v2 offset:11296
  v_cvt_pk_bf16_f32 v81, v114, v115
  v_mfma_f32_16x16x32_bf16 v[228:231], v[40:43], a[28:31], v[228:231]
  buffer_load_dwordx4 v7, s[28:31], s72 offen offset:2048 lds
  v_mfma_f32_16x16x32_bf16 a[176:179], v[44:47], a[24:27], a[176:179]
  ds_read_b64_tr_b16 v[38:39], v2 offset:11808
  ds_read_b64_tr_b16 v[40:41], v3 offset:11264
  v_mfma_f32_16x16x32_bf16 a[184:187], v[44:47], a[28:31], a[184:187]
  ds_read_b64_tr_b16 v[42:43], v3 offset:11776
  s_waitcnt lgkmcnt(6)
  v_mfma_f32_16x16x32_bf16 a[144:147], v[16:19], a[24:27], a[144:147]
  v_exp_f32 v76, v76
  v_mfma_f32_16x16x32_bf16 a[148:151], v[16:19], a[28:31], a[148:151]
  ds_read_b64_tr_b16 v[44:45], v3 offset:11296
  ds_read_b64_tr_b16 v[46:47], v3 offset:11808
  v_mfma_f32_16x16x32_bf16 a[156:159], v[20:23], a[24:27], a[156:159]
  ds_read_b64_tr_b16 v[16:17], v1 offset:12288
  s_add_u32 s72, s65, 2949376
  v_mfma_f32_16x16x32_bf16 a[164:167], v[20:23], a[28:31], a[164:167]
  v_exp_f32 v77, v77
  v_mfma_f32_16x16x32_bf16 a[168:171], v[24:27], a[24:27], a[168:171]
  ds_read_b64_tr_b16 v[18:19], v1 offset:12800
  ds_read_b64_tr_b16 v[20:21], v1 offset:12320
  v_mfma_f32_16x16x32_bf16 a[172:175], v[24:27], a[28:31], a[172:175]
  ds_read_b64_tr_b16 v[22:23], v1 offset:12832
  v_exp_f32 v78, v78
  v_mfma_f32_16x16x32_bf16 a[180:183], v[28:31], a[24:27], a[180:183]
  ds_read_b64_tr_b16 v[24:25], v1 offset:12352
  s_add_u32 m0, s64, 30720
  v_mfma_f32_16x16x32_bf16 a[188:191], v[28:31], a[28:31], a[188:191]
  ds_read_b64_tr_b16 v[26:27], v1 offset:12864
  s_waitcnt lgkmcnt(6)
  v_mfma_f32_16x16x32_bf16 v[208:211], v[32:35], a[24:27], v[208:211]
  buffer_load_dwordx4 a[240:243], v8, s[32:35], s87 offen offset:0
  v_mfma_f32_16x16x32_bf16 v[212:215], v[32:35], a[28:31], v[212:215]
  ds_read_b64_tr_b16 v[28:29], v1 offset:12384
  ds_read_b64_tr_b16 v[30:31], v1 offset:12896
  v_mfma_f32_16x16x32_bf16 v[240:243], v[36:39], a[24:27], v[240:243]
  ds_read_b64_tr_b16 v[32:33], v1 offset:13312
  v_exp_f32 v79, v79
  v_mfma_f32_16x16x32_bf16 v[248:251], v[36:39], a[28:31], v[248:251]
  buffer_load_dwordx4 v5, s[20:23], s72 offen offset:0 lds
  v_mfma_f32_16x16x32_bf16 v[232:235], v[40:43], a[24:27], v[232:235]
  ds_read_b64_tr_b16 v[34:35], v1 offset:13824
  ds_read_b64_tr_b16 v[36:37], v1 offset:13344
  v_mfma_f32_16x16x32_bf16 v[236:239], v[40:43], a[28:31], v[236:239]
  ds_read_b64_tr_b16 v[38:39], v1 offset:13856
  v_rcp_f32 v72, v72
  v_mfma_f32_16x16x32_bf16 v[244:247], v[44:47], a[24:27], v[244:247]
  ds_read_b64_tr_b16 v[40:41], v1 offset:13376
  v_rcp_f32 v73, v73
  v_rcp_f32 v74, v74
  v_rcp_f32 v75, v75
  v_pk_fma_f32 v[128:129], v[12:13], v[56:57], v[128:129] op_sel_hi:[0,1,1]
  v_pk_fma_f32 v[130:131], v[12:13], v[58:59], v[130:131] op_sel_hi:[0,1,1]
  v_pk_fma_f32 v[132:133], v[12:13], v[60:61], v[132:133] op_sel_hi:[0,1,1]
  v_pk_fma_f32 v[134:135], v[12:13], v[62:63], v[134:135] op_sel_hi:[0,1,1]
  v_pk_mul_f32 v[68:69], v[12:13], v[128:129] op_sel:[1,0] op_sel_hi:[1,1]
  v_pk_mul_f32 v[70:71], v[12:13], v[130:131] op_sel:[1,0] op_sel_hi:[1,1]
  v_pk_mul_f32 v[132:133], v[128:129], v[132:133]
  v_pk_mul_f32 v[134:135], v[130:131], v[134:135]
ffn_hop33:
  s_cbranch_execz ffn_hop34
  v_pk_add_f32 v[76:77], v[4:5], v[76:77] op_sel_hi:[0,1]
  v_pk_add_f32 v[78:79], v[4:5], v[78:79] op_sel_hi:[0,1]
  v_pk_mul_f32 v[116:117], v[116:117], v[72:73]
  v_pk_mul_f32 v[118:119], v[118:119], v[74:75]
  v_mfma_f32_16x16x32_bf16 v[252:255], v[44:47], a[28:31], v[252:255]
  ds_read_b64_tr_b16 v[42:43], v1 offset:13888
  s_waitcnt lgkmcnt(6)
  v_mfma_f32_16x16x32_bf16 v[216:219], v[16:19], a[32:35], v[216:219]
  buffer_load_dwordx4 v5, s[24:27], s72 offen offset:1024 lds
  v_mfma_f32_16x16x32_bf16 v[220:223], v[16:19], a[36:39], v[220:223]
  ds_read_b64_tr_b16 v[44:45], v1 offset:13408
  ds_read_b64_tr_b16 v[46:47], v1 offset:13920
  v_mfma_f32_16x16x32_bf16 a[152:155], v[20:23], a[32:35], a[152:155]
  ds_read_b64_tr_b16 v[16:17], v2 offset:14336
  v_cvt_pk_bf16_f32 v84, v116, v117
  v_mfma_f32_16x16x32_bf16 a[160:163], v[20:23], a[36:39], a[160:163]
  ds_read_b64_tr_b16 v[18:19], v2 offset:14848
  v_cvt_pk_bf16_f32 v85, v118, v119
  v_mfma_f32_16x16x32_bf16 v[224:227], v[24:27], a[32:35], v[224:227]
  buffer_load_dwordx4 v7, s[28:31], s72 offen offset:2048 lds
  v_mfma_f32_16x16x32_bf16 v[228:231], v[24:27], a[36:39], v[228:231]
  ds_read_b64_tr_b16 v[20:21], v2 offset:14368
  ds_read_b64_tr_b16 v[22:23], v2 offset:14880
  v_mfma_f32_16x16x32_bf16 a[176:179], v[28:31], a[32:35], a[176:179]
  ds_read_b64_tr_b16 v[24:25], v3 offset:14336
  buffer_load_dwordx4 a[244:247], v8, s[32:35], s87 offen offset:64
  v_mfma_f32_16x16x32_bf16 a[184:187], v[28:31], a[36:39], a[184:187]
  ds_read_b64_tr_b16 v[26:27], v3 offset:14848
  s_waitcnt lgkmcnt(6)
  v_mfma_f32_16x16x32_bf16 a[144:147], v[32:35], a[32:35], a[144:147]
  ds_read_b64_tr_b16 v[28:29], v3 offset:14368
  ds_read_b128 v[56:59], v9 offset:192
  v_mfma_f32_16x16x32_bf16 a[148:151], v[32:35], a[36:39], a[148:151]
  ds_read_b64_tr_b16 v[30:31], v3 offset:14880
  s_add_u32 s72, s65, 3244288
  v_mfma_f32_16x16x32_bf16 a[156:159], v[36:39], a[32:35], a[156:159]
  ds_read_b64_tr_b16 v[32:33], v1 offset:15360
  ds_read_b128 v[60:63], v9 offset:2240
  v_mfma_f32_16x16x32_bf16 a[164:167], v[36:39], a[36:39], a[164:167]
  v_exp_f32 v68, v68
  v_mfma_f32_16x16x32_bf16 a[168:171], v[40:43], a[32:35], a[168:171]
  ds_read_b64_tr_b16 v[34:35], v1 offset:15872
  ds_read_b64_tr_b16 v[36:37], v1 offset:15392
  v_mfma_f32_16x16x32_bf16 a[172:175], v[40:43], a[36:39], a[172:175]
  ds_read_b64_tr_b16 v[38:39], v1 offset:15904
  s_add_u32 m0, s64, 33792
  v_mfma_f32_16x16x32_bf16 a[180:183], v[44:47], a[32:35], a[180:183]
  ds_read_b64_tr_b16 v[40:41], v1 offset:15424
  v_exp_f32 v69, v69
  v_mfma_f32_16x16x32_bf16 a[188:191], v[44:47], a[36:39], a[188:191]
  ds_read_b64_tr_b16 v[42:43], v1 offset:15936
  s_waitcnt lgkmcnt(7)
  v_mfma_f32_16x16x32_bf16 v[208:211], v[16:19], a[32:35], v[208:211]
  v_exp_f32 v70, v70
  v_mfma_f32_16x16x32_bf16 v[212:215], v[16:19], a[36:39], v[212:215]
  ds_read_b64_tr_b16 v[44:45], v1 offset:15456
  ds_read_b64_tr_b16 v[46:47], v1 offset:15968
  v_mfma_f32_16x16x32_bf16 v[240:243], v[20:23], a[32:35], v[240:243]
  buffer_load_dwordx4 v5, s[20:23], s72 offen offset:0 lds
  v_mfma_f32_16x16x32_bf16 v[248:251], v[20:23], a[36:39], v[248:251]
  ds_read_b64_tr_b16 v[16:17], v1 offset:16384
  ds_read_b64_tr_b16 v[18:19], v1 offset:16896
  v_mfma_f32_16x16x32_bf16 v[232:235], v[24:27], a[32:35], v[232:235]
  v_exp_f32 v71, v71
  v_mfma_f32_16x16x32_bf16 v[236:239], v[24:27], a[36:39], v[236:239]
  ds_read_b64_tr_b16 v[20:21], v1 offset:16416
  ds_read_b64_tr_b16 v[22:23], v1 offset:16928
ffn_hop34:
  s_cbranch_execz ffn_hop35
  v_rcp_f32 v76, v76
  v_mfma_f32_16x16x32_bf16 v[244:247], v[28:31], a[32:35], v[244:247]
  ds_read_b64_tr_b16 v[24:25], v1 offset:16448
  v_rcp_f32 v77, v77
  v_rcp_f32 v78, v78
  v_rcp_f32 v79, v79
  v_pk_fma_f32 v[88:89], v[10:11], v[48:49], v[88:89] op_sel_hi:[0,1,1]
  v_pk_fma_f32 v[90:91], v[10:11], v[50:51], v[90:91] op_sel_hi:[0,1,1]
  v_pk_fma_f32 v[136:137], v[10:11], v[52:53], v[136:137] op_sel_hi:[0,1,1]
  v_pk_fma_f32 v[138:139], v[10:11], v[54:55], v[138:139] op_sel_hi:[0,1,1]
  v_pk_mul_f32 v[72:73], v[10:11], v[88:89] op_sel:[1,0] op_sel_hi:[1,1]
  v_pk_mul_f32 v[74:75], v[10:11], v[90:91] op_sel:[1,0] op_sel_hi:[1,1]
  v_pk_mul_f32 v[136:137], v[88:89], v[136:137]
  v_pk_mul_f32 v[138:139], v[90:91], v[138:139]
  v_pk_add_f32 v[68:69], v[4:5], v[68:69] op_sel_hi:[0,1]
  v_pk_add_f32 v[70:71], v[4:5], v[70:71] op_sel_hi:[0,1]
  v_pk_mul_f32 v[124:125], v[124:125], v[76:77]
  v_pk_mul_f32 v[126:127], v[126:127], v[78:79]
  v_mfma_f32_16x16x32_bf16 v[252:255], v[28:31], a[36:39], v[252:255]
  ds_read_b64_tr_b16 v[26:27], v1 offset:16960
  s_waitcnt lgkmcnt(6)
  v_mfma_f32_16x16x32_bf16 v[216:219], v[32:35], a[40:43], v[216:219]
  buffer_load_dwordx4 v5, s[24:27], s72 offen offset:1024 lds
  v_mfma_f32_16x16x32_bf16 v[220:223], v[32:35], a[44:47], v[220:223]
  ds_read_b64_tr_b16 v[28:29], v1 offset:16480
  ds_read_b64_tr_b16 v[30:31], v1 offset:16992
  v_mfma_f32_16x16x32_bf16 a[152:155], v[36:39], a[40:43], a[152:155]
  ds_read_b64_tr_b16 v[32:33], v2 offset:17408
  v_cvt_pk_bf16_f32 v82, v124, v125
  v_mfma_f32_16x16x32_bf16 a[160:163], v[36:39], a[44:47], a[160:163]
  buffer_load_dwordx4 v7, s[28:31], s72 offen offset:2048 lds
  v_mfma_f32_16x16x32_bf16 v[224:227], v[40:43], a[40:43], v[224:227]
  ds_read_b64_tr_b16 v[34:35], v2 offset:17920
  ds_read_b64_tr_b16 v[36:37], v2 offset:17440
  v_mfma_f32_16x16x32_bf16 v[228:231], v[40:43], a[44:47], v[228:231]
  ds_read_b64_tr_b16 v[38:39], v2 offset:17952
  v_cvt_pk_bf16_f32 v83, v126, v127
  v_mfma_f32_16x16x32_bf16 a[176:179], v[44:47], a[40:43], a[176:179]
  ds_read_b64_tr_b16 v[40:41], v3 offset:17408
  buffer_store_dwordx4 v[80:83], v8, s[48:51], 0 offen offset:0 sc1
  v_mfma_f32_16x16x32_bf16 a[184:187], v[44:47], a[44:47], a[184:187]
  ds_read_b64_tr_b16 v[42:43], v3 offset:17920
  s_waitcnt lgkmcnt(6)
  v_mfma_f32_16x16x32_bf16 a[144:147], v[16:19], a[40:43], a[144:147]
  v_exp_f32 v72, v72
  v_mfma_f32_16x16x32_bf16 a[148:151], v[16:19], a[44:47], a[148:151]
  ds_read_b64_tr_b16 v[44:45], v3 offset:17440
  ds_read_b64_tr_b16 v[46:47], v3 offset:17952
  v_mfma_f32_16x16x32_bf16 a[156:159], v[20:23], a[40:43], a[156:159]
  s_waitcnt vmcnt(14)
  s_barrier
  ds_read_b64_tr_b16 v[16:17], v1 offset:18432
  v_mfma_f32_16x16x32_bf16 a[164:167], v[20:23], a[44:47], a[164:167]
  ds_read_b64_tr_b16 v[18:19], v1 offset:18944
  s_add_u32 s72, s65, 3539200
  v_mfma_f32_16x16x32_bf16 a[168:171], v[24:27], a[40:43], a[168:171]
  v_exp_f32 v73, v73
  v_mfma_f32_16x16x32_bf16 a[172:175], v[24:27], a[44:47], a[172:175]
  ds_read_b64_tr_b16 v[20:21], v1 offset:18464
  ds_read_b64_tr_b16 v[22:23], v1 offset:18976
  v_mfma_f32_16x16x32_bf16 a[180:183], v[28:31], a[40:43], a[180:183]
  ds_read_b64_tr_b16 v[24:25], v1 offset:18496
  v_exp_f32 v74, v74
  v_mfma_f32_16x16x32_bf16 a[188:191], v[28:31], a[44:47], a[188:191]
  ds_read_b64_tr_b16 v[26:27], v1 offset:19008
  s_waitcnt lgkmcnt(6)
  v_mfma_f32_16x16x32_bf16 v[208:211], v[32:35], a[40:43], v[208:211]
  ds_read_b64_tr_b16 v[28:29], v1 offset:18528
  s_add_u32 m0, s64, 0
  v_mfma_f32_16x16x32_bf16 v[212:215], v[32:35], a[44:47], v[212:215]
  v_exp_f32 v75, v75
  v_mfma_f32_16x16x32_bf16 v[240:243], v[36:39], a[40:43], v[240:243]
  ds_read_b64_tr_b16 v[30:31], v1 offset:19040
  ds_read_b64_tr_b16 v[32:33], v1 offset:19456
ffn_hop35:
  s_cbranch_execz ffn_hop36
  v_mfma_f32_16x16x32_bf16 v[248:251], v[36:39], a[44:47], v[248:251]
  ds_read_b64_tr_b16 v[34:35], v1 offset:19968
  v_rcp_f32 v68, v68
  v_mfma_f32_16x16x32_bf16 v[232:235], v[40:43], a[40:43], v[232:235]
  buffer_load_dwordx4 v5, s[20:23], s72 offen offset:0 lds
  v_mfma_f32_16x16x32_bf16 v[236:239], v[40:43], a[44:47], v[236:239]
  ds_read_b64_tr_b16 v[36:37], v1 offset:19488
  ds_read_b64_tr_b16 v[38:39], v1 offset:20000
  v_mfma_f32_16x16x32_bf16 v[244:247], v[44:47], a[40:43], v[244:247]
  ds_read_b64_tr_b16 v[40:41], v1 offset:19520
  v_rcp_f32 v69, v69
  v_rcp_f32 v70, v70
  v_rcp_f32 v71, v71
  v_pk_fma_f32 v[92:93], v[12:13], v[48:49], v[92:93] op_sel_hi:[0,1,1]
  v_pk_fma_f32 v[94:95], v[12:13], v[50:51], v[94:95] op_sel_hi:[0,1,1]
  v_pk_fma_f32 v[140:141], v[12:13], v[52:53], v[140:141] op_sel_hi:[0,1,1]
  v_pk_fma_f32 v[142:143], v[12:13], v[54:55], v[142:143] op_sel_hi:[0,1,1]
  v_pk_mul_f32 v[76:77], v[12:13], v[92:93] op_sel:[1,0] op_sel_hi:[1,1]
  v_pk_mul_f32 v[78:79], v[12:13], v[94:95] op_sel:[1,0] op_sel_hi:[1,1]
  v_pk_mul_f32 v[140:141], v[92:93], v[140:141]
  v_pk_mul_f32 v[142:143], v[94:95], v[142:143]
  v_pk_add_f32 v[72:73], v[4:5], v[72:73] op_sel_hi:[0,1]
  v_pk_add_f32 v[74:75], v[4:5], v[74:75] op_sel_hi:[0,1]
  v_pk_mul_f32 v[132:133], v[132:133], v[68:69]
  v_pk_mul_f32 v[134:135], v[134:135], v[70:71]
  v_mfma_f32_16x16x32_bf16 v[252:255], v[44:47], a[44:47], v[252:255]
  ds_read_b64_tr_b16 v[42:43], v1 offset:20032
  s_waitcnt lgkmcnt(6)
  v_mfma_f32_16x16x32_bf16 v[216:219], v[16:19], a[48:51], v[216:219]
  buffer_load_dwordx4 v5, s[24:27], s72 offen offset:1024 lds
  v_mfma_f32_16x16x32_bf16 v[220:223], v[16:19], a[52:55], v[220:223]
  ds_read_b64_tr_b16 v[44:45], v1 offset:19552
  ds_read_b64_tr_b16 v[46:47], v1 offset:20064
  v_mfma_f32_16x16x32_bf16 a[152:155], v[20:23], a[48:51], a[152:155]
  ds_read_b64_tr_b16 v[16:17], v2 offset:20480
  v_cvt_pk_bf16_f32 v86, v132, v133
  v_mfma_f32_16x16x32_bf16 a[160:163], v[20:23], a[52:55], a[160:163]
  ds_read_b64_tr_b16 v[18:19], v2 offset:20992
  v_cvt_pk_bf16_f32 v87, v134, v135
  v_mfma_f32_16x16x32_bf16 v[224:227], v[24:27], a[48:51], v[224:227]
  ds_read_b64_tr_b16 v[20:21], v2 offset:20512
  buffer_store_dwordx4 v[84:87], v8, s[48:51], 0 offen offset:1024 sc1
  v_mfma_f32_16x16x32_bf16 v[228:231], v[24:27], a[52:55], v[228:231]
  buffer_load_dwordx4 v7, s[28:31], s72 offen offset:2048 lds
  v_mfma_f32_16x16x32_bf16 a[176:179], v[28:31], a[48:51], a[176:179]
  ds_read_b64_tr_b16 v[22:23], v2 offset:21024
  ds_read_b64_tr_b16 v[24:25], v3 offset:20480
  v_mfma_f32_16x16x32_bf16 a[184:187], v[28:31], a[52:55], a[184:187]
  ds_read_b64_tr_b16 v[26:27], v3 offset:20992
  s_waitcnt lgkmcnt(6)
  v_mfma_f32_16x16x32_bf16 a[144:147], v[32:35], a[48:51], a[144:147]
  ds_read_b64_tr_b16 v[28:29], v3 offset:20512
  ds_read_b128 v[48:51], v9 offset:256
  v_mfma_f32_16x16x32_bf16 a[148:151], v[32:35], a[52:55], a[148:151]
  ds_read_b64_tr_b16 v[30:31], v3 offset:21024
  ds_read_b128 v[52:55], v9 offset:2304
  v_mfma_f32_16x16x32_bf16 a[156:159], v[36:39], a[48:51], a[156:159]
  ds_read_b64_tr_b16 v[32:33], v1 offset:21504
  s_add_u32 s72, s65, 3834112
  v_mfma_f32_16x16x32_bf16 a[164:167], v[36:39], a[52:55], a[164:167]
  v_exp_f32 v76, v76
  v_mfma_f32_16x16x32_bf16 a[168:171], v[40:43], a[48:51], a[168:171]
  ds_read_b64_tr_b16 v[34:35], v1 offset:22016
ffn_hop36:
  s_cbranch_execz ffn_hop37
  ds_read_b64_tr_b16 v[36:37], v1 offset:21536
  v_mfma_f32_16x16x32_bf16 a[172:175], v[40:43], a[52:55], a[172:175]
  ds_read_b64_tr_b16 v[38:39], v1 offset:22048
  v_exp_f32 v77, v77
  v_mfma_f32_16x16x32_bf16 a[180:183], v[44:47], a[48:51], a[180:183]
  ds_read_b64_tr_b16 v[40:41], v1 offset:21568
  s_add_u32 m0, s64, 3072
  v_mfma_f32_16x16x32_bf16 a[188:191], v[44:47], a[52:55], a[188:191]
  ds_read_b64_tr_b16 v[42:43], v1 offset:22080
  s_waitcnt lgkmcnt(7)
  v_mfma_f32_16x16x32_bf16 v[208:211], v[16:19], a[48:51], v[208:211]
  v_exp_f32 v78, v78
  v_mfma_f32_16x16x32_bf16 v[212:215], v[16:19], a[52:55], v[212:215]
  ds_read_b64_tr_b16 v[44:45], v1 offset:21600
  ds_read_b64_tr_b16 v[46:47], v1 offset:22112
  v_mfma_f32_16x16x32_bf16 v[240:243], v[20:23], a[48:51], v[240:243]
  ds_read_b64_tr_b16 v[16:17], v1 offset:22528
  v_exp_f32 v79, v79
  v_mfma_f32_16x16x32_bf16 v[248:251], v[20:23], a[52:55], v[248:251]
  buffer_load_dwordx4 v5, s[20:23], s72 offen offset:0 lds
  v_mfma_f32_16x16x32_bf16 v[232:235], v[24:27], a[48:51], v[232:235]
  ds_read_b64_tr_b16 v[18:19], v1 offset:23040
  ds_read_b64_tr_b16 v[20:21], v1 offset:22560
  v_mfma_f32_16x16x32_bf16 v[236:239], v[24:27], a[52:55], v[236:239]
  v_rcp_f32 v72, v72
  v_mfma_f32_16x16x32_bf16 v[244:247], v[28:31], a[48:51], v[244:247]
  ds_read_b64_tr_b16 v[22:23], v1 offset:23072
  ds_read_b64_tr_b16 v[24:25], v1 offset:22592
  v_mfma_f32_16x16x32_bf16 v[252:255], v[28:31], a[52:55], v[252:255]
  ds_read_b64_tr_b16 v[26:27], v1 offset:23104
  s_waitcnt lgkmcnt(6)
  v_mfma_f32_16x16x32_bf16 v[216:219], v[32:35], a[56:59], v[216:219]
  buffer_load_dwordx4 v5, s[24:27], s72 offen offset:1024 lds
  v_mfma_f32_16x16x32_bf16 v[220:223], v[32:35], a[60:63], v[220:223]
  ds_read_b64_tr_b16 v[28:29], v1 offset:22624
  ds_read_b64_tr_b16 v[30:31], v1 offset:23136
  v_mfma_f32_16x16x32_bf16 a[152:155], v[36:39], a[56:59], a[152:155]
  ds_read_b64_tr_b16 v[32:33], v2 offset:23552
  v_rcp_f32 v73, v73
  v_rcp_f32 v74, v74
  v_rcp_f32 v75, v75
  v_pk_fma_f32 v[144:145], v[10:11], v[56:57], v[144:145] op_sel_hi:[0,1,1]
  v_pk_fma_f32 v[146:147], v[10:11], v[58:59], v[146:147] op_sel_hi:[0,1,1]
  v_pk_fma_f32 v[148:149], v[10:11], v[60:61], v[148:149] op_sel_hi:[0,1,1]
  v_pk_fma_f32 v[150:151], v[10:11], v[62:63], v[150:151] op_sel_hi:[0,1,1]
  v_pk_mul_f32 v[68:69], v[10:11], v[144:145] op_sel:[1,0] op_sel_hi:[1,1]
  v_pk_mul_f32 v[70:71], v[10:11], v[146:147] op_sel:[1,0] op_sel_hi:[1,1]
  v_pk_mul_f32 v[148:149], v[144:145], v[148:149]
  v_pk_mul_f32 v[150:151], v[146:147], v[150:151]
  v_pk_add_f32 v[76:77], v[4:5], v[76:77] op_sel_hi:[0,1]
  v_pk_add_f32 v[78:79], v[4:5], v[78:79] op_sel_hi:[0,1]
  v_pk_mul_f32 v[136:137], v[136:137], v[72:73]
  v_pk_mul_f32 v[138:139], v[138:139], v[74:75]
  v_mfma_f32_16x16x32_bf16 a[160:163], v[36:39], a[60:63], a[160:163]
  ds_read_b64_tr_b16 v[34:35], v2 offset:24064
  v_cvt_pk_bf16_f32 v88, v136, v137
  v_mfma_f32_16x16x32_bf16 v[224:227], v[40:43], a[56:59], v[224:227]
  buffer_load_dwordx4 v7, s[28:31], s72 offen offset:2048 lds
  v_mfma_f32_16x16x32_bf16 v[228:231], v[40:43], a[60:63], v[228:231]
  ds_read_b64_tr_b16 v[36:37], v2 offset:23584
  ds_read_b64_tr_b16 v[38:39], v2 offset:24096
  v_mfma_f32_16x16x32_bf16 a[176:179], v[44:47], a[56:59], a[176:179]
  ds_read_b64_tr_b16 v[40:41], v3 offset:23552
  v_cvt_pk_bf16_f32 v89, v138, v139
  v_mfma_f32_16x16x32_bf16 a[184:187], v[44:47], a[60:63], a[184:187]
  ds_read_b64_tr_b16 v[42:43], v3 offset:24064
  s_waitcnt lgkmcnt(6)
  v_mfma_f32_16x16x32_bf16 a[144:147], v[16:19], a[56:59], a[144:147]
  ds_read_b64_tr_b16 v[44:45], v3 offset:23584
  v_exp_f32 v68, v68
  v_mfma_f32_16x16x32_bf16 a[148:151], v[16:19], a[60:63], a[148:151]
  ds_read_b64_tr_b16 v[46:47], v3 offset:24096
  s_add_u32 s72, s65, 4129024
ffn_hop37:
  s_cbranch_execz ffn_hop38
  v_mfma_f32_16x16x32_bf16 a[156:159], v[20:23], a[56:59], a[156:159]
  v_exp_f32 v69, v69
  v_mfma_f32_16x16x32_bf16 a[164:167], v[20:23], a[60:63], a[164:167]
  ds_read_b64_tr_b16 v[16:17], v1 offset:24576
  ds_read_b64_tr_b16 v[18:19], v1 offset:25088
  v_mfma_f32_16x16x32_bf16 a[168:171], v[24:27], a[56:59], a[168:171]
  ds_read_b64_tr_b16 v[20:21], v1 offset:24608
  v_exp_f32 v70, v70
  v_mfma_f32_16x16x32_bf16 a[172:175], v[24:27], a[60:63], a[172:175]
  ds_read_b64_tr_b16 v[22:23], v1 offset:25120
  s_add_u32 m0, s64, 6144
  v_mfma_f32_16x16x32_bf16 a[180:183], v[28:31], a[56:59], a[180:183]
  ds_read_b64_tr_b16 v[24:25], v1 offset:24640
  v_exp_f32 v71, v71
  v_mfma_f32_16x16x32_bf16 a[188:191], v[28:31], a[60:63], a[188:191]
  ds_read_b64_tr_b16 v[26:27], v1 offset:25152
  s_waitcnt lgkmcnt(6)
  v_mfma_f32_16x16x32_bf16 v[208:211], v[32:35], a[56:59], v[208:211]
  v_rcp_f32 v76, v76
  v_mfma_f32_16x16x32_bf16 v[212:215], v[32:35], a[60:63], v[212:215]
  ds_read_b64_tr_b16 v[28:29], v1 offset:24672
  ds_read_b64_tr_b16 v[30:31], v1 offset:25184
  v_mfma_f32_16x16x32_bf16 v[240:243], v[36:39], a[56:59], v[240:243]
  buffer_load_dwordx4 v5, s[20:23], s72 offen offset:0 lds
  v_mfma_f32_16x16x32_bf16 v[248:251], v[36:39], a[60:63], v[248:251]
  ds_read_b64_tr_b16 v[32:33], v1 offset:25600
  ds_read_b64_tr_b16 v[34:35], v1 offset:26112
  v_mfma_f32_16x16x32_bf16 v[232:235], v[40:43], a[56:59], v[232:235]
  ds_read_b64_tr_b16 v[36:37], v1 offset:25632
  v_rcp_f32 v77, v77
  v_rcp_f32 v78, v78
  v_rcp_f32 v79, v79
  v_pk_fma_f32 v[152:153], v[12:13], v[56:57], v[152:153] op_sel_hi:[0,1,1]
  v_pk_fma_f32 v[154:155], v[12:13], v[58:59], v[154:155] op_sel_hi:[0,1,1]
  v_pk_fma_f32 v[156:157], v[12:13], v[60:61], v[156:157] op_sel_hi:[0,1,1]
  v_pk_fma_f32 v[158:159], v[12:13], v[62:63], v[158:159] op_sel_hi:[0,1,1]
  v_pk_mul_f32 v[72:73], v[12:13], v[152:153] op_sel:[1,0] op_sel_hi:[1,1]
  v_pk_mul_f32 v[74:75], v[12:13], v[154:155] op_sel:[1,0] op_sel_hi:[1,1]
  v_pk_mul_f32 v[156:157], v[152:153], v[156:157]
  v_pk_mul_f32 v[158:159], v[154:155], v[158:159]
  v_pk_add_f32 v[68:69], v[4:5], v[68:69] op_sel_hi:[0,1]
  v_pk_add_f32 v[70:71], v[4:5], v[70:71] op_sel_hi:[0,1]
  v_pk_mul_f32 v[140:141], v[140:141], v[76:77]
  v_pk_mul_f32 v[142:143], v[142:143], v[78:79]
  v_mfma_f32_16x16x32_bf16 v[236:239], v[40:43], a[60:63], v[236:239]
  ds_read_b64_tr_b16 v[38:39], v1 offset:26144
  v_cvt_pk_bf16_f32 v92, v140, v141
  v_mfma_f32_16x16x32_bf16 v[244:247], v[44:47], a[56:59], v[244:247]
  ds_read_b64_tr_b16 v[40:41], v1 offset:25664
  v_cvt_pk_bf16_f32 v93, v142, v143
  v_mfma_f32_16x16x32_bf16 v[252:255], v[44:47], a[60:63], v[252:255]
  ds_read_b64_tr_b16 v[42:43], v1 offset:26176
  s_waitcnt lgkmcnt(6)
  v_mfma_f32_16x16x32_bf16 v[216:219], v[16:19], a[64:67], v[216:219]
  buffer_load_dwordx4 v5, s[24:27], s72 offen offset:1024 lds
  v_mfma_f32_16x16x32_bf16 v[220:223], v[16:19], a[68:71], v[220:223]
  ds_read_b64_tr_b16 v[44:45], v1 offset:25696
  ds_read_b64_tr_b16 v[46:47], v1 offset:26208
  v_mfma_f32_16x16x32_bf16 a[152:155], v[20:23], a[64:67], a[152:155]
  ds_read_b64_tr_b16 v[16:17], v2 offset:26624
  ds_read_b128 v[56:59], v9 offset:320
  v_mfma_f32_16x16x32_bf16 a[160:163], v[20:23], a[68:71], a[160:163]
  buffer_load_dwordx4 v7, s[28:31], s72 offen offset:2048 lds
  v_mfma_f32_16x16x32_bf16 v[224:227], v[24:27], a[64:67], v[224:227]
  ds_read_b64_tr_b16 v[18:19], v2 offset:27136
  ds_read_b64_tr_b16 v[20:21], v2 offset:26656
  v_mfma_f32_16x16x32_bf16 v[228:231], v[24:27], a[68:71], v[228:231]
  ds_read_b64_tr_b16 v[22:23], v2 offset:27168
ffn_hop38:
  s_cbranch_execz ffn_hop39
  ds_read_b128 v[60:63], v9 offset:2368
  v_mfma_f32_16x16x32_bf16 a[176:179], v[28:31], a[64:67], a[176:179]
  ds_read_b64_tr_b16 v[24:25], v3 offset:26624
  v_exp_f32 v72, v72
  v_mfma_f32_16x16x32_bf16 a[184:187], v[28:31], a[68:71], a[184:187]
  ds_read_b64_tr_b16 v[26:27], v3 offset:27136
  s_waitcnt lgkmcnt(8)
  v_mfma_f32_16x16x32_bf16 a[144:147], v[32:35], a[64:67], a[144:147]
  v_exp_f32 v73, v73
  v_mfma_f32_16x16x32_bf16 a[148:151], v[32:35], a[68:71], a[148:151]
  ds_read_b64_tr_b16 v[28:29], v3 offset:26656
  ds_read_b64_tr_b16 v[30:31], v3 offset:27168
  v_mfma_f32_16x16x32_bf16 a[156:159], v[36:39], a[64:67], a[156:159]
  s_waitcnt vmcnt(11)
  s_barrier
  ds_read_b64_tr_b16 v[32:33], v1 offset:27648
  v_mfma_f32_16x16x32_bf16 a[164:167], v[36:39], a[68:71], a[164:167]
  ds_read_b64_tr_b16 v[34:35], v1 offset:28160
  s_add_u32 s72, s65, 4423936
  v_mfma_f32_16x16x32_bf16 a[168:171], v[40:43], a[64:67], a[168:171]
  v_exp_f32 v74, v74
  v_mfma_f32_16x16x32_bf16 a[172:175], v[40:43], a[68:71], a[172:175]
  ds_read_b64_tr_b16 v[36:37], v1 offset:27680
  ds_read_b64_tr_b16 v[38:39], v1 offset:28192
  v_mfma_f32_16x16x32_bf16 a[180:183], v[44:47], a[64:67], a[180:183]
  ds_read_b64_tr_b16 v[40:41], v1 offset:27712
  v_exp_f32 v75, v75
  v_mfma_f32_16x16x32_bf16 a[188:191], v[44:47], a[68:71], a[188:191]
  ds_read_b64_tr_b16 v[42:43], v1 offset:28224
  s_waitcnt lgkmcnt(6)
  v_mfma_f32_16x16x32_bf16 v[208:211], v[16:19], a[64:67], v[208:211]
  ds_read_b64_tr_b16 v[44:45], v1 offset:27744
  s_add_u32 m0, s64, 9216
  v_mfma_f32_16x16x32_bf16 v[212:215], v[16:19], a[68:71], v[212:215]
  v_rcp_f32 v68, v68
  v_mfma_f32_16x16x32_bf16 v[240:243], v[20:23], a[64:67], v[240:243]
  ds_read_b64_tr_b16 v[46:47], v1 offset:28256
  ds_read_b64_tr_b16 v[16:17], v1 offset:28672
  v_mfma_f32_16x16x32_bf16 v[248:251], v[20:23], a[68:71], v[248:251]
  ds_read_b64_tr_b16 v[18:19], v1 offset:29184
  v_rcp_f32 v69, v69
  v_rcp_f32 v70, v70
  v_rcp_f32 v71, v71
  v_pk_fma_f32 v[96:97], v[10:11], v[48:49], v[96:97] op_sel_hi:[0,1,1]
  v_pk_fma_f32 v[98:99], v[10:11], v[50:51], v[98:99] op_sel_hi:[0,1,1]
  v_pk_fma_f32 v[160:161], v[10:11], v[52:53], v[160:161] op_sel_hi:[0,1,1]
  v_pk_fma_f32 v[162:163], v[10:11], v[54:55], v[162:163] op_sel_hi:[0,1,1]
  v_pk_mul_f32 v[76:77], v[10:11], v[96:97] op_sel:[1,0] op_sel_hi:[1,1]
  v_pk_mul_f32 v[78:79], v[10:11], v[98:99] op_sel:[1,0] op_sel_hi:[1,1]
  v_pk_mul_f32 v[160:161], v[96:97], v[160:161]
  v_pk_mul_f32 v[162:163], v[98:99], v[162:163]
  v_pk_add_f32 v[72:73], v[4:5], v[72:73] op_sel_hi:[0,1]
  v_pk_add_f32 v[74:75], v[4:5], v[74:75] op_sel_hi:[0,1]
  v_pk_mul_f32 v[148:149], v[148:149], v[68:69]
  v_pk_mul_f32 v[150:151], v[150:151], v[70:71]
  v_mfma_f32_16x16x32_bf16 v[232:235], v[24:27], a[64:67], v[232:235]
  buffer_load_dwordx4 v5, s[20:23], s72 offen offset:0 lds
  v_mfma_f32_16x16x32_bf16 v[236:239], v[24:27], a[68:71], v[236:239]
  ds_read_b64_tr_b16 v[20:21], v1 offset:28704
  ds_read_b64_tr_b16 v[22:23], v1 offset:29216
  v_mfma_f32_16x16x32_bf16 v[244:247], v[28:31], a[64:67], v[244:247]
  ds_read_b64_tr_b16 v[24:25], v1 offset:28736
  v_cvt_pk_bf16_f32 v90, v148, v149
  v_mfma_f32_16x16x32_bf16 v[252:255], v[28:31], a[68:71], v[252:255]
  ds_read_b64_tr_b16 v[26:27], v1 offset:29248
  s_waitcnt lgkmcnt(6)
ffn_hop39:
  s_cbranch_execz ffn_hop40
  v_mfma_f32_16x16x32_bf16 v[216:219], v[32:35], a[72:75], v[216:219]
  buffer_load_dwordx4 v5, s[24:27], s72 offen offset:1024 lds
  v_mfma_f32_16x16x32_bf16 v[220:223], v[32:35], a[76:79], v[220:223]
  ds_read_b64_tr_b16 v[28:29], v1 offset:28768
  ds_read_b64_tr_b16 v[30:31], v1 offset:29280
  v_mfma_f32_16x16x32_bf16 a[152:155], v[36:39], a[72:75], a[152:155]
  ds_read_b64_tr_b16 v[32:33], v2 offset:29696
  v_cvt_pk_bf16_f32 v91, v150, v151
  v_mfma_f32_16x16x32_bf16 a[160:163], v[36:39], a[76:79], a[160:163]
  buffer_store_dwordx4 v[88:91], v8, s[48:51], 0 offen offset:2048 sc1
  v_mfma_f32_16x16x32_bf16 v[224:227], v[40:43], a[72:75], v[224:227]
  ds_read_b64_tr_b16 v[34:35], v2 offset:30208
  ds_read_b64_tr_b16 v[36:37], v2 offset:29728
  v_mfma_f32_16x16x32_bf16 v[228:231], v[40:43], a[76:79], v[228:231]
  buffer_load_dwordx4 v7, s[28:31], s72 offen offset:2048 lds
  v_mfma_f32_16x16x32_bf16 a[176:179], v[44:47], a[72:75], a[176:179]
  ds_read_b64_tr_b16 v[38:39], v2 offset:30240
  ds_read_b64_tr_b16 v[40:41], v3 offset:29696
  v_mfma_f32_16x16x32_bf16 a[184:187], v[44:47], a[76:79], a[184:187]
  ds_read_b64_tr_b16 v[42:43], v3 offset:30208
  s_waitcnt lgkmcnt(6)
  v_mfma_f32_16x16x32_bf16 a[144:147], v[16:19], a[72:75], a[144:147]
  v_exp_f32 v76, v76
  v_mfma_f32_16x16x32_bf16 a[148:151], v[16:19], a[76:79], a[148:151]
  ds_read_b64_tr_b16 v[44:45], v3 offset:29728
  ds_read_b64_tr_b16 v[46:47], v3 offset:30240
  v_mfma_f32_16x16x32_bf16 a[156:159], v[20:23], a[72:75], a[156:159]
  ds_read_b64_tr_b16 v[16:17], v1 offset:30720
  s_add_u32 s72, s65, 4718848
  v_mfma_f32_16x16x32_bf16 a[164:167], v[20:23], a[76:79], a[164:167]
  v_exp_f32 v77, v77
  v_mfma_f32_16x16x32_bf16 a[168:171], v[24:27], a[72:75], a[168:171]
  ds_read_b64_tr_b16 v[18:19], v1 offset:31232
  ds_read_b64_tr_b16 v[20:21], v1 offset:30752
  v_mfma_f32_16x16x32_bf16 a[172:175], v[24:27], a[76:79], a[172:175]
  ds_read_b64_tr_b16 v[22:23], v1 offset:31264
  v_exp_f32 v78, v78
  v_mfma_f32_16x16x32_bf16 a[180:183], v[28:31], a[72:75], a[180:183]
  ds_read_b64_tr_b16 v[24:25], v1 offset:30784
  s_add_u32 m0, s64, 12288
  v_mfma_f32_16x16x32_bf16 a[188:191], v[28:31], a[76:79], a[188:191]
  ds_read_b64_tr_b16 v[26:27], v1 offset:31296
  s_waitcnt lgkmcnt(6)
  v_mfma_f32_16x16x32_bf16 v[208:211], v[32:35], a[72:75], v[208:211]
  v_exp_f32 v79, v79
  v_mfma_f32_16x16x32_bf16 v[212:215], v[32:35], a[76:79], v[212:215]
  ds_read_b64_tr_b16 v[28:29], v1 offset:30816
  ds_read_b64_tr_b16 v[30:31], v1 offset:31328
  v_mfma_f32_16x16x32_bf16 v[240:243], v[36:39], a[72:75], v[240:243]
  ds_read_b64_tr_b16 v[32:33], v1 offset:31744
  v_rcp_f32 v72, v72
  v_mfma_f32_16x16x32_bf16 v[248:251], v[36:39], a[76:79], v[248:251]
  buffer_load_dwordx4 v5, s[20:23], s72 offen offset:0 lds
  v_mfma_f32_16x16x32_bf16 v[232:235], v[40:43], a[72:75], v[232:235]
  ds_read_b64_tr_b16 v[34:35], v1 offset:32256
  ds_read_b64_tr_b16 v[36:37], v1 offset:31776
  v_mfma_f32_16x16x32_bf16 v[236:239], v[40:43], a[76:79], v[236:239]
  ds_read_b64_tr_b16 v[38:39], v1 offset:32288
  v_rcp_f32 v73, v73
  v_rcp_f32 v74, v74
  v_rcp_f32 v75, v75
  v_pk_fma_f32 v[100:101], v[12:13], v[48:49], v[100:101] op_sel_hi:[0,1,1]
  v_pk_fma_f32 v[102:103], v[12:13], v[50:51], v[102:103] op_sel_hi:[0,1,1]
  v_pk_fma_f32 v[164:165], v[12:13], v[52:53], v[164:165] op_sel_hi:[0,1,1]
  v_pk_fma_f32 v[166:167], v[12:13], v[54:55], v[166:167] op_sel_hi:[0,1,1]
  v_pk_mul_f32 v[68:69], v[12:13], v[100:101] op_sel:[1,0] op_sel_hi:[1,1]
  v_pk_mul_f32 v[70:71], v[12:13], v[102:103] op_sel:[1,0] op_sel_hi:[1,1]
  v_pk_mul_f32 v[164:165], v[100:101], v[164:165]
  v_pk_mul_f32 v[166:167], v[102:103], v[166:167]
ffn_hop40:
  s_cbranch_execz ffn_hop41
  v_pk_add_f32 v[76:77], v[4:5], v[76:77] op_sel_hi:[0,1]
  v_pk_add_f32 v[78:79], v[4:5], v[78:79] op_sel_hi:[0,1]
  v_pk_mul_f32 v[156:157], v[156:157], v[72:73]
  v_pk_mul_f32 v[158:159], v[158:159], v[74:75]
  v_mfma_f32_16x16x32_bf16 v[244:247], v[44:47], a[72:75], v[244:247]
  ds_read_b64_tr_b16 v[40:41], v1 offset:31808
  v_cvt_pk_bf16_f32 v94, v156, v157
  v_mfma_f32_16x16x32_bf16 v[252:255], v[44:47], a[76:79], v[252:255]
  ds_read_b64_tr_b16 v[42:43], v1 offset:32320
  s_waitcnt lgkmcnt(6)
  v_mfma_f32_16x16x32_bf16 v[216:219], v[16:19], a[80:83], v[216:219]
  buffer_load_dwordx4 v5, s[24:27], s72 offen offset:1024 lds
  v_mfma_f32_16x16x32_bf16 v[220:223], v[16:19], a[84:87], v[220:223]
  ds_read_b64_tr_b16 v[44:45], v1 offset:31840
  ds_read_b64_tr_b16 v[46:47], v1 offset:32352
  v_mfma_f32_16x16x32_bf16 a[152:155], v[20:23], a[80:83], a[152:155]
  ds_read_b64_tr_b16 v[16:17], v2 offset:32768
  v_cvt_pk_bf16_f32 v95, v158, v159
  v_mfma_f32_16x16x32_bf16 a[160:163], v[20:23], a[84:87], a[160:163]
  ds_read_b64_tr_b16 v[18:19], v2 offset:33280
  buffer_store_dwordx4 v[92:95], v8, s[48:51], 0 offen offset:3072 sc1
  v_mfma_f32_16x16x32_bf16 v[224:227], v[24:27], a[80:83], v[224:227]
  buffer_load_dwordx4 v7, s[28:31], s72 offen offset:2048 lds
  v_mfma_f32_16x16x32_bf16 v[228:231], v[24:27], a[84:87], v[228:231]
  ds_read_b64_tr_b16 v[20:21], v2 offset:32800
  ds_read_b64_tr_b16 v[22:23], v2 offset:33312
  v_mfma_f32_16x16x32_bf16 a[176:179], v[28:31], a[80:83], a[176:179]
  ds_read_b64_tr_b16 v[24:25], v3 offset:32768
  ds_read_b128 v[48:51], v9 offset:384
  v_mfma_f32_16x16x32_bf16 a[184:187], v[28:31], a[84:87], a[184:187]
  ds_read_b64_tr_b16 v[26:27], v3 offset:33280
  s_waitcnt lgkmcnt(7)
  v_mfma_f32_16x16x32_bf16 a[144:147], v[32:35], a[80:83], a[144:147]
  ds_read_b64_tr_b16 v[28:29], v3 offset:32800
  ds_read_b128 v[52:55], v9 offset:2432
  v_mfma_f32_16x16x32_bf16 a[148:151], v[32:35], a[84:87], a[148:151]
  ds_read_b64_tr_b16 v[30:31], v3 offset:33312
  s_add_u32 s72, s65, 5013760
  v_mfma_f32_16x16x32_bf16 a[156:159], v[36:39], a[80:83], a[156:159]
  v_exp_f32 v68, v68
  v_mfma_f32_16x16x32_bf16 a[164:167], v[36:39], a[84:87], a[164:167]
  ds_read_b64_tr_b16 v[32:33], v1 offset:33792
  ds_read_b64_tr_b16 v[34:35], v1 offset:34304
  v_mfma_f32_16x16x32_bf16 a[168:171], v[40:43], a[80:83], a[168:171]
  ds_read_b64_tr_b16 v[36:37], v1 offset:33824
  v_exp_f32 v69, v69
  v_mfma_f32_16x16x32_bf16 a[172:175], v[40:43], a[84:87], a[172:175]
  ds_read_b64_tr_b16 v[38:39], v1 offset:34336
  s_add_u32 m0, s64, 15360
  v_mfma_f32_16x16x32_bf16 a[180:183], v[44:47], a[80:83], a[180:183]
  ds_read_b64_tr_b16 v[40:41], v1 offset:33856
  v_exp_f32 v70, v70
  v_mfma_f32_16x16x32_bf16 a[188:191], v[44:47], a[84:87], a[188:191]
  ds_read_b64_tr_b16 v[42:43], v1 offset:34368
  s_waitcnt lgkmcnt(6)
  v_mfma_f32_16x16x32_bf16 v[208:211], v[16:19], a[80:83], v[208:211]
  v_exp_f32 v71, v71
  v_mfma_f32_16x16x32_bf16 v[212:215], v[16:19], a[84:87], v[212:215]
  ds_read_b64_tr_b16 v[44:45], v1 offset:33888
  ds_read_b64_tr_b16 v[46:47], v1 offset:34400
  v_mfma_f32_16x16x32_bf16 v[240:243], v[20:23], a[80:83], v[240:243]
  buffer_load_dwordx4 v5, s[20:23], s72 offen offset:0 lds
  v_mfma_f32_16x16x32_bf16 v[248:251], v[20:23], a[84:87], v[248:251]
  ds_read_b64_tr_b16 v[16:17], v1 offset:34816
  ds_read_b64_tr_b16 v[18:19], v1 offset:35328
  v_mfma_f32_16x16x32_bf16 v[232:235], v[24:27], a[80:83], v[232:235]
  v_rcp_f32 v76, v76
ffn_hop41:
  s_cbranch_execz ffn_hop42
  v_mfma_f32_16x16x32_bf16 v[236:239], v[24:27], a[84:87], v[236:239]
  ds_read_b64_tr_b16 v[20:21], v1 offset:34848
  ds_read_b64_tr_b16 v[22:23], v1 offset:35360
  v_mfma_f32_16x16x32_bf16 v[244:247], v[28:31], a[80:83], v[244:247]
  ds_read_b64_tr_b16 v[24:25], v1 offset:34880
  v_rcp_f32 v77, v77
  v_rcp_f32 v78, v78
  v_rcp_f32 v79, v79
  v_pk_fma_f32 v[168:169], v[10:11], v[56:57], v[168:169] op_sel_hi:[0,1,1]
  v_pk_fma_f32 v[170:171], v[10:11], v[58:59], v[170:171] op_sel_hi:[0,1,1]
  v_pk_fma_f32 v[172:173], v[10:11], v[60:61], v[172:173] op_sel_hi:[0,1,1]
  v_pk_fma_f32 v[174:175], v[10:11], v[62:63], v[174:175] op_sel_hi:[0,1,1]
  v_pk_mul_f32 v[72:73], v[10:11], v[168:169] op_sel:[1,0] op_sel_hi:[1,1]
  v_pk_mul_f32 v[74:75], v[10:11], v[170:171] op_sel:[1,0] op_sel_hi:[1,1]
  v_pk_mul_f32 v[172:173], v[168:169], v[172:173]
  v_pk_mul_f32 v[174:175], v[170:171], v[174:175]
  v_pk_add_f32 v[68:69], v[4:5], v[68:69] op_sel_hi:[0,1]
  v_pk_add_f32 v[70:71], v[4:5], v[70:71] op_sel_hi:[0,1]
  v_pk_mul_f32 v[160:161], v[160:161], v[76:77]
  v_pk_mul_f32 v[162:163], v[162:163], v[78:79]
  v_mfma_f32_16x16x32_bf16 v[252:255], v[28:31], a[84:87], v[252:255]
  ds_read_b64_tr_b16 v[26:27], v1 offset:35392
  s_waitcnt lgkmcnt(6)
  v_mfma_f32_16x16x32_bf16 v[216:219], v[32:35], a[88:91], v[216:219]
  buffer_load_dwordx4 v5, s[24:27], s72 offen offset:1024 lds
  v_mfma_f32_16x16x32_bf16 v[220:223], v[32:35], a[92:95], v[220:223]
  ds_read_b64_tr_b16 v[28:29], v1 offset:34912
  ds_read_b64_tr_b16 v[30:31], v1 offset:35424
  v_mfma_f32_16x16x32_bf16 a[152:155], v[36:39], a[88:91], a[152:155]
  ds_read_b64_tr_b16 v[32:33], v2 offset:35840
  v_cvt_pk_bf16_f32 v96, v160, v161
  v_mfma_f32_16x16x32_bf16 a[160:163], v[36:39], a[92:95], a[160:163]
  buffer_load_dwordx4 v7, s[28:31], s72 offen offset:2048 lds
  v_mfma_f32_16x16x32_bf16 v[224:227], v[40:43], a[88:91], v[224:227]
  ds_read_b64_tr_b16 v[34:35], v2 offset:36352
  ds_read_b64_tr_b16 v[36:37], v2 offset:35872
  v_mfma_f32_16x16x32_bf16 v[228:231], v[40:43], a[92:95], v[228:231]
  ds_read_b64_tr_b16 v[38:39], v2 offset:36384
  v_cvt_pk_bf16_f32 v97, v162, v163
  v_mfma_f32_16x16x32_bf16 a[176:179], v[44:47], a[88:91], a[176:179]
  ds_read_b64_tr_b16 v[40:41], v3 offset:35840
  v_exp_f32 v72, v72
  v_mfma_f32_16x16x32_bf16 a[184:187], v[44:47], a[92:95], a[184:187]
  ds_read_b64_tr_b16 v[42:43], v3 offset:36352
  s_waitcnt lgkmcnt(6)
  v_mfma_f32_16x16x32_bf16 a[144:147], v[16:19], a[88:91], a[144:147]
  v_exp_f32 v73, v73
  v_mfma_f32_16x16x32_bf16 a[148:151], v[16:19], a[92:95], a[148:151]
  ds_read_b64_tr_b16 v[44:45], v3 offset:35872
  ds_read_b64_tr_b16 v[46:47], v3 offset:36384
  v_mfma_f32_16x16x32_bf16 a[156:159], v[20:23], a[88:91], a[156:159]
  s_waitcnt vmcnt(11)
  s_barrier
  ds_read_b64_tr_b16 v[16:17], v1 offset:0
  v_mfma_f32_16x16x32_bf16 a[164:167], v[20:23], a[92:95], a[164:167]
  ds_read_b64_tr_b16 v[18:19], v1 offset:512
  v_add_u32 v6, 292864, v5
  v_mfma_f32_16x16x32_bf16 a[168:171], v[24:27], a[88:91], a[168:171]
  v_exp_f32 v74, v74
  v_mfma_f32_16x16x32_bf16 a[172:175], v[24:27], a[92:95], a[172:175]
  ds_read_b64_tr_b16 v[20:21], v1 offset:32
  ds_read_b64_tr_b16 v[22:23], v1 offset:544
  v_mfma_f32_16x16x32_bf16 a[180:183], v[28:31], a[88:91], a[180:183]
  ds_read_b64_tr_b16 v[24:25], v1 offset:64
  v_exp_f32 v75, v75
  v_mfma_f32_16x16x32_bf16 a[188:191], v[28:31], a[92:95], a[188:191]
  ds_read_b64_tr_b16 v[26:27], v1 offset:576
  s_waitcnt lgkmcnt(6)
  v_mfma_f32_16x16x32_bf16 v[208:211], v[32:35], a[88:91], v[208:211]
  ds_read_b64_tr_b16 v[28:29], v1 offset:96
ffn_hop42:
  s_cbranch_execz ffn_hop43
  s_add_u32 s72, s65, 384
  v_mfma_f32_16x16x32_bf16 v[212:215], v[32:35], a[92:95], v[212:215]
  v_rcp_f32 v68, v68
  v_mfma_f32_16x16x32_bf16 v[240:243], v[36:39], a[88:91], v[240:243]
  ds_read_b64_tr_b16 v[30:31], v1 offset:608
  ds_read_b64_tr_b16 v[32:33], v1 offset:1024
  v_mfma_f32_16x16x32_bf16 v[248:251], v[36:39], a[92:95], v[248:251]
  ds_read_b64_tr_b16 v[34:35], v1 offset:1536
  v_rcp_f32 v69, v69
  v_rcp_f32 v70, v70
  v_rcp_f32 v71, v71
  v_pk_fma_f32 v[176:177], v[12:13], v[56:57], v[176:177] op_sel_hi:[0,1,1]
  v_pk_fma_f32 v[178:179], v[12:13], v[58:59], v[178:179] op_sel_hi:[0,1,1]
  v_pk_fma_f32 v[180:181], v[12:13], v[60:61], v[180:181] op_sel_hi:[0,1,1]
  v_pk_fma_f32 v[182:183], v[12:13], v[62:63], v[182:183] op_sel_hi:[0,1,1]
  v_pk_mul_f32 v[76:77], v[12:13], v[176:177] op_sel:[1,0] op_sel_hi:[1,1]
  v_pk_mul_f32 v[78:79], v[12:13], v[178:179] op_sel:[1,0] op_sel_hi:[1,1]
  v_pk_mul_f32 v[180:181], v[176:177], v[180:181]
  v_pk_mul_f32 v[182:183], v[178:179], v[182:183]
  v_pk_add_f32 v[72:73], v[4:5], v[72:73] op_sel_hi:[0,1]
  v_pk_add_f32 v[74:75], v[4:5], v[74:75] op_sel_hi:[0,1]
  v_pk_mul_f32 v[164:165], v[164:165], v[68:69]
  v_pk_mul_f32 v[166:167], v[166:167], v[70:71]
  v_mfma_f32_16x16x32_bf16 v[232:235], v[40:43], a[88:91], v[232:235]
  ds_read_b64_tr_b16 v[36:37], v1 offset:1056
  v_cvt_pk_bf16_f32 v100, v164, v165
  v_mfma_f32_16x16x32_bf16 v[236:239], v[40:43], a[92:95], v[236:239]
  ds_read_b64_tr_b16 v[38:39], v1 offset:1568
  s_add_u32 m0, s64, 18432
  v_mfma_f32_16x16x32_bf16 v[244:247], v[44:47], a[88:91], v[244:247]
  ds_read_b64_tr_b16 v[40:41], v1 offset:1088
  v_cvt_pk_bf16_f32 v101, v166, v167
  v_mfma_f32_16x16x32_bf16 v[252:255], v[44:47], a[92:95], v[252:255]
  ds_read_b64_tr_b16 v[42:43], v1 offset:1600
  s_waitcnt lgkmcnt(6)
  v_mfma_f32_16x16x32_bf16 v[216:219], v[16:19], a[96:99], v[216:219]
  ds_read_b64_tr_b16 v[44:45], v1 offset:1120
  ds_read_b128 v[56:59], v9 offset:448
  v_mfma_f32_16x16x32_bf16 v[220:223], v[16:19], a[100:103], v[220:223]
  ds_read_b64_tr_b16 v[46:47], v1 offset:1632
  ds_read_b128 v[60:63], v9 offset:2496
  v_mfma_f32_16x16x32_bf16 a[152:155], v[20:23], a[96:99], a[152:155]
  buffer_load_dwordx4 v5, s[20:23], s72 offen offset:0 lds
  v_mfma_f32_16x16x32_bf16 a[160:163], v[20:23], a[100:103], a[160:163]
  ds_read_b64_tr_b16 v[16:17], v2 offset:2048
  ds_read_b64_tr_b16 v[18:19], v2 offset:2560
  v_mfma_f32_16x16x32_bf16 v[224:227], v[24:27], a[96:99], v[224:227]
  v_exp_f32 v76, v76
  v_mfma_f32_16x16x32_bf16 v[228:231], v[24:27], a[100:103], v[228:231]
  ds_read_b64_tr_b16 v[20:21], v2 offset:2080
  ds_read_b64_tr_b16 v[22:23], v2 offset:2592
  v_mfma_f32_16x16x32_bf16 a[176:179], v[28:31], a[96:99], a[176:179]
  ds_read_b64_tr_b16 v[24:25], v3 offset:2048
  v_exp_f32 v77, v77
  v_mfma_f32_16x16x32_bf16 a[184:187], v[28:31], a[100:103], a[184:187]
  ds_read_b64_tr_b16 v[26:27], v3 offset:2560
  s_waitcnt lgkmcnt(7)
  v_mfma_f32_16x16x32_bf16 a[144:147], v[32:35], a[96:99], a[144:147]
  buffer_load_dwordx4 v5, s[24:27], s72 offen offset:1024 lds
  v_mfma_f32_16x16x32_bf16 a[148:151], v[32:35], a[100:103], a[148:151]
  ds_read_b64_tr_b16 v[28:29], v3 offset:2080
  ds_read_b64_tr_b16 v[30:31], v3 offset:2592
  v_mfma_f32_16x16x32_bf16 a[156:159], v[36:39], a[96:99], a[156:159]
  v_exp_f32 v78, v78
  v_mfma_f32_16x16x32_bf16 a[164:167], v[36:39], a[100:103], a[164:167]
  ds_read_b64_tr_b16 v[32:33], v1 offset:3072
  ds_read_b64_tr_b16 v[34:35], v1 offset:3584
  v_mfma_f32_16x16x32_bf16 a[168:171], v[40:43], a[96:99], a[168:171]
  ds_read_b64_tr_b16 v[36:37], v1 offset:3104
  v_exp_f32 v79, v79
  v_mfma_f32_16x16x32_bf16 a[172:175], v[40:43], a[100:103], a[172:175]
  buffer_load_dwordx4 v6, s[20:23], s72 offen offset:2048 lds
ffn_hop43:
  s_cbranch_execz ffn_hop44
  v_mfma_f32_16x16x32_bf16 a[180:183], v[44:47], a[96:99], a[180:183]
  ds_read_b64_tr_b16 v[38:39], v1 offset:3616
  ds_read_b64_tr_b16 v[40:41], v1 offset:3136
  v_mfma_f32_16x16x32_bf16 a[188:191], v[44:47], a[100:103], a[188:191]
  ds_read_b64_tr_b16 v[42:43], v1 offset:3648
  s_waitcnt lgkmcnt(6)
  v_mfma_f32_16x16x32_bf16 v[208:211], v[16:19], a[96:99], v[208:211]
  v_rcp_f32 v72, v72
  v_mfma_f32_16x16x32_bf16 v[212:215], v[16:19], a[100:103], v[212:215]
  ds_read_b64_tr_b16 v[44:45], v1 offset:3168
  ds_read_b64_tr_b16 v[46:47], v1 offset:3680
  v_mfma_f32_16x16x32_bf16 v[240:243], v[20:23], a[96:99], v[240:243]
  buffer_load_dwordx4 v6, s[24:27], s72 offen offset:3072 lds
  v_mfma_f32_16x16x32_bf16 v[248:251], v[20:23], a[100:103], v[248:251]
  ds_read_b64_tr_b16 v[16:17], v1 offset:4096
  ds_read_b64_tr_b16 v[18:19], v1 offset:4608
  v_mfma_f32_16x16x32_bf16 v[232:235], v[24:27], a[96:99], v[232:235]
  ds_read_b64_tr_b16 v[20:21], v1 offset:4128
  v_rcp_f32 v73, v73
  v_rcp_f32 v74, v74
  v_rcp_f32 v75, v75
  v_pk_fma_f32 v[104:105], v[10:11], v[48:49], v[104:105] op_sel_hi:[0,1,1]
  v_pk_fma_f32 v[106:107], v[10:11], v[50:51], v[106:107] op_sel_hi:[0,1,1]
  v_pk_fma_f32 v[184:185], v[10:11], v[52:53], v[184:185] op_sel_hi:[0,1,1]
  v_pk_fma_f32 v[186:187], v[10:11], v[54:55], v[186:187] op_sel_hi:[0,1,1]
  v_pk_mul_f32 v[68:69], v[10:11], v[104:105] op_sel:[1,0] op_sel_hi:[1,1]
  v_pk_mul_f32 v[70:71], v[10:11], v[106:107] op_sel:[1,0] op_sel_hi:[1,1]
  v_pk_mul_f32 v[184:185], v[104:105], v[184:185]
  v_pk_mul_f32 v[186:187], v[106:107], v[186:187]
  v_pk_add_f32 v[76:77], v[4:5], v[76:77] op_sel_hi:[0,1]
  v_pk_add_f32 v[78:79], v[4:5], v[78:79] op_sel_hi:[0,1]
  v_pk_mul_f32 v[172:173], v[172:173], v[72:73]
  v_pk_mul_f32 v[174:175], v[174:175], v[74:75]
  v_mfma_f32_16x16x32_bf16 v[236:239], v[24:27], a[100:103], v[236:239]
  ds_read_b64_tr_b16 v[22:23], v1 offset:4640
  v_cvt_pk_bf16_f32 v98, v172, v173
  v_mfma_f32_16x16x32_bf16 v[244:247], v[28:31], a[96:99], v[244:247]
  ds_read_b64_tr_b16 v[24:25], v1 offset:4160
  v_cvt_pk_bf16_f32 v99, v174, v175
  v_mfma_f32_16x16x32_bf16 v[252:255], v[28:31], a[100:103], v[252:255]
  ds_read_b64_tr_b16 v[26:27], v1 offset:4672
  s_waitcnt lgkmcnt(6)
  v_mfma_f32_16x16x32_bf16 v[216:219], v[32:35], a[104:107], v[216:219]
  ds_read_b64_tr_b16 v[28:29], v1 offset:4192
  s_add_u32 s72, s65, 590208
  v_mfma_f32_16x16x32_bf16 v[220:223], v[32:35], a[108:111], v[220:223]
  buffer_store_dwordx4 v[96:99], v8, s[48:51], s80 offen offset:0 sc1
  v_mfma_f32_16x16x32_bf16 a[152:155], v[36:39], a[104:107], a[152:155]
  ds_read_b64_tr_b16 v[30:31], v1 offset:4704
  ds_read_b64_tr_b16 v[32:33], v2 offset:5120
  v_mfma_f32_16x16x32_bf16 a[160:163], v[36:39], a[108:111], a[160:163]
  v_exp_f32 v68, v68
  v_mfma_f32_16x16x32_bf16 v[224:227], v[40:43], a[104:107], v[224:227]
  ds_read_b64_tr_b16 v[34:35], v2 offset:5632
  ds_read_b64_tr_b16 v[36:37], v2 offset:5152
  v_mfma_f32_16x16x32_bf16 v[228:231], v[40:43], a[108:111], v[228:231]
  ds_read_b64_tr_b16 v[38:39], v2 offset:5664
  s_add_u32 m0, s64, 22528
  v_mfma_f32_16x16x32_bf16 a[176:179], v[44:47], a[104:107], a[176:179]
  ds_read_b64_tr_b16 v[40:41], v3 offset:5120
  v_exp_f32 v69, v69
  v_mfma_f32_16x16x32_bf16 a[184:187], v[44:47], a[108:111], a[184:187]
  ds_read_b64_tr_b16 v[42:43], v3 offset:5632
  s_waitcnt lgkmcnt(6)
ffn_hop44:
  s_cbranch_execz ffn_hop45
  v_mfma_f32_16x16x32_bf16 a[144:147], v[16:19], a[104:107], a[144:147]
  v_exp_f32 v70, v70
  v_mfma_f32_16x16x32_bf16 a[148:151], v[16:19], a[108:111], a[148:151]
  ds_read_b64_tr_b16 v[44:45], v3 offset:5152
  ds_read_b64_tr_b16 v[46:47], v3 offset:5664
  v_mfma_f32_16x16x32_bf16 a[156:159], v[20:23], a[104:107], a[156:159]
  buffer_load_dwordx4 v5, s[20:23], s72 offen offset:0 lds
  v_mfma_f32_16x16x32_bf16 a[164:167], v[20:23], a[108:111], a[164:167]
  ds_read_b64_tr_b16 v[16:17], v1 offset:6144
  ds_read_b64_tr_b16 v[18:19], v1 offset:6656
  v_mfma_f32_16x16x32_bf16 a[168:171], v[24:27], a[104:107], a[168:171]
  v_exp_f32 v71, v71
  v_mfma_f32_16x16x32_bf16 a[172:175], v[24:27], a[108:111], a[172:175]
  ds_read_b64_tr_b16 v[20:21], v1 offset:6176
  ds_read_b64_tr_b16 v[22:23], v1 offset:6688
  v_mfma_f32_16x16x32_bf16 a[180:183], v[28:31], a[104:107], a[180:183]
  ds_read_b64_tr_b16 v[24:25], v1 offset:6208
  v_rcp_f32 v76, v76
  v_mfma_f32_16x16x32_bf16 a[188:191], v[28:31], a[108:111], a[188:191]
  ds_read_b64_tr_b16 v[26:27], v1 offset:6720
  s_waitcnt lgkmcnt(6)
  v_mfma_f32_16x16x32_bf16 v[208:211], v[32:35], a[104:107], v[208:211]
  buffer_load_dwordx4 v5, s[24:27], s72 offen offset:1024 lds
  v_mfma_f32_16x16x32_bf16 v[212:215], v[32:35], a[108:111], v[212:215]
  ds_read_b64_tr_b16 v[28:29], v1 offset:6240
  ds_read_b64_tr_b16 v[30:31], v1 offset:6752
  v_mfma_f32_16x16x32_bf16 v[240:243], v[36:39], a[104:107], v[240:243]
  ds_read_b64_tr_b16 v[32:33], v1 offset:7168
  v_rcp_f32 v77, v77
  v_rcp_f32 v78, v78
  v_rcp_f32 v79, v79
  v_pk_fma_f32 v[108:109], v[12:13], v[48:49], v[108:109] op_sel_hi:[0,1,1]
  v_pk_fma_f32 v[110:111], v[12:13], v[50:51], v[110:111] op_sel_hi:[0,1,1]
  v_pk_fma_f32 v[188:189], v[12:13], v[52:53], v[188:189] op_sel_hi:[0,1,1]
  v_pk_fma_f32 v[190:191], v[12:13], v[54:55], v[190:191] op_sel_hi:[0,1,1]
  v_pk_mul_f32 v[72:73], v[12:13], v[108:109] op_sel:[1,0] op_sel_hi:[1,1]
  v_pk_mul_f32 v[74:75], v[12:13], v[110:111] op_sel:[1,0] op_sel_hi:[1,1]
  v_pk_mul_f32 v[188:189], v[108:109], v[188:189]
  v_pk_mul_f32 v[190:191], v[110:111], v[190:191]
  v_pk_add_f32 v[68:69], v[4:5], v[68:69] op_sel_hi:[0,1]
  v_pk_add_f32 v[70:71], v[4:5], v[70:71] op_sel_hi:[0,1]
  v_pk_mul_f32 v[180:181], v[180:181], v[76:77]
  v_pk_mul_f32 v[182:183], v[182:183], v[78:79]
  v_mfma_f32_16x16x32_bf16 v[248:251], v[36:39], a[108:111], v[248:251]
  ds_read_b64_tr_b16 v[34:35], v1 offset:7680
  v_cvt_pk_bf16_f32 v102, v180, v181
  v_mfma_f32_16x16x32_bf16 v[232:235], v[40:43], a[104:107], v[232:235]
  ds_read_b64_tr_b16 v[36:37], v1 offset:7200
  v_cvt_pk_bf16_f32 v103, v182, v183
  v_mfma_f32_16x16x32_bf16 v[236:239], v[40:43], a[108:111], v[236:239]
  buffer_load_dwordx4 v6, s[20:23], s72 offen offset:2048 lds
  v_mfma_f32_16x16x32_bf16 v[244:247], v[44:47], a[104:107], v[244:247]
  ds_read_b64_tr_b16 v[38:39], v1 offset:7712
  ds_read_b64_tr_b16 v[40:41], v1 offset:7232
  v_mfma_f32_16x16x32_bf16 v[252:255], v[44:47], a[108:111], v[252:255]
  ds_read_b64_tr_b16 v[42:43], v1 offset:7744
  s_waitcnt lgkmcnt(6)
  v_mfma_f32_16x16x32_bf16 v[216:219], v[16:19], a[112:115], v[216:219]
  buffer_store_dwordx4 v[100:103], v8, s[48:51], s80 offen offset:1024 sc1
  v_mfma_f32_16x16x32_bf16 v[220:223], v[16:19], a[116:119], v[220:223]
  ds_read_b64_tr_b16 v[44:45], v1 offset:7264
  ds_read_b64_tr_b16 v[46:47], v1 offset:7776
  v_mfma_f32_16x16x32_bf16 a[152:155], v[20:23], a[112:115], a[152:155]
  buffer_load_dwordx4 v6, s[24:27], s72 offen offset:3072 lds
  v_mfma_f32_16x16x32_bf16 a[160:163], v[20:23], a[116:119], a[160:163]
  ds_read_b64_tr_b16 v[16:17], v2 offset:8192
  ds_read_b64_tr_b16 v[18:19], v2 offset:8704
  v_mfma_f32_16x16x32_bf16 v[224:227], v[24:27], a[112:115], v[224:227]
  ds_read_b64_tr_b16 v[20:21], v2 offset:8224
  s_mul_i32 s86, s17, -1152
  v_mfma_f32_16x16x32_bf16 v[228:231], v[24:27], a[116:119], v[228:231]
  ds_read_b64_tr_b16 v[22:23], v2 offset:8736
ffn_hop45:
  s_cbranch_execz ffn_hop46
  s_add_u32 s86, s86, 0
  v_mfma_f32_16x16x32_bf16 a[176:179], v[28:31], a[112:115], a[176:179]
  ds_read_b64_tr_b16 v[24:25], v3 offset:8192
  v_add_u32 v9, s86, v9
  v_mfma_f32_16x16x32_bf16 a[184:187], v[28:31], a[116:119], a[184:187]
  ds_read_b64_tr_b16 v[26:27], v3 offset:8704
  s_waitcnt lgkmcnt(6)
  v_mfma_f32_16x16x32_bf16 a[144:147], v[32:35], a[112:115], a[144:147]
  ds_read_b64_tr_b16 v[28:29], v3 offset:8224
  ds_read_b128 v[48:51], v9 offset:1024
  v_mfma_f32_16x16x32_bf16 a[148:151], v[32:35], a[116:119], a[148:151]
  ds_read_b64_tr_b16 v[30:31], v3 offset:8736
  ds_read_b128 v[52:55], v9 offset:3072
  v_mfma_f32_16x16x32_bf16 a[156:159], v[36:39], a[112:115], a[156:159]
  s_waitcnt vmcnt(10)
  s_barrier
  ds_read_b64_tr_b16 v[32:33], v1 offset:9216
  v_mfma_f32_16x16x32_bf16 a[164:167], v[36:39], a[116:119], a[164:167]
  ds_read_b64_tr_b16 v[34:35], v1 offset:9728
  s_add_u32 s72, s65, 1180032
  v_mfma_f32_16x16x32_bf16 a[168:171], v[40:43], a[112:115], a[168:171]
  v_exp_f32 v72, v72
  v_mfma_f32_16x16x32_bf16 a[172:175], v[40:43], a[116:119], a[172:175]
  ds_read_b64_tr_b16 v[36:37], v1 offset:9248
  ds_read_b64_tr_b16 v[38:39], v1 offset:9760
  v_mfma_f32_16x16x32_bf16 a[180:183], v[44:47], a[112:115], a[180:183]
  ds_read_b64_tr_b16 v[40:41], v1 offset:9280
  s_add_u32 m0, s64, 26624
  v_mfma_f32_16x16x32_bf16 a[188:191], v[44:47], a[116:119], a[188:191]
  ds_read_b64_tr_b16 v[42:43], v1 offset:9792
  s_waitcnt lgkmcnt(7)
  v_mfma_f32_16x16x32_bf16 v[208:211], v[16:19], a[112:115], v[208:211]
  v_exp_f32 v73, v73
  v_mfma_f32_16x16x32_bf16 v[212:215], v[16:19], a[116:119], v[212:215]
  ds_read_b64_tr_b16 v[44:45], v1 offset:9312
  ds_read_b64_tr_b16 v[46:47], v1 offset:9824
  v_mfma_f32_16x16x32_bf16 v[240:243], v[20:23], a[112:115], v[240:243]
  buffer_load_dwordx4 v5, s[20:23], s72 offen offset:0 lds
  v_mfma_f32_16x16x32_bf16 v[248:251], v[20:23], a[116:119], v[248:251]
  ds_read_b64_tr_b16 v[16:17], v1 offset:10240
  ds_read_b64_tr_b16 v[18:19], v1 offset:10752
  v_mfma_f32_16x16x32_bf16 v[232:235], v[24:27], a[112:115], v[232:235]
  v_exp_f32 v74, v74
  v_mfma_f32_16x16x32_bf16 v[236:239], v[24:27], a[116:119], v[236:239]
  ds_read_b64_tr_b16 v[20:21], v1 offset:10272
  ds_read_b64_tr_b16 v[22:23], v1 offset:10784
  v_mfma_f32_16x16x32_bf16 v[244:247], v[28:31], a[112:115], v[244:247]
  ds_read_b64_tr_b16 v[24:25], v1 offset:10304
  v_exp_f32 v75, v75
  v_mfma_f32_16x16x32_bf16 v[252:255], v[28:31], a[116:119], v[252:255]
  ds_read_b64_tr_b16 v[26:27], v1 offset:10816
  s_waitcnt lgkmcnt(6)
  v_mfma_f32_16x16x32_bf16 v[216:219], v[32:35], a[120:123], v[216:219]
  buffer_load_dwordx4 v5, s[24:27], s72 offen offset:1024 lds
  v_mfma_f32_16x16x32_bf16 v[220:223], v[32:35], a[124:127], v[220:223]
  ds_read_b64_tr_b16 v[28:29], v1 offset:10336
  ds_read_b64_tr_b16 v[30:31], v1 offset:10848
  v_mfma_f32_16x16x32_bf16 a[152:155], v[36:39], a[120:123], a[152:155]
  buffer_load_dwordx4 v6, s[20:23], s72 offen offset:2048 lds
  v_mfma_f32_16x16x32_bf16 a[160:163], v[36:39], a[124:127], a[160:163]
  ds_read_b64_tr_b16 v[32:33], v2 offset:11264
  ds_read_b64_tr_b16 v[34:35], v2 offset:11776
  v_mfma_f32_16x16x32_bf16 v[224:227], v[40:43], a[120:123], v[224:227]
  v_rcp_f32 v68, v68
  v_mfma_f32_16x16x32_bf16 v[228:231], v[40:43], a[124:127], v[228:231]
  ds_read_b64_tr_b16 v[36:37], v2 offset:11296
  ds_read_b64_tr_b16 v[38:39], v2 offset:11808
  v_mfma_f32_16x16x32_bf16 a[176:179], v[44:47], a[120:123], a[176:179]
  ds_read_b64_tr_b16 v[40:41], v3 offset:11264
ffn_hop46:
  s_cbranch_execz ffn_hop47
  v_rcp_f32 v69, v69
  v_rcp_f32 v70, v70
  v_rcp_f32 v71, v71
  v_pk_fma_f32 v[192:193], v[10:11], v[56:57], v[192:193] op_sel_hi:[0,1,1]
  v_pk_fma_f32 v[194:195], v[10:11], v[58:59], v[194:195] op_sel_hi:[0,1,1]
  v_pk_fma_f32 v[196:197], v[10:11], v[60:61], v[196:197] op_sel_hi:[0,1,1]
  v_pk_fma_f32 v[198:199], v[10:11], v[62:63], v[198:199] op_sel_hi:[0,1,1]
  v_pk_mul_f32 v[76:77], v[10:11], v[192:193] op_sel:[1,0] op_sel_hi:[1,1]
  v_pk_mul_f32 v[78:79], v[10:11], v[194:195] op_sel:[1,0] op_sel_hi:[1,1]
  v_pk_mul_f32 v[196:197], v[192:193], v[196:197]
  v_pk_mul_f32 v[198:199], v[194:195], v[198:199]
  v_pk_add_f32 v[72:73], v[4:5], v[72:73] op_sel_hi:[0,1]
  v_pk_add_f32 v[74:75], v[4:5], v[74:75] op_sel_hi:[0,1]
  v_pk_mul_f32 v[184:185], v[184:185], v[68:69]
  v_pk_mul_f32 v[186:187], v[186:187], v[70:71]
  v_mfma_f32_16x16x32_bf16 a[184:187], v[44:47], a[124:127], a[184:187]
  ds_read_b64_tr_b16 v[42:43], v3 offset:11776
  s_waitcnt lgkmcnt(6)
  v_mfma_f32_16x16x32_bf16 a[144:147], v[16:19], a[120:123], a[144:147]
  buffer_load_dwordx4 v6, s[24:27], s72 offen offset:3072 lds
  v_mfma_f32_16x16x32_bf16 a[148:151], v[16:19], a[124:127], a[148:151]
  ds_read_b64_tr_b16 v[44:45], v3 offset:11296
  ds_read_b64_tr_b16 v[46:47], v3 offset:11808
  v_mfma_f32_16x16x32_bf16 a[156:159], v[20:23], a[120:123], a[156:159]
  ds_read_b64_tr_b16 v[16:17], v1 offset:12288
  s_add_u32 s72, s65, 1769856
  v_mfma_f32_16x16x32_bf16 a[164:167], v[20:23], a[124:127], a[164:167]
  ds_read_b64_tr_b16 v[18:19], v1 offset:12800
  v_cvt_pk_bf16_f32 v104, v184, v185
  v_mfma_f32_16x16x32_bf16 a[168:171], v[24:27], a[120:123], a[168:171]
  ds_read_b64_tr_b16 v[20:21], v1 offset:12320
  v_cvt_pk_bf16_f32 v105, v186, v187
  v_mfma_f32_16x16x32_bf16 a[172:175], v[24:27], a[124:127], a[172:175]
  ds_read_b64_tr_b16 v[22:23], v1 offset:12832
  s_add_u32 m0, s64, 30720
  v_mfma_f32_16x16x32_bf16 a[180:183], v[28:31], a[120:123], a[180:183]
  ds_read_b64_tr_b16 v[24:25], v1 offset:12352
  v_exp_f32 v76, v76
  v_mfma_f32_16x16x32_bf16 a[188:191], v[28:31], a[124:127], a[188:191]
  ds_read_b64_tr_b16 v[26:27], v1 offset:12864
  s_waitcnt lgkmcnt(6)
  v_mfma_f32_16x16x32_bf16 v[208:211], v[32:35], a[120:123], v[208:211]
  ds_read_b64_tr_b16 v[28:29], v1 offset:12384
  v_exp_f32 v77, v77
  v_mfma_f32_16x16x32_bf16 v[212:215], v[32:35], a[124:127], v[212:215]
  buffer_load_dwordx4 v5, s[20:23], s72 offen offset:0 lds
  v_mfma_f32_16x16x32_bf16 v[240:243], v[36:39], a[120:123], v[240:243]
  ds_read_b64_tr_b16 v[30:31], v1 offset:12896
  ds_read_b64_tr_b16 v[32:33], v1 offset:13312
  v_mfma_f32_16x16x32_bf16 v[248:251], v[36:39], a[124:127], v[248:251]
  v_exp_f32 v78, v78
  v_mfma_f32_16x16x32_bf16 v[232:235], v[40:43], a[120:123], v[232:235]
  ds_read_b64_tr_b16 v[34:35], v1 offset:13824
  ds_read_b64_tr_b16 v[36:37], v1 offset:13344
  v_mfma_f32_16x16x32_bf16 v[236:239], v[40:43], a[124:127], v[236:239]
  buffer_load_dwordx4 v5, s[24:27], s72 offen offset:1024 lds
  v_mfma_f32_16x16x32_bf16 v[244:247], v[44:47], a[120:123], v[244:247]
  ds_read_b64_tr_b16 v[38:39], v1 offset:13856
  ds_read_b64_tr_b16 v[40:41], v1 offset:13376
  v_mfma_f32_16x16x32_bf16 v[252:255], v[44:47], a[124:127], v[252:255]
  ds_read_b64_tr_b16 v[42:43], v1 offset:13888
  s_waitcnt lgkmcnt(6)
  v_mfma_f32_16x16x32_bf16 v[216:219], v[16:19], a[128:131], v[216:219]
  ds_read_b64_tr_b16 v[44:45], v1 offset:13408
  v_exp_f32 v79, v79
  v_mfma_f32_16x16x32_bf16 v[220:223], v[16:19], a[132:135], v[220:223]
  buffer_load_dwordx4 v6, s[20:23], s72 offen offset:2048 lds
  v_mfma_f32_16x16x32_bf16 a[152:155], v[20:23], a[128:131], a[152:155]
  ds_read_b64_tr_b16 v[46:47], v1 offset:13920
ffn_hop47:
  s_cbranch_execz ffn_hopret
  ds_read_b64_tr_b16 v[16:17], v2 offset:14336
  v_mfma_f32_16x16x32_bf16 a[160:163], v[20:23], a[132:135], a[160:163]
  v_rcp_f32 v72, v72
  v_mfma_f32_16x16x32_bf16 v[224:227], v[24:27], a[128:131], v[224:227]
  ds_read_b64_tr_b16 v[18:19], v2 offset:14848
  ds_read_b64_tr_b16 v[20:21], v2 offset:14368
  v_mfma_f32_16x16x32_bf16 v[228:231], v[24:27], a[132:135], v[228:231]
  buffer_load_dwordx4 v6, s[24:27], s72 offen offset:3072 lds
  v_mfma_f32_16x16x32_bf16 a[176:179], v[28:31], a[128:131], a[176:179]
  ds_read_b64_tr_b16 v[22:23], v2 offset:14880
  ds_read_b64_tr_b16 v[24:25], v3 offset:14336
  v_mfma_f32_16x16x32_bf16 a[184:187], v[28:31], a[132:135], a[184:187]
  ds_read_b64_tr_b16 v[26:27], v3 offset:14848
  s_waitcnt lgkmcnt(6)
  v_mfma_f32_16x16x32_bf16 a[144:147], v[32:35], a[128:131], a[144:147]
  ds_read_b64_tr_b16 v[28:29], v3 offset:14368
  v_rcp_f32 v73, v73
  v_rcp_f32 v74, v74
  v_rcp_f32 v75, v75
  v_pk_fma_f32 v[200:201], v[12:13], v[56:57], v[200:201] op_sel_hi:[0,1,1]
  v_pk_fma_f32 v[202:203], v[12:13], v[58:59], v[202:203] op_sel_hi:[0,1,1]
  v_pk_fma_f32 v[204:205], v[12:13], v[60:61], v[204:205] op_sel_hi:[0,1,1]
  v_pk_fma_f32 v[206:207], v[12:13], v[62:63], v[206:207] op_sel_hi:[0,1,1]
  v_pk_mul_f32 v[68:69], v[12:13], v[200:201] op_sel:[1,0] op_sel_hi:[1,1]
  v_pk_mul_f32 v[70:71], v[12:13], v[202:203] op_sel:[1,0] op_sel_hi:[1,1]
  v_pk_mul_f32 v[204:205], v[200:201], v[204:205]
  v_pk_mul_f32 v[206:207], v[202:203], v[206:207]
  v_pk_add_f32 v[76:77], v[4:5], v[76:77] op_sel_hi:[0,1]
  v_pk_add_f32 v[78:79], v[4:5], v[78:79] op_sel_hi:[0,1]
  v_pk_mul_f32 v[188:189], v[188:189], v[72:73]
  v_pk_mul_f32 v[190:191], v[190:191], v[74:75]
  v_mfma_f32_16x16x32_bf16 a[148:151], v[32:35], a[132:135], a[148:151]
  ds_read_b64_tr_b16 v[30:31], v3 offset:14880
  s_add_u32 s72, s65, 2359680
  v_mfma_f32_16x16x32_bf16 a[156:159], v[36:39], a[128:131], a[156:159]
  ds_read_b64_tr_b16 v[32:33], v1 offset:15360
  v_cvt_pk_bf16_f32 v108, v188, v189
  v_mfma_f32_16x16x32_bf16 a[164:167], v[36:39], a[132:135], a[164:167]
  ds_read_b64_tr_b16 v[34:35], v1 offset:15872
  v_cvt_pk_bf16_f32 v109, v190, v191
  v_mfma_f32_16x16x32_bf16 a[168:171], v[40:43], a[128:131], a[168:171]
  ds_read_b64_tr_b16 v[36:37], v1 offset:15392
  s_add_u32 m0, s64, 34816
  v_mfma_f32_16x16x32_bf16 a[172:175], v[40:43], a[132:135], a[172:175]
  v_exp_f32 v68, v68
  v_mfma_f32_16x16x32_bf16 a[180:183], v[44:47], a[128:131], a[180:183]
  ds_read_b64_tr_b16 v[38:39], v1 offset:15904
  ds_read_b64_tr_b16 v[40:41], v1 offset:15424
  v_mfma_f32_16x16x32_bf16 a[188:191], v[44:47], a[132:135], a[188:191]
  ds_read_b64_tr_b16 v[42:43], v1 offset:15936
  s_waitcnt lgkmcnt(6)
  v_mfma_f32_16x16x32_bf16 v[208:211], v[16:19], a[128:131], v[208:211]
  buffer_load_dwordx4 v5, s[20:23], s72 offen offset:0 lds
  v_mfma_f32_16x16x32_bf16 v[212:215], v[16:19], a[132:135], v[212:215]
  ds_read_b64_tr_b16 v[44:45], v1 offset:15456
  ds_read_b64_tr_b16 v[46:47], v1 offset:15968
  v_mfma_f32_16x16x32_bf16 v[240:243], v[20:23], a[128:131], v[240:243]
  v_exp_f32 v69, v69
  v_mfma_f32_16x16x32_bf16 v[248:251], v[20:23], a[132:135], v[248:251]
  ds_read_b64_tr_b16 v[16:17], v1 offset:16384
  ds_read_b64_tr_b16 v[18:19], v1 offset:16896
  v_mfma_f32_16x16x32_bf16 v[232:235], v[24:27], a[128:131], v[232:235]
  buffer_load_dwordx4 v5, s[24:27], s72 offen offset:1024 lds
ffn_hopq2:
ffn_hop48:
  s_cbranch_execz ffn_hop49
  v_mfma_f32_16x16x32_bf16 v[236:239], v[24:27], a[132:135], v[236:239]
  ds_read_b64_tr_b16 v[20:21], v1 offset:16416
  ds_read_b64_tr_b16 v[22:23], v1 offset:16928
  v_mfma_f32_16x16x32_bf16 v[244:247], v[28:31], a[128:131], v[244:247]
  ds_read_b64_tr_b16 v[24:25], v1 offset:16448
  v_exp_f32 v70, v70
  v_mfma_f32_16x16x32_bf16 v[252:255], v[28:31], a[132:135], v[252:255]
  ds_read_b64_tr_b16 v[26:27], v1 offset:16960
  s_waitcnt lgkmcnt(6)
  v_mfma_f32_16x16x32_bf16 v[216:219], v[32:35], a[136:139], v[216:219]
  buffer_load_dwordx4 v6, s[20:23], s72 offen offset:2048 lds
  v_mfma_f32_16x16x32_bf16 v[220:223], v[32:35], a[140:143], v[220:223]
  ds_read_b64_tr_b16 v[28:29], v1 offset:16480
  ds_read_b64_tr_b16 v[30:31], v1 offset:16992
  v_mfma_f32_16x16x32_bf16 a[152:155], v[36:39], a[136:139], a[152:155]
  v_exp_f32 v71, v71
  v_mfma_f32_16x16x32_bf16 a[160:163], v[36:39], a[140:143], a[160:163]
  ds_read_b64_tr_b16 v[32:33], v2 offset:17408
  ds_read_b64_tr_b16 v[34:35], v2 offset:17920
  v_mfma_f32_16x16x32_bf16 v[224:227], v[40:43], a[136:139], v[224:227]
  buffer_load_dwordx4 v6, s[24:27], s72 offen offset:3072 lds
  v_mfma_f32_16x16x32_bf16 v[228:231], v[40:43], a[140:143], v[228:231]
  ds_read_b64_tr_b16 v[36:37], v2 offset:17440
  ds_read_b64_tr_b16 v[38:39], v2 offset:17952
  v_mfma_f32_16x16x32_bf16 a[176:179], v[44:47], a[136:139], a[176:179]
  ds_read_b64_tr_b16 v[40:41], v3 offset:17408
  v_rcp_f32 v76, v76
  v_mfma_f32_16x16x32_bf16 a[184:187], v[44:47], a[140:143], a[184:187]
  ds_read_b64_tr_b16 v[42:43], v3 offset:17920
  s_waitcnt lgkmcnt(6)
  v_mfma_f32_16x16x32_bf16 a[144:147], v[16:19], a[136:139], a[144:147]
  ds_read_b64_tr_b16 v[44:45], v3 offset:17440
  v_rcp_f32 v77, v77
  v_rcp_f32 v78, v78
  v_rcp_f32 v79, v79
  v_pk_add_f32 v[68:69], v[4:5], v[68:69] op_sel_hi:[0,1]
  v_pk_add_f32 v[70:71], v[4:5], v[70:71] op_sel_hi:[0,1]
  v_pk_mul_f32 v[196:197], v[196:197], v[76:77]
  v_pk_mul_f32 v[198:199], v[198:199], v[78:79]
  v_mfma_f32_16x16x32_bf16 a[148:151], v[16:19], a[140:143], a[148:151]
  ds_read_b64_tr_b16 v[46:47], v3 offset:17952
  v_cvt_pk_bf16_f32 v106, v196, v197
  v_mfma_f32_16x16x32_bf16 a[156:159], v[20:23], a[136:139], a[156:159]
  s_waitcnt vmcnt(12)
  s_barrier
  ds_read_b64_tr_b16 v[16:17], v1 offset:18432
  v_mfma_f32_16x16x32_bf16 a[164:167], v[20:23], a[140:143], a[164:167]
  ds_read_b64_tr_b16 v[18:19], v1 offset:18944
  s_add_u32 s72, s65, 2949504
  v_mfma_f32_16x16x32_bf16 a[168:171], v[24:27], a[136:139], a[168:171]
  ds_read_b64_tr_b16 v[20:21], v1 offset:18464
  v_cvt_pk_bf16_f32 v107, v198, v199
  v_mfma_f32_16x16x32_bf16 a[172:175], v[24:27], a[140:143], a[172:175]
  buffer_store_dwordx4 v[104:107], v8, s[48:51], s80 offen offset:2048 sc1
  v_mfma_f32_16x16x32_bf16 a[180:183], v[28:31], a[136:139], a[180:183]
  ds_read_b64_tr_b16 v[22:23], v1 offset:18976
  ds_read_b64_tr_b16 v[24:25], v1 offset:18496
  v_mfma_f32_16x16x32_bf16 a[188:191], v[28:31], a[140:143], a[188:191]
  ds_read_b64_tr_b16 v[26:27], v1 offset:19008
  s_waitcnt lgkmcnt(6)
  v_mfma_f32_16x16x32_bf16 v[208:211], v[32:35], a[136:139], v[208:211]
  ds_read_b64_tr_b16 v[28:29], v1 offset:18528
  s_add_u32 m0, s64, 0
  v_rcp_f32 v68, v68
  v_mfma_f32_16x16x32_bf16 v[212:215], v[32:35], a[140:143], v[212:215]
  ds_read_b64_tr_b16 v[30:31], v1 offset:19040
  v_rcp_f32 v69, v69
  v_rcp_f32 v70, v70
  v_rcp_f32 v71, v71
  s_nop 0
  v_pk_mul_f32 v[204:205], v[204:205], v[68:69]
  v_pk_mul_f32 v[206:207], v[206:207], v[70:71]
ffn_hop49:
  s_cbranch_execz ffn_hop50
  v_mfma_f32_16x16x32_bf16 v[240:243], v[36:39], a[136:139], v[240:243]
  ds_read_b64_tr_b16 v[32:33], v1 offset:19456
  v_cvt_pk_bf16_f32 v110, v204, v205
  v_mfma_f32_16x16x32_bf16 v[248:251], v[36:39], a[140:143], v[248:251]
  ds_read_b64_tr_b16 v[34:35], v1 offset:19968
  v_cvt_pk_bf16_f32 v111, v206, v207
  v_mfma_f32_16x16x32_bf16 v[232:235], v[40:43], a[136:139], v[232:235]
  ds_read_b64_tr_b16 v[36:37], v1 offset:19488
  buffer_store_dwordx4 v[108:111], v8, s[48:51], s80 offen offset:3072 sc1
  v_mfma_f32_16x16x32_bf16 v[236:239], v[40:43], a[140:143], v[236:239]
  buffer_load_dwordx4 v5, s[20:23], s72 offen offset:0 lds
  v_mfma_f32_16x16x32_bf16 v[244:247], v[44:47], a[136:139], v[244:247]
  ds_read_b64_tr_b16 v[38:39], v1 offset:20000
  ds_read_b64_tr_b16 v[40:41], v1 offset:19520
  v_mfma_f32_16x16x32_bf16 v[252:255], v[44:47], a[140:143], v[252:255]
  ds_read_b64_tr_b16 v[42:43], v1 offset:20032
  s_waitcnt lgkmcnt(6)
  v_mfma_f32_16x16x32_bf16 v[112:115], v[16:19], a[0:3], 0
  ds_read_b64_tr_b16 v[44:45], v1 offset:19552
  ds_read_b128 v[56:59], v9 offset:1088
  v_mfma_f32_16x16x32_bf16 v[116:119], v[16:19], a[4:7], 0
  ds_read_b64_tr_b16 v[46:47], v1 offset:20064
  ds_read_b128 v[60:63], v9 offset:3136
  v_mfma_f32_16x16x32_bf16 v[136:139], v[20:23], a[0:3], 0
  buffer_load_dwordx4 v5, s[24:27], s72 offen offset:1024 lds
  v_mfma_f32_16x16x32_bf16 v[144:147], v[20:23], a[4:7], 0
  ds_read_b64_tr_b16 v[16:17], v1 offset:20480
  ds_read_b64_tr_b16 v[18:19], v1 offset:20992
  v_mfma_f32_16x16x32_bf16 v[120:123], v[24:27], a[0:3], 0
  ds_read_b64_tr_b16 v[20:21], v1 offset:20512
  v_mfma_f32_16x16x32_bf16 v[124:127], v[24:27], a[4:7], 0
  ds_read_b64_tr_b16 v[22:23], v1 offset:21024
  v_mfma_f32_16x16x32_bf16 v[160:163], v[28:31], a[0:3], 0
  ds_read_b64_tr_b16 v[24:25], v1 offset:20544
  v_mfma_f32_16x16x32_bf16 v[168:171], v[28:31], a[4:7], 0
  ds_read_b64_tr_b16 v[26:27], v1 offset:21056
  s_waitcnt lgkmcnt(7)
  v_mfma_f32_16x16x32_bf16 v[128:131], v[32:35], a[0:3], 0
  buffer_load_dwordx4 v6, s[20:23], s72 offen offset:2048 lds
  v_pk_fma_f32 v[208:209], v[10:11], v[48:49], v[208:209] op_sel_hi:[0,1,1]
  v_pk_fma_f32 v[210:211], v[10:11], v[50:51], v[210:211] op_sel_hi:[0,1,1]
  v_pk_fma_f32 v[232:233], v[10:11], v[52:53], v[232:233] op_sel_hi:[0,1,1]
  v_pk_fma_f32 v[234:235], v[10:11], v[54:55], v[234:235] op_sel_hi:[0,1,1]
  v_pk_mul_f32 v[68:69], v[10:11], v[208:209] op_sel:[1,0] op_sel_hi:[1,1]
  v_pk_mul_f32 v[70:71], v[10:11], v[210:211] op_sel:[1,0] op_sel_hi:[1,1]
  v_pk_mul_f32 v[232:233], v[208:209], v[232:233]
  v_pk_mul_f32 v[234:235], v[210:211], v[234:235]
  v_mfma_f32_16x16x32_bf16 v[132:135], v[32:35], a[4:7], 0
  ds_read_b64_tr_b16 v[28:29], v1 offset:20576
  ds_read_b64_tr_b16 v[30:31], v1 offset:21088
  v_mfma_f32_16x16x32_bf16 v[140:143], v[36:39], a[0:3], 0
  v_exp_f32 v68, v68
  v_mfma_f32_16x16x32_bf16 v[148:151], v[36:39], a[4:7], 0
  ds_read_b64_tr_b16 v[32:33], v1 offset:21504
  ds_read_b64_tr_b16 v[34:35], v1 offset:22016
  v_mfma_f32_16x16x32_bf16 v[152:155], v[40:43], a[0:3], 0
  buffer_load_dwordx4 v6, s[24:27], s72 offen offset:3072 lds
  v_mfma_f32_16x16x32_bf16 v[156:159], v[40:43], a[4:7], 0
  ds_read_b64_tr_b16 v[36:37], v1 offset:21536
  ds_read_b64_tr_b16 v[38:39], v1 offset:22048
  v_exp_f32 v69, v69
  v_exp_f32 v70, v70
  v_exp_f32 v71, v71
  v_pk_fma_f32 v[212:213], v[12:13], v[48:49], v[212:213] op_sel_hi:[0,1,1]
  v_pk_fma_f32 v[214:215], v[12:13], v[50:51], v[214:215] op_sel_hi:[0,1,1]
  v_pk_fma_f32 v[236:237], v[12:13], v[52:53], v[236:237] op_sel_hi:[0,1,1]
  v_pk_fma_f32 v[238:239], v[12:13], v[54:55], v[238:239] op_sel_hi:[0,1,1]
ffn_hop50:
  s_cbranch_execz ffn_hop51
  v_pk_mul_f32 v[72:73], v[12:13], v[212:213] op_sel:[1,0] op_sel_hi:[1,1]
  v_pk_mul_f32 v[74:75], v[12:13], v[214:215] op_sel:[1,0] op_sel_hi:[1,1]
  v_pk_mul_f32 v[236:237], v[212:213], v[236:237]
  v_pk_mul_f32 v[238:239], v[214:215], v[238:239]
  v_pk_add_f32 v[68:69], v[4:5], v[68:69] op_sel_hi:[0,1]
  v_pk_add_f32 v[70:71], v[4:5], v[70:71] op_sel_hi:[0,1]
  v_mfma_f32_16x16x32_bf16 v[164:167], v[44:47], a[0:3], 0
  ds_read_b64_tr_b16 v[40:41], v1 offset:21568
  v_subrev_u32 v9, s86, v9
  v_mfma_f32_16x16x32_bf16 v[172:175], v[44:47], a[4:7], 0
  ds_read_b64_tr_b16 v[42:43], v1 offset:22080
  s_waitcnt lgkmcnt(6)
  v_mfma_f32_16x16x32_bf16 v[112:115], v[16:19], a[8:11], v[112:115]
  ds_read_b64_tr_b16 v[44:45], v1 offset:21600
  ds_read_b128 v[48:51], v9 offset:512
  v_mfma_f32_16x16x32_bf16 v[116:119], v[16:19], a[12:15], v[116:119]
  ds_read_b64_tr_b16 v[46:47], v1 offset:22112
  s_add_u32 s72, s65, 3539328
  v_mfma_f32_16x16x32_bf16 v[136:139], v[20:23], a[8:11], v[136:139]
  ds_read_b64_tr_b16 v[16:17], v1 offset:22528
  ds_read_b128 v[52:55], v9 offset:2560
  v_mfma_f32_16x16x32_bf16 v[144:147], v[20:23], a[12:15], v[144:147]
  v_exp_f32 v72, v72
  v_mfma_f32_16x16x32_bf16 v[120:123], v[24:27], a[8:11], v[120:123]
  ds_read_b64_tr_b16 v[18:19], v1 offset:23040
  ds_read_b64_tr_b16 v[20:21], v1 offset:22560
  v_mfma_f32_16x16x32_bf16 v[124:127], v[24:27], a[12:15], v[124:127]
  ds_read_b64_tr_b16 v[22:23], v1 offset:23072
  v_exp_f32 v73, v73
  v_mfma_f32_16x16x32_bf16 v[160:163], v[28:31], a[8:11], v[160:163]
  ds_read_b64_tr_b16 v[24:25], v1 offset:22592
  s_add_u32 m0, s64, 4096
  v_mfma_f32_16x16x32_bf16 v[168:171], v[28:31], a[12:15], v[168:171]
  ds_read_b64_tr_b16 v[26:27], v1 offset:23104
  s_waitcnt lgkmcnt(7)
  v_mfma_f32_16x16x32_bf16 v[128:131], v[32:35], a[8:11], v[128:131]
  ds_read_b64_tr_b16 v[28:29], v1 offset:22624
  v_exp_f32 v74, v74
  v_mfma_f32_16x16x32_bf16 v[132:135], v[32:35], a[12:15], v[132:135]
  ds_read_b64_tr_b16 v[30:31], v1 offset:23136
  v_exp_f32 v75, v75
  v_rcp_f32 v68, v68
  v_mfma_f32_16x16x32_bf16 v[140:143], v[36:39], a[8:11], v[140:143]
  ds_read_b64_tr_b16 v[32:33], v1 offset:23552
  v_rcp_f32 v69, v69
  v_rcp_f32 v70, v70
  v_rcp_f32 v71, v71
  v_pk_fma_f32 v[240:241], v[10:11], v[56:57], v[240:241] op_sel_hi:[0,1,1]
  v_pk_fma_f32 v[242:243], v[10:11], v[58:59], v[242:243] op_sel_hi:[0,1,1]
  v_pk_fma_f32 v[244:245], v[10:11], v[60:61], v[244:245] op_sel_hi:[0,1,1]
  v_pk_fma_f32 v[246:247], v[10:11], v[62:63], v[246:247] op_sel_hi:[0,1,1]
  v_pk_mul_f32 v[76:77], v[10:11], v[240:241] op_sel:[1,0] op_sel_hi:[1,1]
  v_pk_mul_f32 v[78:79], v[10:11], v[242:243] op_sel:[1,0] op_sel_hi:[1,1]
  v_pk_mul_f32 v[244:245], v[240:241], v[244:245]
  v_pk_mul_f32 v[246:247], v[242:243], v[246:247]
  v_pk_add_f32 v[72:73], v[4:5], v[72:73] op_sel_hi:[0,1]
  v_pk_add_f32 v[74:75], v[4:5], v[74:75] op_sel_hi:[0,1]
  v_pk_mul_f32 v[232:233], v[232:233], v[68:69]
  v_pk_mul_f32 v[234:235], v[234:235], v[70:71]
  v_mfma_f32_16x16x32_bf16 v[148:151], v[36:39], a[12:15], v[148:151]
  buffer_load_dwordx4 v5, s[20:23], s72 offen offset:0 lds
  v_mfma_f32_16x16x32_bf16 v[152:155], v[40:43], a[8:11], v[152:155]
  ds_read_b64_tr_b16 v[34:35], v1 offset:24064
  ds_read_b64_tr_b16 v[36:37], v1 offset:23584
  v_mfma_f32_16x16x32_bf16 v[156:159], v[40:43], a[12:15], v[156:159]
  ds_read_b64_tr_b16 v[38:39], v1 offset:24096
  v_cvt_pk_bf16_f32 v208, v232, v233
  v_mfma_f32_16x16x32_bf16 v[164:167], v[44:47], a[8:11], v[164:167]
  ds_read_b64_tr_b16 v[40:41], v1 offset:23616
ffn_hop51:
  s_cbranch_execz ffn_hop52
  v_cvt_pk_bf16_f32 v209, v234, v235
  v_mfma_f32_16x16x32_bf16 v[172:175], v[44:47], a[12:15], v[172:175]
  ds_read_b64_tr_b16 v[42:43], v1 offset:24128
  s_waitcnt lgkmcnt(6)
  v_mfma_f32_16x16x32_bf16 v[112:115], v[16:19], a[16:19], v[112:115]
  buffer_load_dwordx4 v5, s[24:27], s72 offen offset:1024 lds
  v_mfma_f32_16x16x32_bf16 v[116:119], v[16:19], a[20:23], v[116:119]
  ds_read_b64_tr_b16 v[44:45], v1 offset:23648
  ds_read_b64_tr_b16 v[46:47], v1 offset:24160
  v_mfma_f32_16x16x32_bf16 v[136:139], v[20:23], a[16:19], v[136:139]
  v_exp_f32 v76, v76
  v_mfma_f32_16x16x32_bf16 v[144:147], v[20:23], a[20:23], v[144:147]
  ds_read_b64_tr_b16 v[16:17], v1 offset:24576
  ds_read_b64_tr_b16 v[18:19], v1 offset:25088
  v_mfma_f32_16x16x32_bf16 v[120:123], v[24:27], a[16:19], v[120:123]
  ds_read_b64_tr_b16 v[20:21], v1 offset:24608
  v_exp_f32 v77, v77
  v_mfma_f32_16x16x32_bf16 v[124:127], v[24:27], a[20:23], v[124:127]
  buffer_load_dwordx4 v6, s[20:23], s72 offen offset:2048 lds
  v_mfma_f32_16x16x32_bf16 v[160:163], v[28:31], a[16:19], v[160:163]
  ds_read_b64_tr_b16 v[22:23], v1 offset:25120
  ds_read_b64_tr_b16 v[24:25], v1 offset:24640
  v_exp_f32 v78, v78
  v_mfma_f32_16x16x32_bf16 v[168:171], v[28:31], a[20:23], v[168:171]
  ds_read_b64_tr_b16 v[26:27], v1 offset:25152
  v_exp_f32 v79, v79
  s_waitcnt lgkmcnt(6)
  v_mfma_f32_16x16x32_bf16 v[128:131], v[32:35], a[16:19], v[128:131]
  s_waitcnt vmcnt(7)
  buffer_store_dword v5, off, s[60:63], s84 offset:0 sc1
  v_rcp_f32 v72, v72
  v_mfma_f32_16x16x32_bf16 v[132:135], v[32:35], a[20:23], v[132:135]
  ds_read_b64_tr_b16 v[28:29], v1 offset:24672
  ds_read_b64_tr_b16 v[30:31], v1 offset:25184
  v_mfma_f32_16x16x32_bf16 v[140:143], v[36:39], a[16:19], v[140:143]
  buffer_load_dwordx4 v6, s[24:27], s72 offen offset:3072 lds
  v_rcp_f32 v73, v73
  v_rcp_f32 v74, v74
  v_rcp_f32 v75, v75
  v_pk_fma_f32 v[248:249], v[12:13], v[56:57], v[248:249] op_sel_hi:[0,1,1]
  v_pk_fma_f32 v[250:251], v[12:13], v[58:59], v[250:251] op_sel_hi:[0,1,1]
  v_pk_fma_f32 v[252:253], v[12:13], v[60:61], v[252:253] op_sel_hi:[0,1,1]
  v_pk_fma_f32 v[254:255], v[12:13], v[62:63], v[254:255] op_sel_hi:[0,1,1]
  v_pk_mul_f32 v[68:69], v[12:13], v[248:249] op_sel:[1,0] op_sel_hi:[1,1]
  v_pk_mul_f32 v[70:71], v[12:13], v[250:251] op_sel:[1,0] op_sel_hi:[1,1]
  v_pk_mul_f32 v[252:253], v[248:249], v[252:253]
  v_pk_mul_f32 v[254:255], v[250:251], v[254:255]
  v_pk_add_f32 v[76:77], v[4:5], v[76:77] op_sel_hi:[0,1]
  v_pk_add_f32 v[78:79], v[4:5], v[78:79] op_sel_hi:[0,1]
  v_pk_mul_f32 v[236:237], v[236:237], v[72:73]
  v_pk_mul_f32 v[238:239], v[238:239], v[74:75]
  v_mfma_f32_16x16x32_bf16 v[148:151], v[36:39], a[20:23], v[148:151]
  ds_read_b64_tr_b16 v[32:33], v1 offset:25600
  ds_read_b64_tr_b16 v[34:35], v1 offset:26112
  v_mfma_f32_16x16x32_bf16 v[152:155], v[40:43], a[16:19], v[152:155]
  ds_read_b64_tr_b16 v[36:37], v1 offset:25632
  v_cvt_pk_bf16_f32 v212, v236, v237
  v_mfma_f32_16x16x32_bf16 v[156:159], v[40:43], a[20:23], v[156:159]
  ds_read_b64_tr_b16 v[38:39], v1 offset:26144
  v_cvt_pk_bf16_f32 v213, v238, v239
  v_mfma_f32_16x16x32_bf16 v[164:167], v[44:47], a[16:19], v[164:167]
  ds_read_b64_tr_b16 v[40:41], v1 offset:25664
  ds_read_b128 v[56:59], v9 offset:576
  v_mfma_f32_16x16x32_bf16 v[172:175], v[44:47], a[20:23], v[172:175]
  ds_read_b64_tr_b16 v[42:43], v1 offset:26176
  s_waitcnt lgkmcnt(7)
  v_mfma_f32_16x16x32_bf16 v[112:115], v[16:19], a[24:27], v[112:115]
  ds_read_b64_tr_b16 v[44:45], v1 offset:25696
  ds_read_b128 v[60:63], v9 offset:2624
ffn_hop52:
  s_cbranch_execz ffn_hop53
  v_mfma_f32_16x16x32_bf16 v[116:119], v[16:19], a[28:31], v[116:119]
  ds_read_b64_tr_b16 v[46:47], v1 offset:26208
  v_accvgpr_read_b32 v192, a144
  v_mfma_f32_16x16x32_bf16 v[136:139], v[20:23], a[24:27], v[136:139]
  s_barrier
  ds_read_b64_tr_b16 v[16:17], v1 offset:26624
  v_mfma_f32_16x16x32_bf16 v[144:147], v[20:23], a[28:31], v[144:147]
  ds_read_b64_tr_b16 v[18:19], v1 offset:27136
  s_add_u32 s72, s65, 4129152
  v_mfma_f32_16x16x32_bf16 v[120:123], v[24:27], a[24:27], v[120:123]
  ds_read_b64_tr_b16 v[20:21], v1 offset:26656
  v_accvgpr_read_b32 v193, a145
  v_mfma_f32_16x16x32_bf16 v[124:127], v[24:27], a[28:31], v[124:127]
  ds_read_b64_tr_b16 v[22:23], v1 offset:27168
  v_accvgpr_read_b32 v194, a146
  v_accvgpr_read_b32 v195, a147
  v_mfma_f32_16x16x32_bf16 v[160:163], v[28:31], a[24:27], v[160:163]
  ds_read_b64_tr_b16 v[24:25], v1 offset:26688
  s_add_u32 m0, s64, 8192
  v_exp_f32 v68, v68
  v_mfma_f32_16x16x32_bf16 v[168:171], v[28:31], a[28:31], v[168:171]
  ds_read_b64_tr_b16 v[26:27], v1 offset:27200
  v_exp_f32 v69, v69
  s_waitcnt lgkmcnt(6)
  v_mfma_f32_16x16x32_bf16 v[128:131], v[32:35], a[24:27], v[128:131]
  ds_read_b64_tr_b16 v[28:29], v1 offset:26720
  v_exp_f32 v70, v70
  v_mfma_f32_16x16x32_bf16 v[132:135], v[32:35], a[28:31], v[132:135]
  buffer_load_dwordx4 v5, s[20:23], s72 offen offset:0 lds
  v_exp_f32 v71, v71
  v_mfma_f32_16x16x32_bf16 v[140:143], v[36:39], a[24:27], v[140:143]
  ds_read_b64_tr_b16 v[30:31], v1 offset:27232
  ds_read_b64_tr_b16 v[32:33], v1 offset:27648
  v_rcp_f32 v76, v76
  v_mfma_f32_16x16x32_bf16 v[148:151], v[36:39], a[28:31], v[148:151]
  ds_read_b64_tr_b16 v[34:35], v1 offset:28160
  v_rcp_f32 v77, v77
  v_rcp_f32 v78, v78
  v_rcp_f32 v79, v79
  v_pk_fma_f32 v[216:217], v[10:11], v[48:49], v[216:217] op_sel_hi:[0,1,1]
  v_pk_fma_f32 v[218:219], v[10:11], v[50:51], v[218:219] op_sel_hi:[0,1,1]
  v_pk_fma_f32 v[192:193], v[10:11], v[52:53], v[192:193] op_sel_hi:[0,1,1]
  v_pk_fma_f32 v[194:195], v[10:11], v[54:55], v[194:195] op_sel_hi:[0,1,1]
  v_pk_mul_f32 v[72:73], v[10:11], v[216:217] op_sel:[1,0] op_sel_hi:[1,1]
  v_pk_mul_f32 v[74:75], v[10:11], v[218:219] op_sel:[1,0] op_sel_hi:[1,1]
  v_pk_mul_f32 v[192:193], v[216:217], v[192:193]
  v_pk_mul_f32 v[194:195], v[218:219], v[194:195]
  v_pk_add_f32 v[68:69], v[4:5], v[68:69] op_sel_hi:[0,1]
  v_pk_add_f32 v[70:71], v[4:5], v[70:71] op_sel_hi:[0,1]
  v_pk_mul_f32 v[244:245], v[244:245], v[76:77]
  v_pk_mul_f32 v[246:247], v[246:247], v[78:79]
  v_mfma_f32_16x16x32_bf16 v[152:155], v[40:43], a[24:27], v[152:155]
  buffer_load_dwordx4 v5, s[24:27], s72 offen offset:1024 lds
  v_mfma_f32_16x16x32_bf16 v[156:159], v[40:43], a[28:31], v[156:159]
  ds_read_b64_tr_b16 v[36:37], v1 offset:27680
  ds_read_b64_tr_b16 v[38:39], v1 offset:28192
  v_mfma_f32_16x16x32_bf16 v[164:167], v[44:47], a[24:27], v[164:167]
  ds_read_b64_tr_b16 v[40:41], v1 offset:27712
  v_cvt_pk_bf16_f32 v210, v244, v245
  v_mfma_f32_16x16x32_bf16 v[172:175], v[44:47], a[28:31], v[172:175]
  ds_read_b64_tr_b16 v[42:43], v1 offset:28224
  s_waitcnt lgkmcnt(6)
  v_mfma_f32_16x16x32_bf16 v[112:115], v[16:19], a[32:35], v[112:115]
  buffer_load_dwordx4 v6, s[20:23], s72 offen offset:2048 lds
  v_mfma_f32_16x16x32_bf16 v[116:119], v[16:19], a[36:39], v[116:119]
  ds_read_b64_tr_b16 v[44:45], v1 offset:27744
  ds_read_b64_tr_b16 v[46:47], v1 offset:28256
  v_mfma_f32_16x16x32_bf16 v[136:139], v[20:23], a[32:35], v[136:139]
  buffer_load_dwordx4 v6, s[24:27], s72 offen offset:3072 lds
ffn_hop53:
  s_cbranch_execz ffn_hop54
  v_mfma_f32_16x16x32_bf16 v[144:147], v[20:23], a[36:39], v[144:147]
  ds_read_b64_tr_b16 v[16:17], v1 offset:28672
  ds_read_b64_tr_b16 v[18:19], v1 offset:29184
  v_mfma_f32_16x16x32_bf16 v[120:123], v[24:27], a[32:35], v[120:123]
  ds_read_b64_tr_b16 v[20:21], v1 offset:28704
  v_cvt_pk_bf16_f32 v211, v246, v247
  v_mfma_f32_16x16x32_bf16 v[124:127], v[24:27], a[36:39], v[124:127]
  ds_read_b64_tr_b16 v[22:23], v1 offset:29216
  s_add_u32 s72, s65, 4718976
  v_mfma_f32_16x16x32_bf16 v[160:163], v[28:31], a[32:35], v[160:163]
  ds_read_b64_tr_b16 v[24:25], v1 offset:28736
  buffer_store_dwordx4 v[208:211], v8, s[48:51], s83 offen offset:0 sc1
  v_mfma_f32_16x16x32_bf16 v[168:171], v[28:31], a[36:39], v[168:171]
  ds_read_b64_tr_b16 v[26:27], v1 offset:29248
  v_accvgpr_read_b32 v196, a148
  v_accvgpr_read_b32 v197, a149
  s_waitcnt lgkmcnt(6)
  v_mfma_f32_16x16x32_bf16 v[128:131], v[32:35], a[32:35], v[128:131]
  ds_read_b64_tr_b16 v[28:29], v1 offset:28768
  s_add_u32 m0, s64, 12288
  v_accvgpr_read_b32 v198, a150
  v_mfma_f32_16x16x32_bf16 v[132:135], v[32:35], a[36:39], v[132:135]
  ds_read_b64_tr_b16 v[30:31], v1 offset:29280
  v_accvgpr_read_b32 v199, a151
  v_exp_f32 v72, v72
  v_mfma_f32_16x16x32_bf16 v[140:143], v[36:39], a[32:35], v[140:143]
  ds_read_b64_tr_b16 v[32:33], v1 offset:29696
  v_exp_f32 v73, v73
  v_exp_f32 v74, v74
  v_mfma_f32_16x16x32_bf16 v[148:151], v[36:39], a[36:39], v[148:151]
  buffer_load_dwordx4 v5, s[20:23], s72 offen offset:0 lds
  v_mfma_f32_16x16x32_bf16 v[152:155], v[40:43], a[32:35], v[152:155]
  ds_read_b64_tr_b16 v[34:35], v1 offset:30208
  ds_read_b64_tr_b16 v[36:37], v1 offset:29728
  v_exp_f32 v75, v75
  v_mfma_f32_16x16x32_bf16 v[156:159], v[40:43], a[36:39], v[156:159]
  ds_read_b64_tr_b16 v[38:39], v1 offset:30240
  v_rcp_f32 v68, v68
  v_mfma_f32_16x16x32_bf16 v[164:167], v[44:47], a[32:35], v[164:167]
  ds_read_b64_tr_b16 v[40:41], v1 offset:29760
  v_rcp_f32 v69, v69
  v_rcp_f32 v70, v70
  v_rcp_f32 v71, v71
  v_pk_fma_f32 v[220:221], v[12:13], v[48:49], v[220:221] op_sel_hi:[0,1,1]
  v_pk_fma_f32 v[222:223], v[12:13], v[50:51], v[222:223] op_sel_hi:[0,1,1]
  v_pk_fma_f32 v[196:197], v[12:13], v[52:53], v[196:197] op_sel_hi:[0,1,1]
  v_pk_fma_f32 v[198:199], v[12:13], v[54:55], v[198:199] op_sel_hi:[0,1,1]
  v_pk_mul_f32 v[76:77], v[12:13], v[220:221] op_sel:[1,0] op_sel_hi:[1,1]
  v_pk_mul_f32 v[78:79], v[12:13], v[222:223] op_sel:[1,0] op_sel_hi:[1,1]
  v_pk_mul_f32 v[196:197], v[220:221], v[196:197]
  v_pk_mul_f32 v[198:199], v[222:223], v[198:199]
  v_pk_add_f32 v[72:73], v[4:5], v[72:73] op_sel_hi:[0,1]
  v_pk_add_f32 v[74:75], v[4:5], v[74:75] op_sel_hi:[0,1]
  v_pk_mul_f32 v[252:253], v[252:253], v[68:69]
  v_pk_mul_f32 v[254:255], v[254:255], v[70:71]
  v_mfma_f32_16x16x32_bf16 v[172:175], v[44:47], a[36:39], v[172:175]
  ds_read_b64_tr_b16 v[42:43], v1 offset:30272
  s_waitcnt lgkmcnt(6)
  v_mfma_f32_16x16x32_bf16 v[112:115], v[16:19], a[40:43], v[112:115]
  buffer_load_dwordx4 v5, s[24:27], s72 offen offset:1024 lds
  buffer_load_dword v184, off, s[60:63], s85 offset:0 sc1
  v_mfma_f32_16x16x32_bf16 v[116:119], v[16:19], a[44:47], v[116:119]
  ds_read_b64_tr_b16 v[44:45], v1 offset:29792
  ds_read_b64_tr_b16 v[46:47], v1 offset:30304
  v_mfma_f32_16x16x32_bf16 v[136:139], v[20:23], a[40:43], v[136:139]
  buffer_load_dwordx4 v6, s[20:23], s72 offen offset:2048 lds
  v_mfma_f32_16x16x32_bf16 v[144:147], v[20:23], a[44:47], v[144:147]
  ds_read_b64_tr_b16 v[16:17], v1 offset:30720
  ds_read_b64_tr_b16 v[18:19], v1 offset:31232
ffn_hop54:
  s_cbranch_execz ffn_hop55
  v_mfma_f32_16x16x32_bf16 v[120:123], v[24:27], a[40:43], v[120:123]
  buffer_load_dwordx4 v6, s[24:27], s72 offen offset:3072 lds
  v_mfma_f32_16x16x32_bf16 v[124:127], v[24:27], a[44:47], v[124:127]
  ds_read_b64_tr_b16 v[20:21], v1 offset:30752
  ds_read_b64_tr_b16 v[22:23], v1 offset:31264
  v_mfma_f32_16x16x32_bf16 v[160:163], v[28:31], a[40:43], v[160:163]
  ds_read_b64_tr_b16 v[24:25], v1 offset:30784
  v_cvt_pk_bf16_f32 v214, v252, v253
  v_mfma_f32_16x16x32_bf16 v[168:171], v[28:31], a[44:47], v[168:171]
  ds_read_b64_tr_b16 v[26:27], v1 offset:31296
  s_waitcnt lgkmcnt(6)
  v_mfma_f32_16x16x32_bf16 v[128:131], v[32:35], a[40:43], v[128:131]
  ds_read_b64_tr_b16 v[28:29], v1 offset:30816
  v_mov_b32 v5, v14
  v_cvt_pk_bf16_f32 v215, v254, v255
  v_mfma_f32_16x16x32_bf16 v[132:135], v[32:35], a[44:47], v[132:135]
  ds_read_b64_tr_b16 v[30:31], v1 offset:31328
  buffer_store_dwordx4 v[212:215], v8, s[48:51], s83 offen offset:1024 sc1
  v_mfma_f32_16x16x32_bf16 v[140:143], v[36:39], a[40:43], v[140:143]
  ds_read_b64_tr_b16 v[32:33], v1 offset:31744
  ds_read_b128 v[48:51], v9 offset:640
  ds_read_b128 v[52:55], v9 offset:2688
  v_mov_b32 v7, v15
  v_mfma_f32_16x16x32_bf16 v[148:151], v[36:39], a[44:47], v[148:151]
  ds_read_b64_tr_b16 v[34:35], v1 offset:32256
  v_accvgpr_read_b32 v64, a152
  v_accvgpr_read_b32 v65, a153
  v_accvgpr_read_b32 v66, a154
  v_mfma_f32_16x16x32_bf16 v[152:155], v[40:43], a[40:43], v[152:155]
  ds_read_b64_tr_b16 v[36:37], v1 offset:31776
  v_accvgpr_read_b32 v67, a155
  v_accvgpr_read_b32 v188, a156
  v_mfma_f32_16x16x32_bf16 v[156:159], v[40:43], a[44:47], v[156:159]
  ds_read_b64_tr_b16 v[38:39], v1 offset:32288
  v_add_u32 v6, 35840, v14
  v_accvgpr_read_b32 v189, a157
  v_accvgpr_read_b32 v190, a158
  v_mfma_f32_16x16x32_bf16 v[164:167], v[44:47], a[40:43], v[164:167]
  ds_read_b64_tr_b16 v[40:41], v1 offset:31808
  v_accvgpr_read_b32 v191, a159
  v_exp_f32 v76, v76
  v_mfma_f32_16x16x32_bf16 v[172:175], v[44:47], a[44:47], v[172:175]
  ds_read_b64_tr_b16 v[42:43], v1 offset:32320
  v_exp_f32 v77, v77
  s_waitcnt lgkmcnt(8)
  v_mfma_f32_16x16x32_bf16 v[112:115], v[16:19], a[48:51], v[112:115]
  ds_read_b64_tr_b16 v[44:45], v1 offset:31840
  s_add_u32 s72, s66, 0
  v_exp_f32 v78, v78
  v_mfma_f32_16x16x32_bf16 v[116:119], v[16:19], a[52:55], v[116:119]
  v_exp_f32 v79, v79
  v_mfma_f32_16x16x32_bf16 v[136:139], v[20:23], a[48:51], v[136:139]
  ds_read_b64_tr_b16 v[46:47], v1 offset:32352
  ds_read_b64_tr_b16 v[16:17], v1 offset:32768
  v_rcp_f32 v72, v72
  v_mfma_f32_16x16x32_bf16 v[144:147], v[20:23], a[52:55], v[144:147]
  ds_read_b64_tr_b16 v[18:19], v1 offset:33280
  s_add_u32 s72, s72, s36
  v_rcp_f32 v73, v73
  v_rcp_f32 v74, v74
  v_rcp_f32 v75, v75
  v_pk_fma_f32 v[64:65], v[10:11], v[56:57], v[64:65] op_sel_hi:[0,1,1]
  v_pk_fma_f32 v[66:67], v[10:11], v[58:59], v[66:67] op_sel_hi:[0,1,1]
  v_pk_fma_f32 v[188:189], v[10:11], v[60:61], v[188:189] op_sel_hi:[0,1,1]
  v_pk_fma_f32 v[190:191], v[10:11], v[62:63], v[190:191] op_sel_hi:[0,1,1]
  v_pk_mul_f32 v[68:69], v[10:11], v[64:65] op_sel:[1,0] op_sel_hi:[1,1]
  v_pk_mul_f32 v[70:71], v[10:11], v[66:67] op_sel:[1,0] op_sel_hi:[1,1]
  v_pk_mul_f32 v[188:189], v[64:65], v[188:189]
  v_pk_mul_f32 v[190:191], v[66:67], v[190:191]
  v_pk_add_f32 v[76:77], v[4:5], v[76:77] op_sel_hi:[0,1]
ffn_hop55:
  s_cbranch_execz ffn_hop56
  v_pk_add_f32 v[78:79], v[4:5], v[78:79] op_sel_hi:[0,1]
  v_pk_mul_f32 v[192:193], v[192:193], v[72:73]
  v_pk_mul_f32 v[194:195], v[194:195], v[74:75]
  v_mfma_f32_16x16x32_bf16 v[120:123], v[24:27], a[48:51], v[120:123]
  ds_read_b64_tr_b16 v[20:21], v1 offset:32800
  v_cvt_pk_bf16_f32 v216, v192, v193
  v_mfma_f32_16x16x32_bf16 v[124:127], v[24:27], a[52:55], v[124:127]
  ds_read_b64_tr_b16 v[22:23], v1 offset:33312
  v_cvt_pk_bf16_f32 v217, v194, v195
  v_mfma_f32_16x16x32_bf16 v[160:163], v[28:31], a[48:51], v[160:163]
  ds_read_b64_tr_b16 v[24:25], v1 offset:32832
  s_add_u32 m0, s64, 16384
  v_mfma_f32_16x16x32_bf16 v[168:171], v[28:31], a[52:55], v[168:171]
  ds_read_b64_tr_b16 v[26:27], v1 offset:33344
  s_waitcnt lgkmcnt(6)
  v_mfma_f32_16x16x32_bf16 v[128:131], v[32:35], a[48:51], v[128:131]
  ds_read_b64_tr_b16 v[28:29], v1 offset:32864
  v_accvgpr_read_b32 v64, a160
  v_mfma_f32_16x16x32_bf16 v[132:135], v[32:35], a[52:55], v[132:135]
  buffer_load_dwordx4 v5, s[32:35], s72 offen offset:0 lds
  v_mfma_f32_16x16x32_bf16 v[140:143], v[36:39], a[48:51], v[140:143]
  ds_read_b64_tr_b16 v[30:31], v1 offset:33376
  ds_read_b64_tr_b16 v[32:33], v1 offset:33792
  v_mfma_f32_16x16x32_bf16 v[148:151], v[36:39], a[52:55], v[148:151]
  ds_read_b64_tr_b16 v[34:35], v1 offset:34304
  v_accvgpr_read_b32 v65, a161
  v_mfma_f32_16x16x32_bf16 v[152:155], v[40:43], a[48:51], v[152:155]
  buffer_load_dwordx4 v6, s[32:35], s72 offen offset:1024 lds
  v_mfma_f32_16x16x32_bf16 v[156:159], v[40:43], a[52:55], v[156:159]
  ds_read_b64_tr_b16 v[36:37], v1 offset:33824
  ds_read_b64_tr_b16 v[38:39], v1 offset:34336
  v_mfma_f32_16x16x32_bf16 v[164:167], v[44:47], a[48:51], v[164:167]
  ds_read_b64_tr_b16 v[40:41], v1 offset:33856
  v_accvgpr_read_b32 v66, a162
  v_accvgpr_read_b32 v67, a163
  v_mfma_f32_16x16x32_bf16 v[172:175], v[44:47], a[52:55], v[172:175]
  ds_read_b64_tr_b16 v[42:43], v1 offset:34368
  v_accvgpr_read_b32 v192, a164
  s_waitcnt lgkmcnt(6)
  v_mfma_f32_16x16x32_bf16 v[112:115], v[16:19], a[56:59], v[112:115]
  s_waitcnt vmcnt(5)
  v_readfirstlane_b32 s77, v184
  v_accvgpr_read_b32 v193, a165
  v_accvgpr_read_b32 v194, a166
  v_mfma_f32_16x16x32_bf16 v[116:119], v[16:19], a[60:63], v[116:119]
  ds_read_b64_tr_b16 v[44:45], v1 offset:33888
  ds_read_b64_tr_b16 v[46:47], v1 offset:34400
  v_accvgpr_read_b32 v195, a167
  v_exp_f32 v68, v68
  v_mfma_f32_16x16x32_bf16 v[136:139], v[20:23], a[56:59], v[136:139]
  s_barrier
  ds_read_b64_tr_b16 v[16:17], v1 offset:34816
  v_mfma_f32_16x16x32_bf16 v[144:147], v[20:23], a[60:63], v[144:147]
  ds_read_b64_tr_b16 v[18:19], v1 offset:35328
  s_add_u32 s72, s66, 73728
  v_exp_f32 v69, v69
  v_mfma_f32_16x16x32_bf16 v[120:123], v[24:27], a[56:59], v[120:123]
  s_cmp_lg_u32 s77, 0
  s_cbranch_scc0 ffn_slow0
ffn_back0:
  v_exp_f32 v70, v70
  v_mfma_f32_16x16x32_bf16 v[124:127], v[24:27], a[60:63], v[124:127]
  ds_read_b64_tr_b16 v[20:21], v1 offset:34848
  ds_read_b64_tr_b16 v[22:23], v1 offset:35360
  v_exp_f32 v71, v71
  v_mfma_f32_16x16x32_bf16 v[160:163], v[28:31], a[56:59], v[160:163]
  ds_read_b64_tr_b16 v[24:25], v1 offset:34880
  s_add_u32 s72, s72, s36
  v_rcp_f32 v76, v76
  v_mfma_f32_16x16x32_bf16 v[168:171], v[28:31], a[60:63], v[168:171]
  ds_read_b64_tr_b16 v[26:27], v1 offset:35392
ffn_hop56:
  s_cbranch_execz ffn_hop57
  s_waitcnt lgkmcnt(6)
  v_mfma_f32_16x16x32_bf16 v[128:131], v[32:35], a[56:59], v[128:131]
  ds_read_b64_tr_b16 v[28:29], v1 offset:34912
  v_rcp_f32 v77, v77
  v_rcp_f32 v78, v78
  v_rcp_f32 v79, v79
  v_pk_fma_f32 v[64:65], v[12:13], v[56:57], v[64:65] op_sel_hi:[0,1,1]
  v_pk_fma_f32 v[66:67], v[12:13], v[58:59], v[66:67] op_sel_hi:[0,1,1]
  v_pk_fma_f32 v[192:193], v[12:13], v[60:61], v[192:193] op_sel_hi:[0,1,1]
  v_pk_fma_f32 v[194:195], v[12:13], v[62:63], v[194:195] op_sel_hi:[0,1,1]
  v_pk_mul_f32 v[72:73], v[12:13], v[64:65] op_sel:[1,0] op_sel_hi:[1,1]
  v_pk_mul_f32 v[74:75], v[12:13], v[66:67] op_sel:[1,0] op_sel_hi:[1,1]
  v_pk_mul_f32 v[192:193], v[64:65], v[192:193]
  v_pk_mul_f32 v[194:195], v[66:67], v[194:195]
  v_pk_add_f32 v[68:69], v[4:5], v[68:69] op_sel_hi:[0,1]
  v_pk_add_f32 v[70:71], v[4:5], v[70:71] op_sel_hi:[0,1]
  v_pk_mul_f32 v[196:197], v[196:197], v[76:77]
  v_pk_mul_f32 v[198:199], v[198:199], v[78:79]
  v_mfma_f32_16x16x32_bf16 v[132:135], v[32:35], a[60:63], v[132:135]
  ds_read_b64_tr_b16 v[30:31], v1 offset:35424
  s_add_u32 m0, s64, 18432
  v_mfma_f32_16x16x32_bf16 v[140:143], v[36:39], a[56:59], v[140:143]
  buffer_load_dwordx4 a[192:195], v8, s[52:55], 0 offen offset:0 sc1 nt
  v_mfma_f32_16x16x32_bf16 v[148:151], v[36:39], a[60:63], v[148:151]
  ds_read_b64_tr_b16 v[32:33], v1 offset:35840
  ds_read_b64_tr_b16 v[34:35], v1 offset:36352
  v_mfma_f32_16x16x32_bf16 v[152:155], v[40:43], a[56:59], v[152:155]
  buffer_load_dwordx4 v5, s[32:35], s72 offen offset:0 lds
  v_mfma_f32_16x16x32_bf16 v[156:159], v[40:43], a[60:63], v[156:159]
  ds_read_b64_tr_b16 v[36:37], v1 offset:35872
  ds_read_b64_tr_b16 v[38:39], v1 offset:36384
  v_mfma_f32_16x16x32_bf16 v[164:167], v[44:47], a[56:59], v[164:167]
  ds_read_b64_tr_b16 v[40:41], v1 offset:35904
  buffer_load_dwordx4 a[196:199], v8, s[52:55], 0 offen offset:1024 sc1 nt
  v_mfma_f32_16x16x32_bf16 v[172:175], v[44:47], a[60:63], v[172:175]
  ds_read_b64_tr_b16 v[42:43], v1 offset:36416
  s_waitcnt lgkmcnt(6)
  v_mfma_f32_16x16x32_bf16 v[112:115], v[16:19], a[64:67], v[112:115]
  buffer_load_dwordx4 v6, s[32:35], s72 offen offset:1024 lds
  v_mfma_f32_16x16x32_bf16 v[116:119], v[16:19], a[68:71], v[116:119]
  ds_read_b64_tr_b16 v[44:45], v1 offset:35936
  ds_read_b64_tr_b16 v[46:47], v1 offset:36448
  v_mfma_f32_16x16x32_bf16 v[136:139], v[20:23], a[64:67], v[136:139]
  ds_read_b64_tr_b16 v[16:17], v1 offset:36864
  s_add_u32 s72, s67, 0
  v_cvt_pk_bf16_f32 v220, v196, v197
  v_mfma_f32_16x16x32_bf16 v[144:147], v[20:23], a[68:71], v[144:147]
  buffer_load_dwordx4 a[200:203], v8, s[52:55], 0 offen offset:2048 sc1 nt
  v_cvt_pk_bf16_f32 v221, v198, v199
  v_mfma_f32_16x16x32_bf16 v[120:123], v[24:27], a[64:67], v[120:123]
  ds_read_b64_tr_b16 v[18:19], v1 offset:37376
  ds_read_b64_tr_b16 v[20:21], v1 offset:36896
  ds_read_b128 v[56:59], v9 offset:704
  ds_read_b128 v[60:63], v9 offset:2752
  v_mfma_f32_16x16x32_bf16 v[124:127], v[24:27], a[68:71], v[124:127]
  ds_read_b64_tr_b16 v[22:23], v1 offset:37408
  s_add_u32 s72, s72, s36
  v_accvgpr_read_b32 v196, a168
  v_mfma_f32_16x16x32_bf16 v[160:163], v[28:31], a[64:67], v[160:163]
  ds_read_b64_tr_b16 v[24:25], v1 offset:36928
  v_accvgpr_read_b32 v197, a169
  v_accvgpr_read_b32 v198, a170
  v_accvgpr_read_b32 v199, a171
  v_mfma_f32_16x16x32_bf16 v[168:171], v[28:31], a[68:71], v[168:171]
  ds_read_b64_tr_b16 v[26:27], v1 offset:37440
  v_exp_f32 v72, v72
  s_waitcnt lgkmcnt(8)
  v_mfma_f32_16x16x32_bf16 v[128:131], v[32:35], a[64:67], v[128:131]
  ds_read_b64_tr_b16 v[28:29], v1 offset:36960
  s_add_u32 m0, s64, 20480
  v_exp_f32 v73, v73
  v_mfma_f32_16x16x32_bf16 v[132:135], v[32:35], a[68:71], v[132:135]
  buffer_load_dwordx4 a[204:207], v8, s[52:55], 0 offen offset:3072 sc1 nt
ffn_hop57:
  s_cbranch_execz ffn_hop58
  v_exp_f32 v74, v74
  v_mfma_f32_16x16x32_bf16 v[140:143], v[36:39], a[64:67], v[140:143]
  ds_read_b64_tr_b16 v[30:31], v1 offset:37472
  ds_read_b64_tr_b16 v[32:33], v1 offset:37888
  v_exp_f32 v75, v75
  v_mfma_f32_16x16x32_bf16 v[148:151], v[36:39], a[68:71], v[148:151]
  buffer_load_dwordx4 v5, s[32:35], s72 offen offset:0 lds
  v_mfma_f32_16x16x32_bf16 v[152:155], v[40:43], a[64:67], v[152:155]
  ds_read_b64_tr_b16 v[34:35], v1 offset:38400
  ds_read_b64_tr_b16 v[36:37], v1 offset:37920
  v_rcp_f32 v68, v68
  v_mfma_f32_16x16x32_bf16 v[156:159], v[40:43], a[68:71], v[156:159]
  buffer_load_dwordx4 a[208:211], v8, s[52:55], s80 offen offset:0 sc1 nt
  v_rcp_f32 v69, v69
  v_rcp_f32 v70, v70
  v_rcp_f32 v71, v71
  v_pk_fma_f32 v[224:225], v[10:11], v[48:49], v[224:225] op_sel_hi:[0,1,1]
  v_pk_fma_f32 v[226:227], v[10:11], v[50:51], v[226:227] op_sel_hi:[0,1,1]
  v_pk_fma_f32 v[196:197], v[10:11], v[52:53], v[196:197] op_sel_hi:[0,1,1]
  v_pk_fma_f32 v[198:199], v[10:11], v[54:55], v[198:199] op_sel_hi:[0,1,1]
  v_pk_mul_f32 v[76:77], v[10:11], v[224:225] op_sel:[1,0] op_sel_hi:[1,1]
  v_pk_mul_f32 v[78:79], v[10:11], v[226:227] op_sel:[1,0] op_sel_hi:[1,1]
  v_pk_mul_f32 v[196:197], v[224:225], v[196:197]
  v_pk_mul_f32 v[198:199], v[226:227], v[198:199]
  v_pk_add_f32 v[72:73], v[4:5], v[72:73] op_sel_hi:[0,1]
  v_pk_add_f32 v[74:75], v[4:5], v[74:75] op_sel_hi:[0,1]
  v_pk_mul_f32 v[188:189], v[188:189], v[68:69]
  v_pk_mul_f32 v[190:191], v[190:191], v[70:71]
  v_mfma_f32_16x16x32_bf16 v[164:167], v[44:47], a[64:67], v[164:167]
  ds_read_b64_tr_b16 v[38:39], v1 offset:38432
  ds_read_b64_tr_b16 v[40:41], v1 offset:37952
  v_mfma_f32_16x16x32_bf16 v[172:175], v[44:47], a[68:71], v[172:175]
  ds_read_b64_tr_b16 v[42:43], v1 offset:38464
  s_waitcnt lgkmcnt(6)
  v_mfma_f32_16x16x32_bf16 v[112:115], v[16:19], a[72:75], v[112:115]
  buffer_load_dwordx4 v6, s[32:35], s72 offen offset:1024 lds
  v_mfma_f32_16x16x32_bf16 v[116:119], v[16:19], a[76:79], v[116:119]
  ds_read_b64_tr_b16 v[44:45], v1 offset:37984
  ds_read_b64_tr_b16 v[46:47], v1 offset:38496
  v_mfma_f32_16x16x32_bf16 v[136:139], v[20:23], a[72:75], v[136:139]
  ds_read_b64_tr_b16 v[16:17], v1 offset:0
  s_add_u32 s72, s67, 73728
  v_mfma_f32_16x16x32_bf16 v[144:147], v[20:23], a[76:79], v[144:147]
  ds_read_b64_tr_b16 v[18:19], v1 offset:512
  buffer_load_dwordx4 a[212:215], v8, s[52:55], s80 offen offset:1024 sc1 nt
  v_mfma_f32_16x16x32_bf16 v[120:123], v[24:27], a[72:75], v[120:123]
  ds_read_b64_tr_b16 v[20:21], v1 offset:32
  s_add_u32 s72, s72, s36
  v_mfma_f32_16x16x32_bf16 v[124:127], v[24:27], a[76:79], v[124:127]
  buffer_load_dwordx4 a[216:219], v8, s[52:55], s80 offen offset:2048 sc1 nt
  v_mfma_f32_16x16x32_bf16 v[160:163], v[28:31], a[72:75], v[160:163]
  ds_read_b64_tr_b16 v[22:23], v1 offset:544
  ds_read_b64_tr_b16 v[24:25], v1 offset:64
  v_mfma_f32_16x16x32_bf16 v[168:171], v[28:31], a[76:79], v[168:171]
  ds_read_b64_tr_b16 v[26:27], v1 offset:576
  s_waitcnt lgkmcnt(6)
  v_mfma_f32_16x16x32_bf16 v[128:131], v[32:35], a[72:75], v[128:131]
  ds_read_b64_tr_b16 v[28:29], v1 offset:96
  s_add_u32 m0, s64, 22528
  v_mfma_f32_16x16x32_bf16 v[132:135], v[32:35], a[76:79], v[132:135]
  ds_read_b64_tr_b16 v[30:31], v1 offset:608
  buffer_load_dwordx4 a[220:223], v8, s[52:55], s80 offen offset:3072 sc1 nt
  v_cvt_pk_bf16_f32 v218, v188, v189
  v_cvt_pk_bf16_f32 v219, v190, v191
ffn_hop58:
  s_cbranch_execz ffn_hop59
  v_mfma_f32_16x16x32_bf16 v[140:143], v[36:39], a[72:75], v[140:143]
  buffer_load_dwordx4 v5, s[32:35], s72 offen offset:0 lds
  buffer_store_dwordx4 v[216:219], v8, s[48:51], s81 offen offset:0 sc1
  v_mfma_f32_16x16x32_bf16 v[148:151], v[36:39], a[76:79], v[148:151]
  ds_read_b64_tr_b16 v[32:33], v1 offset:1024
  ds_read_b64_tr_b16 v[34:35], v1 offset:1536
  v_accvgpr_read_b32 v188, a172
  v_mfma_f32_16x16x32_bf16 v[152:155], v[40:43], a[72:75], v[152:155]
  ds_read_b64_tr_b16 v[36:37], v1 offset:1056
  v_accvgpr_read_b32 v189, a173
  v_accvgpr_read_b32 v190, a174
  v_accvgpr_read_b32 v191, a175
  v_mfma_f32_16x16x32_bf16 v[156:159], v[40:43], a[76:79], v[156:159]
  buffer_load_dwordx4 v6, s[32:35], s72 offen offset:1024 lds
  v_exp_f32 v76, v76
  v_mfma_f32_16x16x32_bf16 v[164:167], v[44:47], a[72:75], v[164:167]
  ds_read_b64_tr_b16 v[38:39], v1 offset:1568
  ds_read_b64_tr_b16 v[40:41], v1 offset:1088
  v_exp_f32 v77, v77
  v_mfma_f32_16x16x32_bf16 v[172:175], v[44:47], a[76:79], v[172:175]
  ds_read_b64_tr_b16 v[42:43], v1 offset:1600
  v_exp_f32 v78, v78
  s_waitcnt lgkmcnt(6)
  v_mfma_f32_16x16x32_bf16 v[112:115], v[16:19], a[80:83], v[112:115]
  ds_read_b64_tr_b16 v[44:45], v1 offset:1120
  s_add_u32 s72, s66, 0
  v_exp_f32 v79, v79
  v_mfma_f32_16x16x32_bf16 v[116:119], v[16:19], a[84:87], v[116:119]
  v_rcp_f32 v72, v72
  v_mfma_f32_16x16x32_bf16 v[136:139], v[20:23], a[80:83], v[136:139]
  ds_read_b64_tr_b16 v[46:47], v1 offset:1632
  ds_read_b64_tr_b16 v[16:17], v1 offset:2048
  v_rcp_f32 v73, v73
  v_rcp_f32 v74, v74
  v_rcp_f32 v75, v75
  v_pk_fma_f32 v[228:229], v[12:13], v[48:49], v[228:229] op_sel_hi:[0,1,1]
  v_pk_fma_f32 v[230:231], v[12:13], v[50:51], v[230:231] op_sel_hi:[0,1,1]
  v_pk_fma_f32 v[188:189], v[12:13], v[52:53], v[188:189] op_sel_hi:[0,1,1]
  v_pk_fma_f32 v[190:191], v[12:13], v[54:55], v[190:191] op_sel_hi:[0,1,1]
  v_pk_mul_f32 v[68:69], v[12:13], v[228:229] op_sel:[1,0] op_sel_hi:[1,1]
  v_pk_mul_f32 v[70:71], v[12:13], v[230:231] op_sel:[1,0] op_sel_hi:[1,1]
  v_pk_mul_f32 v[188:189], v[228:229], v[188:189]
  v_pk_mul_f32 v[190:191], v[230:231], v[190:191]
  v_pk_add_f32 v[76:77], v[4:5], v[76:77] op_sel_hi:[0,1]
  v_pk_add_f32 v[78:79], v[4:5], v[78:79] op_sel_hi:[0,1]
  v_pk_mul_f32 v[192:193], v[192:193], v[72:73]
  v_pk_mul_f32 v[194:195], v[194:195], v[74:75]
  v_mfma_f32_16x16x32_bf16 v[144:147], v[20:23], a[84:87], v[144:147]
  ds_read_b64_tr_b16 v[18:19], v1 offset:2560
  s_add_u32 s72, s72, s37
  v_mfma_f32_16x16x32_bf16 v[120:123], v[24:27], a[80:83], v[120:123]
  ds_read_b64_tr_b16 v[20:21], v1 offset:2080
  v_cvt_pk_bf16_f32 v222, v192, v193
  v_mfma_f32_16x16x32_bf16 v[124:127], v[24:27], a[84:87], v[124:127]
  ds_read_b64_tr_b16 v[22:23], v1 offset:2592
  v_cvt_pk_bf16_f32 v223, v194, v195
  v_mfma_f32_16x16x32_bf16 v[160:163], v[28:31], a[80:83], v[160:163]
  ds_read_b64_tr_b16 v[24:25], v1 offset:2112
  s_add_u32 m0, s64, 24576
  v_mfma_f32_16x16x32_bf16 v[168:171], v[28:31], a[84:87], v[168:171]
  ds_read_b64_tr_b16 v[26:27], v1 offset:2624
  s_waitcnt lgkmcnt(6)
  v_mfma_f32_16x16x32_bf16 v[128:131], v[32:35], a[80:83], v[128:131]
  ds_read_b64_tr_b16 v[28:29], v1 offset:2144
  buffer_store_dwordx4 v[220:223], v8, s[48:51], s81 offen offset:1024 sc1
  v_mfma_f32_16x16x32_bf16 v[132:135], v[32:35], a[84:87], v[132:135]
  buffer_load_dwordx4 v5, s[32:35], s72 offen offset:0 lds
  v_mfma_f32_16x16x32_bf16 v[140:143], v[36:39], a[80:83], v[140:143]
  ds_read_b64_tr_b16 v[30:31], v1 offset:2656
ffn_hop59:
  s_cbranch_execz ffn_hop60
  ds_read_b64_tr_b16 v[32:33], v1 offset:3072
  v_mfma_f32_16x16x32_bf16 v[148:151], v[36:39], a[84:87], v[148:151]
  ds_read_b64_tr_b16 v[34:35], v1 offset:3584
  ds_read_b128 v[48:51], v9 offset:768
  v_mfma_f32_16x16x32_bf16 v[152:155], v[40:43], a[80:83], v[152:155]
  buffer_load_dwordx4 v6, s[32:35], s72 offen offset:1024 lds
  v_mfma_f32_16x16x32_bf16 v[156:159], v[40:43], a[84:87], v[156:159]
  ds_read_b64_tr_b16 v[36:37], v1 offset:3104
  ds_read_b64_tr_b16 v[38:39], v1 offset:3616
  v_mfma_f32_16x16x32_bf16 v[164:167], v[44:47], a[80:83], v[164:167]
  ds_read_b64_tr_b16 v[40:41], v1 offset:3136
  ds_read_b128 v[52:55], v9 offset:2816
  v_accvgpr_read_b32 v64, a176
  v_mfma_f32_16x16x32_bf16 v[172:175], v[44:47], a[84:87], v[172:175]
  ds_read_b64_tr_b16 v[42:43], v1 offset:3648
  v_accvgpr_read_b32 v65, a177
  v_accvgpr_read_b32 v66, a178
  s_waitcnt lgkmcnt(8)
  v_mfma_f32_16x16x32_bf16 v[112:115], v[16:19], a[88:91], v[112:115]
  ds_read_b64_tr_b16 v[44:45], v1 offset:3168
  v_accvgpr_read_b32 v67, a179
  v_accvgpr_read_b32 v192, a180
  v_accvgpr_read_b32 v193, a181
  v_mfma_f32_16x16x32_bf16 v[116:119], v[16:19], a[92:95], v[116:119]
  ds_read_b64_tr_b16 v[46:47], v1 offset:3680
  v_accvgpr_read_b32 v194, a182
  v_accvgpr_read_b32 v195, a183
  v_mfma_f32_16x16x32_bf16 v[136:139], v[20:23], a[88:91], v[136:139]
  s_barrier
  ds_read_b64_tr_b16 v[16:17], v1 offset:4096
  v_exp_f32 v68, v68
  v_mfma_f32_16x16x32_bf16 v[144:147], v[20:23], a[92:95], v[144:147]
  ds_read_b64_tr_b16 v[18:19], v1 offset:4608
  s_add_u32 s72, s66, 73728
  v_exp_f32 v69, v69
  v_mfma_f32_16x16x32_bf16 v[120:123], v[24:27], a[88:91], v[120:123]
  ds_read_b64_tr_b16 v[20:21], v1 offset:4128
  v_exp_f32 v70, v70
  v_mfma_f32_16x16x32_bf16 v[124:127], v[24:27], a[92:95], v[124:127]
  ds_read_b64_tr_b16 v[22:23], v1 offset:4640
  v_exp_f32 v71, v71
  v_rcp_f32 v76, v76
  v_mfma_f32_16x16x32_bf16 v[160:163], v[28:31], a[88:91], v[160:163]
  ds_read_b64_tr_b16 v[24:25], v1 offset:4160
  s_add_u32 s72, s72, s37
  v_rcp_f32 v77, v77
  v_rcp_f32 v78, v78
  v_rcp_f32 v79, v79
  v_pk_fma_f32 v[64:65], v[10:11], v[56:57], v[64:65] op_sel_hi:[0,1,1]
  v_pk_fma_f32 v[66:67], v[10:11], v[58:59], v[66:67] op_sel_hi:[0,1,1]
  v_pk_fma_f32 v[192:193], v[10:11], v[60:61], v[192:193] op_sel_hi:[0,1,1]
  v_pk_fma_f32 v[194:195], v[10:11], v[62:63], v[194:195] op_sel_hi:[0,1,1]
  v_pk_mul_f32 v[72:73], v[10:11], v[64:65] op_sel:[1,0] op_sel_hi:[1,1]
  v_pk_mul_f32 v[74:75], v[10:11], v[66:67] op_sel:[1,0] op_sel_hi:[1,1]
  v_pk_mul_f32 v[192:193], v[64:65], v[192:193]
  v_pk_mul_f32 v[194:195], v[66:67], v[194:195]
  v_pk_add_f32 v[68:69], v[4:5], v[68:69] op_sel_hi:[0,1]
  v_pk_add_f32 v[70:71], v[4:5], v[70:71] op_sel_hi:[0,1]
  v_pk_mul_f32 v[196:197], v[196:197], v[76:77]
  v_pk_mul_f32 v[198:199], v[198:199], v[78:79]
  v_mfma_f32_16x16x32_bf16 v[168:171], v[28:31], a[92:95], v[168:171]
  ds_read_b64_tr_b16 v[26:27], v1 offset:4672
  s_waitcnt lgkmcnt(6)
  v_mfma_f32_16x16x32_bf16 v[128:131], v[32:35], a[88:91], v[128:131]
  ds_read_b64_tr_b16 v[28:29], v1 offset:4192
  v_cvt_pk_bf16_f32 v224, v196, v197
  v_mfma_f32_16x16x32_bf16 v[132:135], v[32:35], a[92:95], v[132:135]
  ds_read_b64_tr_b16 v[30:31], v1 offset:4704
  s_add_u32 m0, s64, 26624
  v_mfma_f32_16x16x32_bf16 v[140:143], v[36:39], a[88:91], v[140:143]
  ds_read_b64_tr_b16 v[32:33], v1 offset:5120
  v_cvt_pk_bf16_f32 v225, v198, v199
  v_mfma_f32_16x16x32_bf16 v[148:151], v[36:39], a[92:95], v[148:151]
  ds_read_b64_tr_b16 v[34:35], v1 offset:5632
ffn_hop60:
  s_cbranch_execz ffn_hop61
  v_accvgpr_read_b32 v64, a184
  v_mfma_f32_16x16x32_bf16 v[152:155], v[40:43], a[88:91], v[152:155]
  buffer_load_dwordx4 v5, s[32:35], s72 offen offset:0 lds
  v_mfma_f32_16x16x32_bf16 v[156:159], v[40:43], a[92:95], v[156:159]
  ds_read_b64_tr_b16 v[36:37], v1 offset:5152
  ds_read_b64_tr_b16 v[38:39], v1 offset:5664
  v_mfma_f32_16x16x32_bf16 v[164:167], v[44:47], a[88:91], v[164:167]
  ds_read_b64_tr_b16 v[40:41], v1 offset:5184
  v_accvgpr_read_b32 v65, a185
  v_mfma_f32_16x16x32_bf16 v[172:175], v[44:47], a[92:95], v[172:175]
  ds_read_b64_tr_b16 v[42:43], v1 offset:5696
  s_waitcnt lgkmcnt(6)
  v_mfma_f32_16x16x32_bf16 v[112:115], v[16:19], a[96:99], v[112:115]
  buffer_load_dwordx4 v6, s[32:35], s72 offen offset:1024 lds
  v_mfma_f32_16x16x32_bf16 v[116:119], v[16:19], a[100:103], v[116:119]
  ds_read_b64_tr_b16 v[44:45], v1 offset:5216
  ds_read_b64_tr_b16 v[46:47], v1 offset:5728
  v_mfma_f32_16x16x32_bf16 v[136:139], v[20:23], a[96:99], v[136:139]
  ds_read_b64_tr_b16 v[16:17], v1 offset:6144
  s_add_u32 s72, s66, 147456
  v_accvgpr_read_b32 v66, a186
  v_mfma_f32_16x16x32_bf16 v[144:147], v[20:23], a[100:103], v[144:147]
  ds_read_b64_tr_b16 v[18:19], v1 offset:6656
  v_accvgpr_read_b32 v67, a187
  v_accvgpr_read_b32 v196, a188
  v_mfma_f32_16x16x32_bf16 v[120:123], v[24:27], a[96:99], v[120:123]
  ds_read_b64_tr_b16 v[20:21], v1 offset:6176
  v_accvgpr_read_b32 v197, a189
  v_accvgpr_read_b32 v198, a190
  v_accvgpr_read_b32 v199, a191
  v_mfma_f32_16x16x32_bf16 v[124:127], v[24:27], a[100:103], v[124:127]
  ds_read_b64_tr_b16 v[22:23], v1 offset:6688
  s_add_u32 s72, s72, s36
  v_exp_f32 v72, v72
  v_mfma_f32_16x16x32_bf16 v[160:163], v[28:31], a[96:99], v[160:163]
  ds_read_b64_tr_b16 v[24:25], v1 offset:6208
  v_exp_f32 v73, v73
  v_exp_f32 v74, v74
  v_mfma_f32_16x16x32_bf16 v[168:171], v[28:31], a[100:103], v[168:171]
  ds_read_b64_tr_b16 v[26:27], v1 offset:6720
  s_waitcnt lgkmcnt(6)
  v_mfma_f32_16x16x32_bf16 v[128:131], v[32:35], a[96:99], v[128:131]
  ds_read_b64_tr_b16 v[28:29], v1 offset:6240
  s_add_u32 m0, s64, 28672
  v_exp_f32 v75, v75
  v_mfma_f32_16x16x32_bf16 v[132:135], v[32:35], a[100:103], v[132:135]
  ds_read_b64_tr_b16 v[30:31], v1 offset:6752
  v_rcp_f32 v68, v68
  v_rcp_f32 v69, v69
  v_rcp_f32 v70, v70
  v_rcp_f32 v71, v71
  v_pk_fma_f32 v[64:65], v[12:13], v[56:57], v[64:65] op_sel_hi:[0,1,1]
  v_pk_fma_f32 v[66:67], v[12:13], v[58:59], v[66:67] op_sel_hi:[0,1,1]
  v_pk_fma_f32 v[196:197], v[12:13], v[60:61], v[196:197] op_sel_hi:[0,1,1]
  v_pk_fma_f32 v[198:199], v[12:13], v[62:63], v[198:199] op_sel_hi:[0,1,1]
  v_pk_mul_f32 v[76:77], v[12:13], v[64:65] op_sel:[1,0] op_sel_hi:[1,1]
  v_pk_mul_f32 v[78:79], v[12:13], v[66:67] op_sel:[1,0] op_sel_hi:[1,1]
  v_pk_mul_f32 v[196:197], v[64:65], v[196:197]
  v_pk_mul_f32 v[198:199], v[66:67], v[198:199]
  v_pk_add_f32 v[72:73], v[4:5], v[72:73] op_sel_hi:[0,1]
  v_pk_add_f32 v[74:75], v[4:5], v[74:75] op_sel_hi:[0,1]
  v_pk_mul_f32 v[188:189], v[188:189], v[68:69]
  v_pk_mul_f32 v[190:191], v[190:191], v[70:71]
  v_mfma_f32_16x16x32_bf16 v[140:143], v[36:39], a[96:99], v[140:143]
  ds_read_b64_tr_b16 v[32:33], v1 offset:7168
ffn_hop61:
  s_cbranch_execz ffn_hop62
  v_cvt_pk_bf16_f32 v228, v188, v189
  v_mfma_f32_16x16x32_bf16 v[148:151], v[36:39], a[100:103], v[148:151]
  buffer_load_dwordx4 v5, s[32:35], s72 offen offset:0 lds
  v_mfma_f32_16x16x32_bf16 v[152:155], v[40:43], a[96:99], v[152:155]
  ds_read_b64_tr_b16 v[34:35], v1 offset:7680
  ds_read_b64_tr_b16 v[36:37], v1 offset:7200
  v_mfma_f32_16x16x32_bf16 v[156:159], v[40:43], a[100:103], v[156:159]
  ds_read_b64_tr_b16 v[38:39], v1 offset:7712
  v_cvt_pk_bf16_f32 v229, v190, v191
  v_mfma_f32_16x16x32_bf16 v[164:167], v[44:47], a[96:99], v[164:167]
  ds_read_b64_tr_b16 v[40:41], v1 offset:7232
  v_exp_f32 v76, v76
  v_mfma_f32_16x16x32_bf16 v[172:175], v[44:47], a[100:103], v[172:175]
  ds_read_b64_tr_b16 v[42:43], v1 offset:7744
  s_waitcnt lgkmcnt(6)
  v_mfma_f32_16x16x32_bf16 v[112:115], v[16:19], a[104:107], v[112:115]
  buffer_load_dwordx4 v6, s[32:35], s72 offen offset:1024 lds
  v_mfma_f32_16x16x32_bf16 v[116:119], v[16:19], a[108:111], v[116:119]
  ds_read_b64_tr_b16 v[44:45], v1 offset:7264
  ds_read_b64_tr_b16 v[46:47], v1 offset:7776
  v_mfma_f32_16x16x32_bf16 v[136:139], v[20:23], a[104:107], v[136:139]
  ds_read_b64_tr_b16 v[16:17], v1 offset:8192
  s_add_u32 s72, s67, 0
  v_mfma_f32_16x16x32_bf16 v[144:147], v[20:23], a[108:111], v[144:147]
  ds_read_b64_tr_b16 v[18:19], v1 offset:8704
  v_exp_f32 v77, v77
  v_mfma_f32_16x16x32_bf16 v[120:123], v[24:27], a[104:107], v[120:123]
  ds_read_b64_tr_b16 v[20:21], v1 offset:8224
  s_add_u32 s72, s72, s37
  v_mfma_f32_16x16x32_bf16 v[124:127], v[24:27], a[108:111], v[124:127]
  v_exp_f32 v78, v78
  v_mfma_f32_16x16x32_bf16 v[160:163], v[28:31], a[104:107], v[160:163]
  ds_read_b64_tr_b16 v[22:23], v1 offset:8736
  ds_read_b64_tr_b16 v[24:25], v1 offset:8256
  v_mfma_f32_16x16x32_bf16 v[168:171], v[28:31], a[108:111], v[168:171]
  ds_read_b64_tr_b16 v[26:27], v1 offset:8768
  v_exp_f32 v79, v79
  s_waitcnt lgkmcnt(6)
  v_mfma_f32_16x16x32_bf16 v[128:131], v[32:35], a[104:107], v[128:131]
  ds_read_b64_tr_b16 v[28:29], v1 offset:8288
  s_add_u32 m0, s64, 30720
  v_rcp_f32 v72, v72
  v_mfma_f32_16x16x32_bf16 v[132:135], v[32:35], a[108:111], v[132:135]
  ds_read_b64_tr_b16 v[30:31], v1 offset:8800
  v_rcp_f32 v73, v73
  v_rcp_f32 v74, v74
  v_rcp_f32 v75, v75
  v_pk_add_f32 v[76:77], v[4:5], v[76:77] op_sel_hi:[0,1]
  v_pk_add_f32 v[78:79], v[4:5], v[78:79] op_sel_hi:[0,1]
  v_pk_mul_f32 v[192:193], v[192:193], v[72:73]
  v_pk_mul_f32 v[194:195], v[194:195], v[74:75]
  v_mfma_f32_16x16x32_bf16 v[140:143], v[36:39], a[104:107], v[140:143]
  buffer_load_dwordx4 v5, s[32:35], s72 offen offset:0 lds
  v_mfma_f32_16x16x32_bf16 v[148:151], v[36:39], a[108:111], v[148:151]
  ds_read_b64_tr_b16 v[32:33], v1 offset:9216
  ds_read_b64_tr_b16 v[34:35], v1 offset:9728
  v_mfma_f32_16x16x32_bf16 v[152:155], v[40:43], a[104:107], v[152:155]
  ds_read_b64_tr_b16 v[36:37], v1 offset:9248
  v_cvt_pk_bf16_f32 v226, v192, v193
  v_mfma_f32_16x16x32_bf16 v[156:159], v[40:43], a[108:111], v[156:159]
  buffer_load_dwordx4 v6, s[32:35], s72 offen offset:1024 lds
  v_mfma_f32_16x16x32_bf16 v[164:167], v[44:47], a[104:107], v[164:167]
  ds_read_b64_tr_b16 v[38:39], v1 offset:9760
  ds_read_b64_tr_b16 v[40:41], v1 offset:9280
  v_cvt_pk_bf16_f32 v227, v194, v195
  v_mfma_f32_16x16x32_bf16 v[172:175], v[44:47], a[108:111], v[172:175]
  ds_read_b64_tr_b16 v[42:43], v1 offset:9792
  buffer_store_dwordx4 v[224:227], v8, s[48:51], s81 offen offset:2048 sc1
  s_waitcnt lgkmcnt(6)
  v_mfma_f32_16x16x32_bf16 v[112:115], v[16:19], a[112:115], v[112:115]
  ds_read_b64_tr_b16 v[44:45], v1 offset:9312
  s_add_u32 s72, s66, 221184
  v_rcp_f32 v76, v76
  v_rcp_f32 v77, v77
  v_rcp_f32 v78, v78
ffn_hop62:
  s_cbranch_execz ffn_hop63
  v_rcp_f32 v79, v79
  s_nop 0
  v_pk_mul_f32 v[196:197], v[196:197], v[76:77]
  v_pk_mul_f32 v[198:199], v[198:199], v[78:79]
  v_mfma_f32_16x16x32_bf16 v[116:119], v[16:19], a[116:119], v[116:119]
  ds_read_b64_tr_b16 v[46:47], v1 offset:9824
  v_cvt_pk_bf16_f32 v230, v196, v197
  v_mfma_f32_16x16x32_bf16 v[136:139], v[20:23], a[112:115], v[136:139]
  ds_read_b64_tr_b16 v[16:17], v1 offset:10240
  v_cvt_pk_bf16_f32 v231, v198, v199
  v_mfma_f32_16x16x32_bf16 v[144:147], v[20:23], a[116:119], v[144:147]
  ds_read_b64_tr_b16 v[18:19], v1 offset:10752
  s_add_u32 s72, s72, s36
  v_mfma_f32_16x16x32_bf16 v[120:123], v[24:27], a[112:115], v[120:123]
  buffer_store_dwordx4 v[228:231], v8, s[48:51], s81 offen offset:3072 sc1
  v_mfma_f32_16x16x32_bf16 v[124:127], v[24:27], a[116:119], v[124:127]
  ds_read_b64_tr_b16 v[20:21], v1 offset:10272
  ds_read_b64_tr_b16 v[22:23], v1 offset:10784
  v_mfma_f32_16x16x32_bf16 v[160:163], v[28:31], a[112:115], v[160:163]
  ds_read_b64_tr_b16 v[24:25], v1 offset:10304
  s_add_u32 m0, s64, 32768
  v_mfma_f32_16x16x32_bf16 v[168:171], v[28:31], a[116:119], v[168:171]
  ds_read_b64_tr_b16 v[26:27], v1 offset:10816
  s_waitcnt lgkmcnt(6)
  v_mfma_f32_16x16x32_bf16 v[128:131], v[32:35], a[112:115], v[128:131]
  ds_read_b64_tr_b16 v[28:29], v1 offset:10336
  ds_read_b128 v[56:59], v9 offset:832
  v_mfma_f32_16x16x32_bf16 v[132:135], v[32:35], a[116:119], v[132:135]
  buffer_load_dwordx4 v5, s[32:35], s72 offen offset:0 lds
  v_mfma_f32_16x16x32_bf16 v[140:143], v[36:39], a[112:115], v[140:143]
  ds_read_b64_tr_b16 v[30:31], v1 offset:10848
  ds_read_b64_tr_b16 v[32:33], v1 offset:11264
  v_mfma_f32_16x16x32_bf16 v[148:151], v[36:39], a[116:119], v[148:151]
  ds_read_b64_tr_b16 v[34:35], v1 offset:11776
  ds_read_b128 v[60:63], v9 offset:2880
  v_mfma_f32_16x16x32_bf16 v[152:155], v[40:43], a[112:115], v[152:155]
  buffer_load_dwordx4 v6, s[32:35], s72 offen offset:1024 lds
  v_mfma_f32_16x16x32_bf16 v[156:159], v[40:43], a[116:119], v[156:159]
  ds_read_b64_tr_b16 v[36:37], v1 offset:11296
  ds_read_b64_tr_b16 v[38:39], v1 offset:11808
  v_mfma_f32_16x16x32_bf16 v[164:167], v[44:47], a[112:115], v[164:167]
  ds_read_b64_tr_b16 v[40:41], v1 offset:11328
  v_mfma_f32_16x16x32_bf16 v[172:175], v[44:47], a[116:119], v[172:175]
  ds_read_b64_tr_b16 v[42:43], v1 offset:11840
  s_waitcnt lgkmcnt(7)
  v_mfma_f32_16x16x32_bf16 v[112:115], v[16:19], a[120:123], v[112:115]
  ds_read_b64_tr_b16 v[44:45], v1 offset:11360
  v_mfma_f32_16x16x32_bf16 v[116:119], v[16:19], a[124:127], v[116:119]
  ds_read_b64_tr_b16 v[46:47], v1 offset:11872
  v_mfma_f32_16x16x32_bf16 v[136:139], v[20:23], a[120:123], v[136:139]
  s_waitcnt vmcnt(31)
  s_barrier
  ds_read_b64_tr_b16 v[16:17], v1 offset:12288
  v_mfma_f32_16x16x32_bf16 v[144:147], v[20:23], a[124:127], v[144:147]
  ds_read_b64_tr_b16 v[18:19], v1 offset:12800
  s_add_u32 s72, s67, 147456
  v_mfma_f32_16x16x32_bf16 v[120:123], v[24:27], a[120:123], v[120:123]
  ds_read_b64_tr_b16 v[20:21], v1 offset:12320
  s_add_u32 s72, s72, s36
  v_mfma_f32_16x16x32_bf16 v[124:127], v[24:27], a[124:127], v[124:127]
  ds_read_b64_tr_b16 v[22:23], v1 offset:12832
  s_add_u32 m0, s64, 34816
  v_mfma_f32_16x16x32_bf16 v[160:163], v[28:31], a[120:123], v[160:163]
  ds_read_b64_tr_b16 v[24:25], v1 offset:12352
ffn_hop63:
  s_cbranch_execz ffn_hop64
  v_mfma_f32_16x16x32_bf16 v[168:171], v[28:31], a[124:127], v[168:171]
  ds_read_b64_tr_b16 v[26:27], v1 offset:12864
  s_waitcnt lgkmcnt(6)
  v_mfma_f32_16x16x32_bf16 v[128:131], v[32:35], a[120:123], v[128:131]
  buffer_load_dwordx4 v5, s[32:35], s72 offen offset:0 lds
  v_mfma_f32_16x16x32_bf16 v[132:135], v[32:35], a[124:127], v[132:135]
  ds_read_b64_tr_b16 v[28:29], v1 offset:12384
  ds_read_b64_tr_b16 v[30:31], v1 offset:12896
  v_mfma_f32_16x16x32_bf16 v[140:143], v[36:39], a[120:123], v[140:143]
  buffer_load_dwordx4 v6, s[32:35], s72 offen offset:1024 lds
  v_mfma_f32_16x16x32_bf16 v[148:151], v[36:39], a[124:127], v[148:151]
  ds_read_b64_tr_b16 v[32:33], v1 offset:13312
  ds_read_b64_tr_b16 v[34:35], v1 offset:13824
  v_mfma_f32_16x16x32_bf16 v[152:155], v[40:43], a[120:123], v[152:155]
  ds_read_b64_tr_b16 v[36:37], v1 offset:13344
  s_add_u32 s72, s68, s36
  v_mfma_f32_16x16x32_bf16 v[156:159], v[40:43], a[124:127], v[156:159]
  ds_read_b64_tr_b16 v[38:39], v1 offset:13856
  s_add_u32 m0, s64, 36864
  v_mfma_f32_16x16x32_bf16 v[164:167], v[44:47], a[120:123], v[164:167]
  ds_read_b64_tr_b16 v[40:41], v1 offset:13376
  v_mfma_f32_16x16x32_bf16 v[172:175], v[44:47], a[124:127], v[172:175]
  ds_read_b64_tr_b16 v[42:43], v1 offset:13888
  s_waitcnt lgkmcnt(6)
  v_mfma_f32_16x16x32_bf16 v[112:115], v[16:19], a[128:131], v[112:115]
  buffer_load_dwordx4 v5, s[32:35], s72 offen offset:0 lds
  v_mfma_f32_16x16x32_bf16 v[116:119], v[16:19], a[132:135], v[116:119]
  ds_read_b64_tr_b16 v[44:45], v1 offset:13408
  ds_read_b64_tr_b16 v[46:47], v1 offset:13920
  v_mfma_f32_16x16x32_bf16 v[136:139], v[20:23], a[128:131], v[136:139]
  ds_read_b64_tr_b16 v[16:17], v1 offset:14336
  s_add_u32 s72, s69, s36
  v_mfma_f32_16x16x32_bf16 v[144:147], v[20:23], a[132:135], v[144:147]
  ds_read_b64_tr_b16 v[18:19], v1 offset:14848
  s_add_u32 m0, s64, 37888
  v_mfma_f32_16x16x32_bf16 v[120:123], v[24:27], a[128:131], v[120:123]
  buffer_load_dwordx4 v5, s[32:35], s72 offen offset:0 lds
  v_mfma_f32_16x16x32_bf16 v[124:127], v[24:27], a[132:135], v[124:127]
  ds_read_b64_tr_b16 v[20:21], v1 offset:14368
  ds_read_b64_tr_b16 v[22:23], v1 offset:14880
  v_mfma_f32_16x16x32_bf16 v[160:163], v[28:31], a[128:131], v[160:163]
  ds_read_b64_tr_b16 v[24:25], v1 offset:14400
  s_add_u32 s72, s67, 73728
  v_mfma_f32_16x16x32_bf16 v[168:171], v[28:31], a[132:135], v[168:171]
  ds_read_b64_tr_b16 v[26:27], v1 offset:14912
  s_waitcnt lgkmcnt(6)
  v_mfma_f32_16x16x32_bf16 v[128:131], v[32:35], a[128:131], v[128:131]
  ds_read_b64_tr_b16 v[28:29], v1 offset:14432
  s_add_u32 s72, s72, s37
  v_mfma_f32_16x16x32_bf16 v[132:135], v[32:35], a[132:135], v[132:135]
  ds_read_b64_tr_b16 v[30:31], v1 offset:14944
  s_add_u32 m0, s64, 0
  v_mfma_f32_16x16x32_bf16 v[140:143], v[36:39], a[128:131], v[140:143]
  buffer_load_dwordx4 v5, s[32:35], s72 offen offset:0 lds
  v_mfma_f32_16x16x32_bf16 v[148:151], v[36:39], a[132:135], v[148:151]
  ds_read_b64_tr_b16 v[32:33], v1 offset:15360
  ds_read_b64_tr_b16 v[34:35], v1 offset:15872
  v_mfma_f32_16x16x32_bf16 v[152:155], v[40:43], a[128:131], v[152:155]
  buffer_load_dwordx4 v6, s[32:35], s72 offen offset:1024 lds
  s_waitcnt vmcnt(8)
  buffer_store_dword v5, off, s[60:63], s84 offset:4 sc1
  v_mfma_f32_16x16x32_bf16 v[156:159], v[40:43], a[132:135], v[156:159]
  ds_read_b64_tr_b16 v[36:37], v1 offset:15392
  ds_read_b64_tr_b16 v[38:39], v1 offset:15904
  v_mfma_f32_16x16x32_bf16 v[164:167], v[44:47], a[128:131], v[164:167]
  ds_read_b64_tr_b16 v[40:41], v1 offset:15424
  s_add_u32 s72, s67, 221184
ffn_hop64:
  s_cbranch_execz ffn_hop65
  v_mfma_f32_16x16x32_bf16 v[172:175], v[44:47], a[132:135], v[172:175]
  ds_read_b64_tr_b16 v[42:43], v1 offset:15936
  s_waitcnt lgkmcnt(6)
  v_mfma_f32_16x16x32_bf16 v[112:115], v[16:19], a[136:139], v[112:115]
  ds_read_b64_tr_b16 v[44:45], v1 offset:15456
  s_add_u32 s72, s72, s36
  v_mfma_f32_16x16x32_bf16 v[116:119], v[16:19], a[140:143], v[116:119]
  ds_read_b64_tr_b16 v[46:47], v1 offset:15968
  s_add_u32 m0, s64, 2048
  v_mfma_f32_16x16x32_bf16 v[136:139], v[20:23], a[136:139], v[136:139]
  s_barrier
  ds_read_b64_tr_b16 v[16:17], v1 offset:16384
  v_mfma_f32_16x16x32_bf16 v[144:147], v[20:23], a[140:143], v[144:147]
  buffer_load_dwordx4 v5, s[32:35], s72 offen offset:0 lds
  v_mfma_f32_16x16x32_bf16 v[120:123], v[24:27], a[136:139], v[120:123]
  ds_read_b64_tr_b16 v[18:19], v1 offset:16896
  ds_read_b64_tr_b16 v[20:21], v1 offset:16416
  v_mfma_f32_16x16x32_bf16 v[124:127], v[24:27], a[140:143], v[124:127]
  buffer_load_dwordx4 v6, s[32:35], s72 offen offset:1024 lds
  v_mfma_f32_16x16x32_bf16 v[160:163], v[28:31], a[136:139], v[160:163]
  ds_read_b64_tr_b16 v[22:23], v1 offset:16928
  ds_read_b64_tr_b16 v[24:25], v1 offset:16448
  v_mfma_f32_16x16x32_bf16 v[168:171], v[28:31], a[140:143], v[168:171]
  ds_read_b64_tr_b16 v[26:27], v1 offset:16960
  s_waitcnt lgkmcnt(6)
  v_mfma_f32_16x16x32_bf16 v[128:131], v[32:35], a[136:139], v[128:131]
  ds_read_b64_tr_b16 v[28:29], v1 offset:16480
  s_add_u32 s72, s66, 147456
  v_mfma_f32_16x16x32_bf16 v[132:135], v[32:35], a[140:143], v[132:135]
  ds_read_b64_tr_b16 v[30:31], v1 offset:16992
  s_add_u32 s72, s72, s37
  v_mfma_f32_16x16x32_bf16 v[140:143], v[36:39], a[136:139], v[140:143]
  ds_read_b64_tr_b16 v[32:33], v1 offset:17408
  s_add_u32 m0, s64, 4096
  v_mfma_f32_16x16x32_bf16 v[148:151], v[36:39], a[140:143], v[148:151]
  buffer_load_dwordx4 v5, s[32:35], s72 offen offset:0 lds
  v_mfma_f32_16x16x32_bf16 v[152:155], v[40:43], a[136:139], v[152:155]
  ds_read_b64_tr_b16 v[34:35], v1 offset:17920
  ds_read_b64_tr_b16 v[36:37], v1 offset:17440
  v_mfma_f32_16x16x32_bf16 v[156:159], v[40:43], a[140:143], v[156:159]
  ds_read_b64_tr_b16 v[38:39], v1 offset:17952
  v_mfma_f32_16x16x32_bf16 v[164:167], v[44:47], a[136:139], v[164:167]
  ds_read_b64_tr_b16 v[40:41], v1 offset:17472
  v_mfma_f32_16x16x32_bf16 v[172:175], v[44:47], a[140:143], v[172:175]
  ds_read_b64_tr_b16 v[42:43], v1 offset:17984
  s_waitcnt lgkmcnt(6)
  v_mfma_f32_16x16x32_bf16 a[0:3], v[16:19], v[80:83], 0
  buffer_load_dwordx4 v6, s[32:35], s72 offen offset:1024 lds
  v_mfma_f32_16x16x32_bf16 a[4:7], v[16:19], v[84:87], 0
  ds_read_b64_tr_b16 v[44:45], v1 offset:17504
  ds_read_b64_tr_b16 v[46:47], v1 offset:18016
  v_mfma_f32_16x16x32_bf16 a[8:11], v[20:23], v[80:83], 0
  ds_read_b64_tr_b16 v[16:17], v1 offset:18432
  s_add_u32 s72, s66, 221184
  v_mfma_f32_16x16x32_bf16 a[12:15], v[20:23], v[84:87], 0
  ds_read_b64_tr_b16 v[18:19], v1 offset:18944
  v_mfma_f32_16x16x32_bf16 a[16:19], v[24:27], v[80:83], 0
  ds_read_b64_tr_b16 v[20:21], v1 offset:18464
  s_add_u32 s72, s72, s37
  v_mfma_f32_16x16x32_bf16 a[20:23], v[24:27], v[84:87], 0
  ds_read_b64_tr_b16 v[22:23], v1 offset:18976
  v_mfma_f32_16x16x32_bf16 a[24:27], v[28:31], v[80:83], 0
  ds_read_b64_tr_b16 v[24:25], v1 offset:18496
  v_mfma_f32_16x16x32_bf16 a[28:31], v[28:31], v[84:87], 0
  ds_read_b64_tr_b16 v[26:27], v1 offset:19008
  s_waitcnt lgkmcnt(6)
  v_mfma_f32_16x16x32_bf16 a[0:3], v[32:35], v[88:91], a[0:3]
  ds_read_b64_tr_b16 v[28:29], v1 offset:18528
ffn_hop65:
  s_cbranch_execz ffn_hop66
  s_add_u32 m0, s64, 6144
  v_pk_fma_f32 v[112:113], v[10:11], v[48:49], v[112:113] op_sel_hi:[0,1,1]
  v_pk_fma_f32 v[114:115], v[10:11], v[50:51], v[114:115] op_sel_hi:[0,1,1]
  v_pk_fma_f32 v[128:129], v[10:11], v[52:53], v[128:129] op_sel_hi:[0,1,1]
  v_pk_fma_f32 v[130:131], v[10:11], v[54:55], v[130:131] op_sel_hi:[0,1,1]
  v_pk_mul_f32 v[68:69], v[10:11], v[112:113] op_sel:[1,0] op_sel_hi:[1,1]
  v_pk_mul_f32 v[70:71], v[10:11], v[114:115] op_sel:[1,0] op_sel_hi:[1,1]
  v_pk_mul_f32 v[128:129], v[112:113], v[128:129]
  v_pk_mul_f32 v[130:131], v[114:115], v[130:131]
  v_mfma_f32_16x16x32_bf16 a[4:7], v[32:35], v[92:95], a[4:7]
  ds_read_b64_tr_b16 v[30:31], v1 offset:19040
  v_exp_f32 v68, v68
  v_exp_f32 v69, v69
  v_exp_f32 v70, v70
  v_exp_f32 v71, v71
  v_pk_fma_f32 v[116:117], v[12:13], v[48:49], v[116:117] op_sel_hi:[0,1,1]
  v_pk_fma_f32 v[118:119], v[12:13], v[50:51], v[118:119] op_sel_hi:[0,1,1]
  v_pk_fma_f32 v[132:133], v[12:13], v[52:53], v[132:133] op_sel_hi:[0,1,1]
  v_pk_fma_f32 v[134:135], v[12:13], v[54:55], v[134:135] op_sel_hi:[0,1,1]
  v_pk_mul_f32 v[72:73], v[12:13], v[116:117] op_sel:[1,0] op_sel_hi:[1,1]
  v_pk_mul_f32 v[74:75], v[12:13], v[118:119] op_sel:[1,0] op_sel_hi:[1,1]
  v_pk_mul_f32 v[132:133], v[116:117], v[132:133]
  v_pk_mul_f32 v[134:135], v[118:119], v[134:135]
  v_pk_add_f32 v[68:69], v[4:5], v[68:69] op_sel_hi:[0,1]
  v_pk_add_f32 v[70:71], v[4:5], v[70:71] op_sel_hi:[0,1]
  v_mfma_f32_16x16x32_bf16 a[8:11], v[36:39], v[88:91], a[8:11]
  buffer_load_dwordx4 v5, s[32:35], s72 offen offset:0 lds
  v_mfma_f32_16x16x32_bf16 a[12:15], v[36:39], v[92:95], a[12:15]
  ds_read_b64_tr_b16 v[32:33], v1 offset:19456
  ds_read_b64_tr_b16 v[34:35], v1 offset:19968
  v_mfma_f32_16x16x32_bf16 a[16:19], v[40:43], v[88:91], a[16:19]
  ds_read_b64_tr_b16 v[36:37], v1 offset:19488
  ds_read_b128 v[48:51], v9 offset:896
  ds_read_b128 v[52:55], v9 offset:2944
  v_exp_f32 v72, v72
  v_exp_f32 v73, v73
  v_mfma_f32_16x16x32_bf16 a[20:23], v[40:43], v[92:95], a[20:23]
  buffer_load_dwordx4 v6, s[32:35], s72 offen offset:1024 lds
  v_exp_f32 v74, v74
  v_exp_f32 v75, v75
  v_rcp_f32 v68, v68
  v_rcp_f32 v69, v69
  v_rcp_f32 v70, v70
  v_rcp_f32 v71, v71
  v_pk_fma_f32 v[136:137], v[10:11], v[56:57], v[136:137] op_sel_hi:[0,1,1]
  v_pk_fma_f32 v[138:139], v[10:11], v[58:59], v[138:139] op_sel_hi:[0,1,1]
  v_pk_fma_f32 v[140:141], v[10:11], v[60:61], v[140:141] op_sel_hi:[0,1,1]
  v_pk_fma_f32 v[142:143], v[10:11], v[62:63], v[142:143] op_sel_hi:[0,1,1]
  v_pk_mul_f32 v[76:77], v[10:11], v[136:137] op_sel:[1,0] op_sel_hi:[1,1]
  v_pk_mul_f32 v[78:79], v[10:11], v[138:139] op_sel:[1,0] op_sel_hi:[1,1]
  v_pk_mul_f32 v[140:141], v[136:137], v[140:141]
  v_pk_mul_f32 v[142:143], v[138:139], v[142:143]
  v_pk_add_f32 v[72:73], v[4:5], v[72:73] op_sel_hi:[0,1]
  v_pk_add_f32 v[74:75], v[4:5], v[74:75] op_sel_hi:[0,1]
  v_pk_mul_f32 v[128:129], v[128:129], v[68:69]
  v_pk_mul_f32 v[130:131], v[130:131], v[70:71]
  v_mfma_f32_16x16x32_bf16 a[24:27], v[44:47], v[88:91], a[24:27]
  ds_read_b64_tr_b16 v[38:39], v1 offset:20000
  ds_read_b64_tr_b16 v[40:41], v1 offset:19520
  v_mfma_f32_16x16x32_bf16 a[28:31], v[44:47], v[92:95], a[28:31]
  ds_read_b64_tr_b16 v[42:43], v1 offset:20032
  s_waitcnt lgkmcnt(8)
  v_mfma_f32_16x16x32_bf16 a[0:3], v[16:19], v[96:99], a[0:3]
  ds_read_b64_tr_b16 v[44:45], v1 offset:19552
  s_add_u32 s72, s67, 147456
  v_cvt_pk_bf16_f32 v112, v128, v129
  v_mfma_f32_16x16x32_bf16 a[4:7], v[16:19], v[100:103], a[4:7]
  ds_read_b64_tr_b16 v[46:47], v1 offset:20064
  v_cvt_pk_bf16_f32 v113, v130, v131
  v_exp_f32 v76, v76
ffn_hop66:
  s_cbranch_execz ffn_hop67
  v_exp_f32 v77, v77
  v_exp_f32 v78, v78
  v_mfma_f32_16x16x32_bf16 a[8:11], v[20:23], v[96:99], a[8:11]
  ds_read_b64_tr_b16 v[16:17], v1 offset:20480
  s_add_u32 s72, s72, s37
  v_exp_f32 v79, v79
  v_rcp_f32 v72, v72
  v_rcp_f32 v73, v73
  v_rcp_f32 v74, v74
  v_rcp_f32 v75, v75
  v_pk_fma_f32 v[144:145], v[12:13], v[56:57], v[144:145] op_sel_hi:[0,1,1]
  v_pk_fma_f32 v[146:147], v[12:13], v[58:59], v[146:147] op_sel_hi:[0,1,1]
  v_pk_fma_f32 v[148:149], v[12:13], v[60:61], v[148:149] op_sel_hi:[0,1,1]
  v_pk_fma_f32 v[150:151], v[12:13], v[62:63], v[150:151] op_sel_hi:[0,1,1]
  v_pk_mul_f32 v[68:69], v[12:13], v[144:145] op_sel:[1,0] op_sel_hi:[1,1]
  v_pk_mul_f32 v[70:71], v[12:13], v[146:147] op_sel:[1,0] op_sel_hi:[1,1]
  v_pk_mul_f32 v[148:149], v[144:145], v[148:149]
  v_pk_mul_f32 v[150:151], v[146:147], v[150:151]
  v_pk_add_f32 v[76:77], v[4:5], v[76:77] op_sel_hi:[0,1]
  v_pk_add_f32 v[78:79], v[4:5], v[78:79] op_sel_hi:[0,1]
  v_pk_mul_f32 v[132:133], v[132:133], v[72:73]
  v_pk_mul_f32 v[134:135], v[134:135], v[74:75]
  v_mfma_f32_16x16x32_bf16 a[12:15], v[20:23], v[100:103], a[12:15]
  ds_read_b64_tr_b16 v[18:19], v1 offset:20992
  v_cvt_pk_bf16_f32 v116, v132, v133
  v_mfma_f32_16x16x32_bf16 a[16:19], v[24:27], v[96:99], a[16:19]
  ds_read_b64_tr_b16 v[20:21], v1 offset:20512
  buffer_load_dword v184, off, s[60:63], s85 offset:4 sc1
  v_mfma_f32_16x16x32_bf16 a[20:23], v[24:27], v[100:103], a[20:23]
  ds_read_b64_tr_b16 v[22:23], v1 offset:21024
  s_add_u32 m0, s64, 8192
  ds_read_b128 v[56:59], v9 offset:960
  v_cvt_pk_bf16_f32 v117, v134, v135
  v_mfma_f32_16x16x32_bf16 a[24:27], v[28:31], v[96:99], a[24:27]
  ds_read_b64_tr_b16 v[24:25], v1 offset:20544
  ds_read_b128 v[60:63], v9 offset:3008
  v_exp_f32 v68, v68
  v_exp_f32 v69, v69
  v_exp_f32 v70, v70
  v_exp_f32 v71, v71
  v_mfma_f32_16x16x32_bf16 a[28:31], v[28:31], v[100:103], a[28:31]
  ds_read_b64_tr_b16 v[26:27], v1 offset:21056
  v_rcp_f32 v76, v76
  s_waitcnt lgkmcnt(8)
  v_mfma_f32_16x16x32_bf16 a[0:3], v[32:35], v[104:107], a[0:3]
  buffer_load_dwordx4 v5, s[32:35], s72 offen offset:0 lds
  v_rcp_f32 v77, v77
  v_rcp_f32 v78, v78
  v_rcp_f32 v79, v79
  v_pk_fma_f32 v[120:121], v[10:11], v[48:49], v[120:121] op_sel_hi:[0,1,1]
  v_pk_fma_f32 v[122:123], v[10:11], v[50:51], v[122:123] op_sel_hi:[0,1,1]
  v_pk_fma_f32 v[152:153], v[10:11], v[52:53], v[152:153] op_sel_hi:[0,1,1]
  v_pk_fma_f32 v[154:155], v[10:11], v[54:55], v[154:155] op_sel_hi:[0,1,1]
  v_pk_mul_f32 v[72:73], v[10:11], v[120:121] op_sel:[1,0] op_sel_hi:[1,1]
  v_pk_mul_f32 v[74:75], v[10:11], v[122:123] op_sel:[1,0] op_sel_hi:[1,1]
  v_pk_mul_f32 v[152:153], v[120:121], v[152:153]
  v_pk_mul_f32 v[154:155], v[122:123], v[154:155]
  v_pk_add_f32 v[68:69], v[4:5], v[68:69] op_sel_hi:[0,1]
  v_pk_add_f32 v[70:71], v[4:5], v[70:71] op_sel_hi:[0,1]
  v_pk_mul_f32 v[140:141], v[140:141], v[76:77]
  v_pk_mul_f32 v[142:143], v[142:143], v[78:79]
  v_mfma_f32_16x16x32_bf16 a[4:7], v[32:35], v[108:111], a[4:7]
  ds_read_b64_tr_b16 v[28:29], v1 offset:20576
  ds_read_b64_tr_b16 v[30:31], v1 offset:21088
  v_mfma_f32_16x16x32_bf16 a[8:11], v[36:39], v[104:107], a[8:11]
  ds_read_b64_tr_b16 v[32:33], v1 offset:21504
  v_cvt_pk_bf16_f32 v114, v140, v141
  v_cvt_pk_bf16_f32 v115, v142, v143
  buffer_store_dwordx4 v[112:115], v8, s[48:51], s82 offen offset:0 sc1
  v_exp_f32 v72, v72
  v_mfma_f32_16x16x32_bf16 a[12:15], v[36:39], v[108:111], a[12:15]
  buffer_load_dwordx4 v6, s[32:35], s72 offen offset:1024 lds
  v_exp_f32 v73, v73
ffn_hop67:
  s_cbranch_execz ffn_hop68
  v_exp_f32 v74, v74
  v_exp_f32 v75, v75
  v_mfma_f32_16x16x32_bf16 a[16:19], v[40:43], v[104:107], a[16:19]
  ds_read_b64_tr_b16 v[34:35], v1 offset:22016
  ds_read_b64_tr_b16 v[36:37], v1 offset:21536
  v_rcp_f32 v68, v68
  v_rcp_f32 v69, v69
  v_rcp_f32 v70, v70
  v_rcp_f32 v71, v71
  v_pk_fma_f32 v[124:125], v[12:13], v[48:49], v[124:125] op_sel_hi:[0,1,1]
  v_pk_fma_f32 v[126:127], v[12:13], v[50:51], v[126:127] op_sel_hi:[0,1,1]
  v_pk_fma_f32 v[156:157], v[12:13], v[52:53], v[156:157] op_sel_hi:[0,1,1]
  v_pk_fma_f32 v[158:159], v[12:13], v[54:55], v[158:159] op_sel_hi:[0,1,1]
  v_pk_mul_f32 v[76:77], v[12:13], v[124:125] op_sel:[1,0] op_sel_hi:[1,1]
  v_pk_mul_f32 v[78:79], v[12:13], v[126:127] op_sel:[1,0] op_sel_hi:[1,1]
  v_pk_mul_f32 v[156:157], v[124:125], v[156:157]
  v_pk_mul_f32 v[158:159], v[126:127], v[158:159]
  v_pk_add_f32 v[72:73], v[4:5], v[72:73] op_sel_hi:[0,1]
  v_pk_add_f32 v[74:75], v[4:5], v[74:75] op_sel_hi:[0,1]
  v_pk_mul_f32 v[148:149], v[148:149], v[68:69]
  v_pk_mul_f32 v[150:151], v[150:151], v[70:71]
  v_mfma_f32_16x16x32_bf16 a[20:23], v[40:43], v[108:111], a[20:23]
  ds_read_b64_tr_b16 v[38:39], v1 offset:22048
  v_cvt_pk_bf16_f32 v118, v148, v149
  v_mfma_f32_16x16x32_bf16 a[24:27], v[44:47], v[104:107], a[24:27]
  ds_read_b64_tr_b16 v[40:41], v1 offset:21568
  s_add_u32 s72, s68, s37
  v_mfma_f32_16x16x32_bf16 a[28:31], v[44:47], v[108:111], a[28:31]
  ds_read_b64_tr_b16 v[42:43], v1 offset:22080
  v_cvt_pk_bf16_f32 v119, v150, v151
  buffer_store_dwordx4 v[116:119], v8, s[48:51], s82 offen offset:1024 sc1
  v_exp_f32 v76, v76
  s_waitcnt lgkmcnt(6)
  v_mfma_f32_16x16x32_bf16 a[0:3], v[16:19], a[192:195], a[0:3]
  ds_read_b64_tr_b16 v[44:45], v1 offset:21600
  v_exp_f32 v77, v77
  v_exp_f32 v78, v78
  v_exp_f32 v79, v79
  v_mfma_f32_16x16x32_bf16 a[4:7], v[16:19], a[196:199], a[4:7]
  ds_read_b64_tr_b16 v[46:47], v1 offset:22112
  s_add_u32 m0, s64, 10240
  v_rcp_f32 v72, v72
  v_rcp_f32 v73, v73
  v_rcp_f32 v74, v74
  v_rcp_f32 v75, v75
  v_pk_fma_f32 v[160:161], v[10:11], v[56:57], v[160:161] op_sel_hi:[0,1,1]
  v_pk_fma_f32 v[162:163], v[10:11], v[58:59], v[162:163] op_sel_hi:[0,1,1]
  v_pk_fma_f32 v[164:165], v[10:11], v[60:61], v[164:165] op_sel_hi:[0,1,1]
  v_pk_fma_f32 v[166:167], v[10:11], v[62:63], v[166:167] op_sel_hi:[0,1,1]
  v_pk_mul_f32 v[68:69], v[10:11], v[160:161] op_sel:[1,0] op_sel_hi:[1,1]
  v_pk_mul_f32 v[70:71], v[10:11], v[162:163] op_sel:[1,0] op_sel_hi:[1,1]
  v_pk_mul_f32 v[164:165], v[160:161], v[164:165]
  v_pk_mul_f32 v[166:167], v[162:163], v[166:167]
  v_pk_add_f32 v[76:77], v[4:5], v[76:77] op_sel_hi:[0,1]
  v_pk_add_f32 v[78:79], v[4:5], v[78:79] op_sel_hi:[0,1]
  v_pk_mul_f32 v[152:153], v[152:153], v[72:73]
  v_pk_mul_f32 v[154:155], v[154:155], v[74:75]
  v_mfma_f32_16x16x32_bf16 a[8:11], v[20:23], a[192:195], a[8:11]
  ds_read_b64_tr_b16 v[16:17], v1 offset:22528
  v_cvt_pk_bf16_f32 v120, v152, v153
  v_mfma_f32_16x16x32_bf16 a[12:15], v[20:23], a[196:199], a[12:15]
  ds_read_b64_tr_b16 v[18:19], v1 offset:23040
  v_cvt_pk_bf16_f32 v121, v154, v155
  v_mfma_f32_16x16x32_bf16 a[16:19], v[24:27], a[192:195], a[16:19]
  buffer_load_dwordx4 v5, s[32:35], s72 offen offset:0 lds
  v_exp_f32 v68, v68
  v_exp_f32 v69, v69
  v_mfma_f32_16x16x32_bf16 a[20:23], v[24:27], a[196:199], a[20:23]
  ds_read_b64_tr_b16 v[20:21], v1 offset:22560
  ds_read_b64_tr_b16 v[22:23], v1 offset:23072
  v_exp_f32 v70, v70
  v_exp_f32 v71, v71
  v_rcp_f32 v76, v76
  v_rcp_f32 v77, v77
  v_rcp_f32 v78, v78
ffn_hop68:
  s_cbranch_execz ffn_hop69
  v_rcp_f32 v79, v79
  v_pk_fma_f32 v[168:169], v[12:13], v[56:57], v[168:169] op_sel_hi:[0,1,1]
  v_pk_fma_f32 v[170:171], v[12:13], v[58:59], v[170:171] op_sel_hi:[0,1,1]
  v_pk_fma_f32 v[172:173], v[12:13], v[60:61], v[172:173] op_sel_hi:[0,1,1]
  v_pk_fma_f32 v[174:175], v[12:13], v[62:63], v[174:175] op_sel_hi:[0,1,1]
  v_pk_mul_f32 v[72:73], v[12:13], v[168:169] op_sel:[1,0] op_sel_hi:[1,1]
  v_pk_mul_f32 v[74:75], v[12:13], v[170:171] op_sel:[1,0] op_sel_hi:[1,1]
  v_pk_mul_f32 v[172:173], v[168:169], v[172:173]
  v_pk_mul_f32 v[174:175], v[170:171], v[174:175]
  v_pk_add_f32 v[68:69], v[4:5], v[68:69] op_sel_hi:[0,1]
  v_pk_add_f32 v[70:71], v[4:5], v[70:71] op_sel_hi:[0,1]
  v_pk_mul_f32 v[156:157], v[156:157], v[76:77]
  v_pk_mul_f32 v[158:159], v[158:159], v[78:79]
  v_mfma_f32_16x16x32_bf16 a[24:27], v[28:31], a[192:195], a[24:27]
  ds_read_b64_tr_b16 v[24:25], v1 offset:22592
  v_cvt_pk_bf16_f32 v124, v156, v157
  v_mfma_f32_16x16x32_bf16 a[28:31], v[28:31], a[196:199], a[28:31]
  ds_read_b64_tr_b16 v[26:27], v1 offset:23104
  s_waitcnt lgkmcnt(6)
  v_mfma_f32_16x16x32_bf16 a[0:3], v[32:35], a[200:203], a[0:3]
  ds_read_b64_tr_b16 v[28:29], v1 offset:22624
  s_add_u32 s72, s69, s37
  v_mfma_f32_16x16x32_bf16 a[4:7], v[32:35], a[204:207], a[4:7]
  ds_read_b64_tr_b16 v[30:31], v1 offset:23136
  v_cvt_pk_bf16_f32 v125, v158, v159
  v_exp_f32 v72, v72
  v_exp_f32 v73, v73
  v_exp_f32 v74, v74
  v_exp_f32 v75, v75
  v_mfma_f32_16x16x32_bf16 a[8:11], v[36:39], a[200:203], a[8:11]
  ds_read_b64_tr_b16 v[32:33], v1 offset:23552
  s_add_u32 m0, s64, 11264
  v_rcp_f32 v68, v68
  v_rcp_f32 v69, v69
  v_rcp_f32 v70, v70
  v_rcp_f32 v71, v71
  v_pk_add_f32 v[72:73], v[4:5], v[72:73] op_sel_hi:[0,1]
  v_pk_add_f32 v[74:75], v[4:5], v[74:75] op_sel_hi:[0,1]
  v_pk_mul_f32 v[164:165], v[164:165], v[68:69]
  v_pk_mul_f32 v[166:167], v[166:167], v[70:71]
  v_mfma_f32_16x16x32_bf16 a[12:15], v[36:39], a[204:207], a[12:15]
  ds_read_b64_tr_b16 v[34:35], v1 offset:24064
  v_cvt_pk_bf16_f32 v122, v164, v165
  v_mfma_f32_16x16x32_bf16 a[16:19], v[40:43], a[200:203], a[16:19]
  ds_read_b64_tr_b16 v[36:37], v1 offset:23584
  v_cvt_pk_bf16_f32 v123, v166, v167
  buffer_store_dwordx4 v[120:123], v8, s[48:51], s82 offen offset:2048 sc1
  v_rcp_f32 v72, v72
  v_rcp_f32 v73, v73
  v_rcp_f32 v74, v74
  v_rcp_f32 v75, v75
  s_nop 0
  v_pk_mul_f32 v[172:173], v[172:173], v[72:73]
  v_pk_mul_f32 v[174:175], v[174:175], v[74:75]
  v_mfma_f32_16x16x32_bf16 a[20:23], v[40:43], a[204:207], a[20:23]
  buffer_load_dwordx4 v5, s[32:35], s72 offen offset:0 lds
  v_cvt_pk_bf16_f32 v126, v172, v173
  v_cvt_pk_bf16_f32 v127, v174, v175
  buffer_store_dwordx4 v[124:127], v8, s[48:51], s82 offen offset:3072 sc1
  v_mfma_f32_16x16x32_bf16 a[24:27], v[44:47], a[200:203], a[24:27]
  ds_read_b64_tr_b16 v[38:39], v1 offset:24096
  ds_read_b64_tr_b16 v[40:41], v1 offset:23616
  v_mfma_f32_16x16x32_bf16 a[28:31], v[44:47], a[204:207], a[28:31]
  ds_read_b64_tr_b16 v[42:43], v1 offset:24128
  s_waitcnt lgkmcnt(6)
  v_mfma_f32_16x16x32_bf16 a[0:3], v[16:19], a[208:211], a[0:3]
  ds_read_b64_tr_b16 v[44:45], v1 offset:23648
  s_load_dwordx2 s[28:29], s[0:1], 80
  v_mfma_f32_16x16x32_bf16 a[4:7], v[16:19], a[212:215], a[4:7]
  ds_read_b64_tr_b16 v[46:47], v1 offset:24160
  v_lshrrev_b32 v64, 4, v8
  v_mfma_f32_16x16x32_bf16 a[8:11], v[20:23], a[208:211], a[8:11]
  s_barrier
ffn_hop69:
  s_cbranch_execz ffn_hop70
  ds_read_b64_tr_b16 v[16:17], v1 offset:24576
  v_mfma_f32_16x16x32_bf16 a[12:15], v[20:23], a[212:215], a[12:15]
  ds_read_b64_tr_b16 v[18:19], v1 offset:25088
  s_add_u32 s72, s67, 221184
  v_mfma_f32_16x16x32_bf16 a[16:19], v[24:27], a[208:211], a[16:19]
  s_waitcnt vmcnt(8)
  v_readfirstlane_b32 s77, v184
  v_mfma_f32_16x16x32_bf16 a[20:23], v[24:27], a[212:215], a[20:23]
  ds_read_b64_tr_b16 v[20:21], v1 offset:24608
  ds_read_b64_tr_b16 v[22:23], v1 offset:25120
  v_mfma_f32_16x16x32_bf16 a[24:27], v[28:31], a[208:211], a[24:27]
  ds_read_b64_tr_b16 v[24:25], v1 offset:24640
  v_and_b32 v204, 7, v64
  v_mfma_f32_16x16x32_bf16 a[28:31], v[28:31], a[212:215], a[28:31]
  ds_read_b64_tr_b16 v[26:27], v1 offset:25152
  s_and_b32 s3, s2, 0xf8
  s_waitcnt lgkmcnt(0)
  v_mfma_f32_16x16x32_bf16 a[0:3], v[32:35], a[216:219], a[0:3]
  ds_read_b64_tr_b16 v[28:29], v1 offset:24672
  v_or_b32 v204, s3, v204
  v_mfma_f32_16x16x32_bf16 a[4:7], v[32:35], a[220:223], a[4:7]
  ds_read_b64_tr_b16 v[30:31], v1 offset:25184
  s_add_u32 s72, s72, s37
  v_mfma_f32_16x16x32_bf16 a[8:11], v[36:39], a[216:219], a[8:11]
  s_cmp_lg_u32 s77, 0
  s_cbranch_scc0 ffn_slow1
ffn_back1:
  v_mfma_f32_16x16x32_bf16 a[12:15], v[36:39], a[220:223], a[12:15]
  ds_read_b64_tr_b16 v[32:33], v1 offset:25600
  ds_read_b64_tr_b16 v[34:35], v1 offset:26112
  v_mfma_f32_16x16x32_bf16 a[16:19], v[40:43], a[216:219], a[16:19]
  buffer_load_dwordx4 a[232:235], v8, s[52:55], s81 offen offset:0 sc1 nt
  v_mfma_f32_16x16x32_bf16 a[20:23], v[40:43], a[220:223], a[20:23]
  ds_read_b64_tr_b16 v[36:37], v1 offset:25632
  ds_read_b64_tr_b16 v[38:39], v1 offset:26144
  v_mfma_f32_16x16x32_bf16 a[24:27], v[44:47], a[216:219], a[24:27]
  ds_read_b64_tr_b16 v[40:41], v1 offset:25664
  v_lshl_add_u32 v204, v204, 2, s16
  v_mfma_f32_16x16x32_bf16 a[28:31], v[44:47], a[220:223], a[28:31]
  ds_read_b64_tr_b16 v[42:43], v1 offset:26176
  v_lshlrev_b32 v204, 6, v204
  s_waitcnt lgkmcnt(6)
  v_mfma_f32_16x16x32_bf16 a[32:35], v[16:19], v[80:83], 0
  ds_read_b64_tr_b16 v[44:45], v1 offset:25696
  s_add_u32 m0, s64, 12288
  v_mfma_f32_16x16x32_bf16 a[36:39], v[16:19], v[84:87], 0
  buffer_load_dwordx4 a[236:239], v8, s[52:55], s81 offen offset:1024 sc1 nt
  v_mfma_f32_16x16x32_bf16 a[40:43], v[20:23], v[80:83], 0
  ds_read_b64_tr_b16 v[46:47], v1 offset:26208
  ds_read_b64_tr_b16 v[16:17], v1 offset:26624
  v_mfma_f32_16x16x32_bf16 a[44:47], v[20:23], v[84:87], 0
  buffer_load_dwordx4 a[240:243], v8, s[52:55], s81 offen offset:2048 sc1 nt
  v_mfma_f32_16x16x32_bf16 a[48:51], v[24:27], v[80:83], 0
  ds_read_b64_tr_b16 v[18:19], v1 offset:27136
  ds_read_b64_tr_b16 v[20:21], v1 offset:26656
  v_mfma_f32_16x16x32_bf16 a[52:55], v[24:27], v[84:87], 0
  buffer_load_dwordx4 v5, s[32:35], s72 offen offset:0 lds
  v_mfma_f32_16x16x32_bf16 a[56:59], v[28:31], v[80:83], 0
  ds_read_b64_tr_b16 v[22:23], v1 offset:27168
  ds_read_b64_tr_b16 v[24:25], v1 offset:26688
  v_mfma_f32_16x16x32_bf16 a[60:63], v[28:31], v[84:87], 0
  ds_read_b64_tr_b16 v[26:27], v1 offset:27200
  v_cmp_le_u32 vcc, 8, v64
  v_bfrev_b32 v65, 1
  s_lshr_b32 s3, s18, 1
  v_cndmask_b32 v204, v204, v65, vcc
  s_waitcnt lgkmcnt(6)
  v_mfma_f32_16x16x32_bf16 a[32:35], v[32:35], v[88:91], a[32:35]
  buffer_load_dwordx4 a[244:247], v8, s[52:55], s81 offen offset:3072 sc1 nt
  v_mfma_f32_16x16x32_bf16 a[36:39], v[32:35], v[92:95], a[36:39]
  ds_read_b64_tr_b16 v[28:29], v1 offset:26720
  ds_read_b64_tr_b16 v[30:31], v1 offset:27232
ffn_hop70:
  s_cbranch_execz ffn_hop71
  v_mfma_f32_16x16x32_bf16 a[40:43], v[36:39], v[88:91], a[40:43]
  ds_read_b64_tr_b16 v[32:33], v1 offset:27648
  s_xor_b32 s4, s3, 1
  v_mfma_f32_16x16x32_bf16 a[44:47], v[36:39], v[92:95], a[44:47]
  buffer_load_dwordx4 v6, s[32:35], s72 offen offset:1024 lds
  v_mfma_f32_16x16x32_bf16 a[48:51], v[40:43], v[88:91], a[48:51]
  ds_read_b64_tr_b16 v[34:35], v1 offset:28160
  ds_read_b64_tr_b16 v[36:37], v1 offset:27680
  v_mfma_f32_16x16x32_bf16 a[52:55], v[40:43], v[92:95], a[52:55]
  buffer_load_dwordx4 a[224:227], v8, s[52:55], s83 offen offset:0 sc1 nt
  v_mfma_f32_16x16x32_bf16 a[56:59], v[44:47], v[88:91], a[56:59]
  ds_read_b64_tr_b16 v[38:39], v1 offset:28192
  ds_read_b64_tr_b16 v[40:41], v1 offset:27712
  v_mfma_f32_16x16x32_bf16 a[60:63], v[44:47], v[92:95], a[60:63]
  ds_read_b64_tr_b16 v[42:43], v1 offset:28224
  s_waitcnt lgkmcnt(6)
  v_mfma_f32_16x16x32_bf16 a[32:35], v[16:19], v[96:99], a[32:35]
  ds_read_b64_tr_b16 v[44:45], v1 offset:27744
  s_lshl_b32 s4, s4, 1
  v_mfma_f32_16x16x32_bf16 a[36:39], v[16:19], v[100:103], a[36:39]
  ds_read_b64_tr_b16 v[46:47], v1 offset:28256
  s_add_u32 s72, s66, 0
  v_mfma_f32_16x16x32_bf16 a[40:43], v[20:23], v[96:99], a[40:43]
  buffer_load_dwordx4 a[228:231], v8, s[52:55], s83 offen offset:1024 sc1 nt
  v_mfma_f32_16x16x32_bf16 a[44:47], v[20:23], v[100:103], a[44:47]
  ds_read_b64_tr_b16 v[16:17], v1 offset:28672
  ds_read_b64_tr_b16 v[18:19], v1 offset:29184
  v_mfma_f32_16x16x32_bf16 a[48:51], v[24:27], v[96:99], a[48:51]
  ds_read_b64_tr_b16 v[20:21], v1 offset:28704
  s_lshl_b32 s4, 3, s4
  v_mfma_f32_16x16x32_bf16 a[52:55], v[24:27], v[100:103], a[52:55]
  s_waitcnt vmcnt(8)
  buffer_store_dword v5, off, s[60:63], s84 offset:8 sc1
  v_mfma_f32_16x16x32_bf16 a[56:59], v[28:31], v[96:99], a[56:59]
  ds_read_b64_tr_b16 v[22:23], v1 offset:29216
  ds_read_b64_tr_b16 v[24:25], v1 offset:28736
  v_mfma_f32_16x16x32_bf16 a[60:63], v[28:31], v[100:103], a[60:63]
  ds_read_b64_tr_b16 v[26:27], v1 offset:29248
  s_waitcnt lgkmcnt(6)
  v_mfma_f32_16x16x32_bf16 a[32:35], v[32:35], v[104:107], a[32:35]
  ds_read_b64_tr_b16 v[28:29], v1 offset:28768
  s_add_u32 s72, s72, s38
  v_mfma_f32_16x16x32_bf16 a[36:39], v[32:35], v[108:111], a[36:39]
  ds_read_b64_tr_b16 v[30:31], v1 offset:29280
  s_xor_b32 s5, s3, 2
  v_mfma_f32_16x16x32_bf16 a[40:43], v[36:39], v[104:107], a[40:43]
  ds_read_b64_tr_b16 v[32:33], v1 offset:29696
  s_lshl_b32 s5, s5, 1
  v_mfma_f32_16x16x32_bf16 a[44:47], v[36:39], v[108:111], a[44:47]
  ds_read_b64_tr_b16 v[34:35], v1 offset:30208
  s_lshl_b32 s5, 3, s5
  v_mfma_f32_16x16x32_bf16 a[48:51], v[40:43], v[104:107], a[48:51]
  ds_read_b64_tr_b16 v[36:37], v1 offset:29728
  s_xor_b32 s8, s3, 3
  v_mfma_f32_16x16x32_bf16 a[52:55], v[40:43], v[108:111], a[52:55]
  ds_read_b64_tr_b16 v[38:39], v1 offset:30240
  s_add_u32 m0, s64, 14336
  v_mfma_f32_16x16x32_bf16 a[56:59], v[44:47], v[104:107], a[56:59]
  ds_read_b64_tr_b16 v[40:41], v1 offset:29760
  s_lshl_b32 s8, s8, 1
  v_mfma_f32_16x16x32_bf16 a[60:63], v[44:47], v[108:111], a[60:63]
  ds_read_b64_tr_b16 v[42:43], v1 offset:30272
  s_waitcnt lgkmcnt(6)
  v_mfma_f32_16x16x32_bf16 a[0:3], v[16:19], v[216:219], a[0:3]
  ds_read_b64_tr_b16 v[44:45], v1 offset:29792
  s_lshl_b32 s8, 3, s8
  v_mfma_f32_16x16x32_bf16 a[4:7], v[16:19], v[220:223], a[4:7]
  ds_read_b64_tr_b16 v[46:47], v1 offset:30304
  s_mov_b32 s9, 0xff
  v_mfma_f32_16x16x32_bf16 a[8:11], v[20:23], v[216:219], a[8:11]
  ds_read_b64_tr_b16 v[16:17], v1 offset:30720
ffn_hop71:
  s_cbranch_execz ffn_hopret
  s_xor_b32 s3, s18, 1
  v_mfma_f32_16x16x32_bf16 a[12:15], v[20:23], v[220:223], a[12:15]
  buffer_load_dwordx4 v5, s[32:35], s72 offen offset:0 lds
  v_mfma_f32_16x16x32_bf16 a[16:19], v[24:27], v[216:219], a[16:19]
  ds_read_b64_tr_b16 v[18:19], v1 offset:31232
  ds_read_b64_tr_b16 v[20:21], v1 offset:30752
  v_mfma_f32_16x16x32_bf16 a[20:23], v[24:27], v[220:223], a[20:23]
  ds_read_b64_tr_b16 v[22:23], v1 offset:31264
  s_lshl_b32 s13, 1, s3
  v_mfma_f32_16x16x32_bf16 a[24:27], v[28:31], v[216:219], a[24:27]
  ds_read_b64_tr_b16 v[24:25], v1 offset:30784
  s_lshl_b32 s3, s19, 2
  v_mfma_f32_16x16x32_bf16 a[28:31], v[28:31], v[220:223], a[28:31]
  ds_read_b64_tr_b16 v[26:27], v1 offset:31296
  s_waitcnt lgkmcnt(6)
  v_mfma_f32_16x16x32_bf16 a[0:3], v[32:35], v[224:227], a[0:3]
  ds_read_b64_tr_b16 v[28:29], v1 offset:30816
  s_add_u32 s3, s3, s16
  v_mfma_f32_16x16x32_bf16 a[4:7], v[32:35], v[228:231], a[4:7]
  buffer_load_dwordx4 v6, s[32:35], s72 offen offset:1024 lds
  s_lshl_b32 s3, s3, 5
  v_mfma_f32_16x16x32_bf16 a[8:11], v[36:39], v[224:227], a[8:11]
  ds_read_b64_tr_b16 v[30:31], v1 offset:31328
  ds_read_b64_tr_b16 v[32:33], v1 offset:31744
  v_mfma_f32_16x16x32_bf16 a[12:15], v[36:39], v[228:231], a[12:15]
  ds_read_b64_tr_b16 v[34:35], v1 offset:32256
  v_and_b32 v65, 15, v64
  v_mfma_f32_16x16x32_bf16 a[16:19], v[40:43], v[224:227], a[16:19]
  ds_read_b64_tr_b16 v[36:37], v1 offset:31776
  v_lshl_add_u32 v65, v65, 1, s3
  v_mfma_f32_16x16x32_bf16 a[20:23], v[40:43], v[228:231], a[20:23]
  ds_read_b64_tr_b16 v[38:39], v1 offset:32288
  v_lshrrev_b32 v64, 4, v64
  v_mfma_f32_16x16x32_bf16 a[24:27], v[44:47], v[224:227], a[24:27]
  ds_read_b64_tr_b16 v[40:41], v1 offset:31808
  v_lshlrev_b32 v205, 14, v64
  v_mfma_f32_16x16x32_bf16 a[28:31], v[44:47], v[228:231], a[28:31]
  ds_read_b64_tr_b16 v[42:43], v1 offset:32320
  s_waitcnt lgkmcnt(6)
  v_mfma_f32_16x16x32_bf16 a[32:35], v[16:19], a[192:195], a[32:35]
  ds_read_b64_tr_b16 v[44:45], v1 offset:31840
  v_lshl_add_u32 v205, v65, 3, v205
  v_mfma_f32_16x16x32_bf16 a[36:39], v[16:19], a[196:199], a[36:39]
  ds_read_b64_tr_b16 v[46:47], v1 offset:32352
  v_mul_u32_u24 v206, 1152, v65
  v_and_b32 v65, 1, v64
  v_mfma_f32_16x16x32_bf16 a[40:43], v[20:23], a[192:195], a[40:43]
  s_barrier
  ds_read_b64_tr_b16 v[16:17], v1 offset:32768
  v_mfma_f32_16x16x32_bf16 a[44:47], v[20:23], a[196:199], a[44:47]
  ds_read_b64_tr_b16 v[18:19], v1 offset:33280
  s_add_u32 s72, s66, 73728
  v_mfma_f32_16x16x32_bf16 a[48:51], v[24:27], a[192:195], a[48:51]
  ds_read_b64_tr_b16 v[20:21], v1 offset:32800
  v_lshl_add_u32 v206, v65, 5, v206
  v_mfma_f32_16x16x32_bf16 a[52:55], v[24:27], a[196:199], a[52:55]
  ds_read_b64_tr_b16 v[22:23], v1 offset:33312
  v_lshrrev_b32 v64, 1, v64
  v_mfma_f32_16x16x32_bf16 a[56:59], v[28:31], a[192:195], a[56:59]
  ds_read_b64_tr_b16 v[24:25], v1 offset:32832
  s_add_u32 s72, s72, s38
  v_mfma_f32_16x16x32_bf16 a[60:63], v[28:31], a[196:199], a[60:63]
  ds_read_b64_tr_b16 v[26:27], v1 offset:33344
  s_waitcnt lgkmcnt(6)
  v_mfma_f32_16x16x32_bf16 a[32:35], v[32:35], a[200:203], a[32:35]
  ds_read_b64_tr_b16 v[28:29], v1 offset:32864
  v_lshl_add_u32 v206, v64, 4, v206
  v_mfma_f32_16x16x32_bf16 a[36:39], v[32:35], a[204:207], a[36:39]
  ds_read_b64_tr_b16 v[30:31], v1 offset:33376
  s_add_u32 m0, s64, 16384
  s_mov_b32 s30, 2359296
ffn_hopq3:
ffn_hop72:
  s_cbranch_execz ffn_hop73
  v_mfma_f32_16x16x32_bf16 a[40:43], v[36:39], a[200:203], a[40:43]
  ds_read_b64_tr_b16 v[32:33], v1 offset:33792
  s_mov_b32 s31, 0x20000
  v_mfma_f32_16x16x32_bf16 a[44:47], v[36:39], a[204:207], a[44:47]
  ds_read_b64_tr_b16 v[34:35], v1 offset:34304
  s_lshr_b32 s3, s2, 3
  v_mfma_f32_16x16x32_bf16 a[48:51], v[40:43], a[200:203], a[48:51]
  buffer_load_dwordx4 v5, s[32:35], s72 offen offset:0 lds
  v_mfma_f32_16x16x32_bf16 a[52:55], v[40:43], a[204:207], a[52:55]
  ds_read_b64_tr_b16 v[36:37], v1 offset:33824
  ds_read_b64_tr_b16 v[38:39], v1 offset:34336
  v_mfma_f32_16x16x32_bf16 a[56:59], v[44:47], a[200:203], a[56:59]
  ds_read_b64_tr_b16 v[40:41], v1 offset:33856
  buffer_load_dword v184, off, s[60:63], s85 offset:8 sc1
  v_mfma_f32_16x16x32_bf16 a[60:63], v[44:47], a[204:207], a[60:63]
  ds_read_b64_tr_b16 v[42:43], v1 offset:34368
  s_waitcnt lgkmcnt(6)
  v_mfma_f32_16x16x32_bf16 a[0:3], v[16:19], v[112:115], a[0:3]
  buffer_load_dwordx4 v6, s[32:35], s72 offen offset:1024 lds
  v_mfma_f32_16x16x32_bf16 a[4:7], v[16:19], v[116:119], a[4:7]
  ds_read_b64_tr_b16 v[44:45], v1 offset:33888
  ds_read_b64_tr_b16 v[46:47], v1 offset:34400
  s_lshl_b32 s3, s3, 2
  v_mfma_f32_16x16x32_bf16 a[8:11], v[20:23], v[112:115], a[8:11]
  ds_read_b64_tr_b16 v[16:17], v1 offset:34816
  s_add_u32 s72, s67, 0
  v_mfma_f32_16x16x32_bf16 a[12:15], v[20:23], v[116:119], a[12:15]
  ds_read_b64_tr_b16 v[18:19], v1 offset:35328
  s_add_u32 s3, s3, s16
  v_mfma_f32_16x16x32_bf16 a[16:19], v[24:27], v[112:115], a[16:19]
  ds_read_b64_tr_b16 v[20:21], v1 offset:34848
  s_mul_i32 s3, s3, 18432
  v_mfma_f32_16x16x32_bf16 a[20:23], v[24:27], v[116:119], a[20:23]
  ds_read_b64_tr_b16 v[22:23], v1 offset:35360
  s_add_u32 s72, s72, s38
  v_mfma_f32_16x16x32_bf16 a[24:27], v[28:31], v[112:115], a[24:27]
  ds_read_b64_tr_b16 v[24:25], v1 offset:34880
  s_add_u32 s3, s3, 16777216
  v_mfma_f32_16x16x32_bf16 a[28:31], v[28:31], v[116:119], a[28:31]
  ds_read_b64_tr_b16 v[26:27], v1 offset:35392
  s_waitcnt lgkmcnt(6)
  v_mfma_f32_16x16x32_bf16 a[0:3], v[32:35], v[120:123], a[0:3]
  ds_read_b64_tr_b16 v[28:29], v1 offset:34912
  s_add_u32 m0, s64, 18432
  s_add_u32 s24, s14, s3
  s_addc_u32 s25, s15, 0
  v_mfma_f32_16x16x32_bf16 a[4:7], v[32:35], v[124:127], a[4:7]
  ds_read_b64_tr_b16 v[30:31], v1 offset:35424
  s_mov_b32 s26, 16533504
  v_mfma_f32_16x16x32_bf16 a[8:11], v[36:39], v[120:123], a[8:11]
  ds_read_b64_tr_b16 v[32:33], v1 offset:35840
  s_mov_b32 s27, 0x20000
  v_mfma_f32_16x16x32_bf16 a[12:15], v[36:39], v[124:127], a[12:15]
  buffer_load_dwordx4 v5, s[32:35], s72 offen offset:0 lds
  v_mfma_f32_16x16x32_bf16 a[16:19], v[40:43], v[120:123], a[16:19]
  ds_read_b64_tr_b16 v[34:35], v1 offset:36352
  ds_read_b64_tr_b16 v[36:37], v1 offset:35872
  v_mfma_f32_16x16x32_bf16 a[20:23], v[40:43], v[124:127], a[20:23]
  ds_read_b64_tr_b16 v[38:39], v1 offset:36384
  s_xor_b32 s20, s18, 0
  v_mfma_f32_16x16x32_bf16 a[24:27], v[44:47], v[120:123], a[24:27]
  ds_read_b64_tr_b16 v[40:41], v1 offset:35904
  s_mul_i32 s20, s20, 2359296
  v_mfma_f32_16x16x32_bf16 a[28:31], v[44:47], v[124:127], a[28:31]
  ds_read_b64_tr_b16 v[42:43], v1 offset:36416
  s_waitcnt lgkmcnt(6)
  s_waitcnt vmcnt(14)
  v_mfma_f32_16x16x32_bf16 a[0:3], v[16:19], a[232:235], a[0:3]
  buffer_load_dwordx4 v6, s[32:35], s72 offen offset:1024 lds
  s_waitcnt vmcnt(14)
ffn_hop73:
  s_cbranch_execz ffn_hop74
  v_mfma_f32_16x16x32_bf16 a[4:7], v[16:19], a[236:239], a[4:7]
  ds_read_b64_tr_b16 v[44:45], v1 offset:35936
  ds_read_b64_tr_b16 v[46:47], v1 offset:36448
  v_mfma_f32_16x16x32_bf16 a[8:11], v[20:23], a[232:235], a[8:11]
  ds_read_b64_tr_b16 v[16:17], v1 offset:36864
  s_add_u32 s72, s67, 73728
  v_mfma_f32_16x16x32_bf16 a[12:15], v[20:23], a[236:239], a[12:15]
  ds_read_b64_tr_b16 v[18:19], v1 offset:37376
  s_xor_b32 s21, s18, 1
  v_mfma_f32_16x16x32_bf16 a[16:19], v[24:27], a[232:235], a[16:19]
  ds_read_b64_tr_b16 v[20:21], v1 offset:36896
  s_add_u32 s72, s72, s38
  v_mfma_f32_16x16x32_bf16 a[20:23], v[24:27], a[236:239], a[20:23]
  ds_read_b64_tr_b16 v[22:23], v1 offset:37408
  s_mul_i32 s21, s21, 2359296
  v_mfma_f32_16x16x32_bf16 a[24:27], v[28:31], a[232:235], a[24:27]
  ds_read_b64_tr_b16 v[24:25], v1 offset:36928
  s_xor_b32 s22, s18, 2
  v_mfma_f32_16x16x32_bf16 a[28:31], v[28:31], a[236:239], a[28:31]
  ds_read_b64_tr_b16 v[26:27], v1 offset:37440
  s_waitcnt lgkmcnt(6)
  s_waitcnt vmcnt(13)
  v_mfma_f32_16x16x32_bf16 a[0:3], v[32:35], a[240:243], a[0:3]
  ds_read_b64_tr_b16 v[28:29], v1 offset:36960
  s_add_u32 m0, s64, 20480
  s_waitcnt vmcnt(11)
  v_mfma_f32_16x16x32_bf16 a[4:7], v[32:35], a[244:247], a[4:7]
  ds_read_b64_tr_b16 v[30:31], v1 offset:37472
  s_mul_i32 s22, s22, 2359296
  s_xor_b32 s23, s18, 3
  v_mfma_f32_16x16x32_bf16 a[8:11], v[36:39], a[240:243], a[8:11]
  buffer_load_dwordx4 v5, s[32:35], s72 offen offset:0 lds
  v_mfma_f32_16x16x32_bf16 a[12:15], v[36:39], a[244:247], a[12:15]
  ds_read_b64_tr_b16 v[32:33], v1 offset:37888
  ds_read_b64_tr_b16 v[34:35], v1 offset:38400
  v_mfma_f32_16x16x32_bf16 a[16:19], v[40:43], a[240:243], a[16:19]
  ds_read_b64_tr_b16 v[36:37], v1 offset:37920
  s_mul_i32 s23, s23, 2359296
  v_mfma_f32_16x16x32_bf16 a[20:23], v[40:43], a[244:247], a[20:23]
  buffer_load_dwordx4 v6, s[32:35], s72 offen offset:1024 lds
  v_mfma_f32_16x16x32_bf16 a[24:27], v[44:47], a[240:243], a[24:27]
  ds_read_b64_tr_b16 v[38:39], v1 offset:38432
  ds_read_b64_tr_b16 v[40:41], v1 offset:37952
  v_mfma_f32_16x16x32_bf16 a[28:31], v[44:47], a[244:247], a[28:31]
  ds_read_b64_tr_b16 v[42:43], v1 offset:38464
  s_waitcnt lgkmcnt(6)
  v_mfma_f32_16x16x32_bf16 a[0:3], v[16:19], v[208:211], a[0:3]
  ds_read_b64_tr_b16 v[44:45], v1 offset:37984
  s_add_u32 s72, s66, 147456
  v_mfma_f32_16x16x32_bf16 a[4:7], v[16:19], v[212:215], a[4:7]
  s_xor_b32 s44, s18, 4
  s_waitcnt vmcnt(5)
  v_readfirstlane_b32 s77, v184
  v_mfma_f32_16x16x32_bf16 a[8:11], v[20:23], v[208:211], a[8:11]
  ds_read_b64_tr_b16 v[46:47], v1 offset:38496
  ds_read_b64_tr_b16 v[16:17], v1 offset:0
  v_mfma_f32_16x16x32_bf16 a[12:15], v[20:23], v[212:215], a[12:15]
  ds_read_b64_tr_b16 v[18:19], v1 offset:512
  s_add_u32 s72, s72, s38
  v_mfma_f32_16x16x32_bf16 a[16:19], v[24:27], v[208:211], a[16:19]
  s_cmp_lg_u32 s77, 0
  s_cbranch_scc0 ffn_slow2
ffn_back2:
  v_mfma_f32_16x16x32_bf16 a[20:23], v[24:27], v[212:215], a[20:23]
  ds_read_b64_tr_b16 v[20:21], v1 offset:32
  ds_read_b64_tr_b16 v[22:23], v1 offset:544
  v_mfma_f32_16x16x32_bf16 a[24:27], v[28:31], v[208:211], a[24:27]
  ds_read_b64_tr_b16 v[24:25], v1 offset:64
  s_add_u32 m0, s64, 22528
  v_mfma_f32_16x16x32_bf16 a[28:31], v[28:31], v[212:215], a[28:31]
  ds_read_b64_tr_b16 v[26:27], v1 offset:576
  s_waitcnt lgkmcnt(6)
ffn_hop74:
  s_cbranch_execz ffn_hop75
  v_mfma_f32_16x16x32_bf16 a[0:3], v[32:35], a[224:227], a[0:3]
  ds_read_b64_tr_b16 v[28:29], v1 offset:96
  buffer_load_dwordx4 a[248:251], v8, s[52:55], s82 offen offset:0 sc1 nt
  v_mfma_f32_16x16x32_bf16 a[4:7], v[32:35], a[228:231], a[4:7]
  buffer_load_dwordx4 v5, s[32:35], s72 offen offset:0 lds
  s_mul_i32 s44, s44, 2359296
  v_mfma_f32_16x16x32_bf16 a[8:11], v[36:39], a[224:227], a[8:11]
  ds_read_b64_tr_b16 v[30:31], v1 offset:608
  ds_read_b64_tr_b16 v[32:33], v1 offset:1024
  v_mfma_f32_16x16x32_bf16 a[12:15], v[36:39], a[228:231], a[12:15]
  ds_read_b64_tr_b16 v[34:35], v1 offset:1536
  buffer_load_dwordx4 a[252:255], v8, s[52:55], s82 offen offset:1024 sc1 nt
  v_mfma_f32_16x16x32_bf16 a[16:19], v[40:43], a[224:227], a[16:19]
  buffer_load_dwordx4 v6, s[32:35], s72 offen offset:1024 lds
  v_mfma_f32_16x16x32_bf16 a[20:23], v[40:43], a[228:231], a[20:23]
  ds_read_b64_tr_b16 v[36:37], v1 offset:1056
  ds_read_b64_tr_b16 v[38:39], v1 offset:1568
  v_mfma_f32_16x16x32_bf16 a[24:27], v[44:47], a[224:227], a[24:27]
  ds_read_b64_tr_b16 v[40:41], v1 offset:1088
  s_xor_b32 s45, s18, 5
  v_mfma_f32_16x16x32_bf16 a[28:31], v[44:47], a[228:231], a[28:31]
  ds_read_b64_tr_b16 v[42:43], v1 offset:1600
  s_waitcnt lgkmcnt(6)
  v_mfma_f32_16x16x32_bf16 a[32:35], v[16:19], a[208:211], a[32:35]
  buffer_load_dwordx4 v[176:179], v8, s[52:55], s82 offen offset:2048 sc1 nt
  v_mfma_f32_16x16x32_bf16 a[36:39], v[16:19], a[212:215], a[36:39]
  ds_read_b64_tr_b16 v[44:45], v1 offset:1120
  ds_read_b64_tr_b16 v[46:47], v1 offset:1632
  s_mul_i32 s45, s45, 2359296
  v_mfma_f32_16x16x32_bf16 a[40:43], v[20:23], a[208:211], a[40:43]
  s_barrier
  ds_read_b64_tr_b16 v[16:17], v1 offset:2048
  v_mfma_f32_16x16x32_bf16 a[44:47], v[20:23], a[212:215], a[44:47]
  ds_read_b64_tr_b16 v[18:19], v1 offset:2560
  s_add_u32 s72, s66, 221184
  v_mfma_f32_16x16x32_bf16 a[48:51], v[24:27], a[208:211], a[48:51]
  ds_read_b64_tr_b16 v[20:21], v1 offset:2080
  buffer_load_dwordx4 v[180:183], v8, s[52:55], s82 offen offset:3072 sc1 nt
  v_mfma_f32_16x16x32_bf16 a[52:55], v[24:27], a[212:215], a[52:55]
  ds_read_b64_tr_b16 v[22:23], v1 offset:2592
  s_add_u32 s72, s72, s38
  v_mfma_f32_16x16x32_bf16 a[56:59], v[28:31], a[208:211], a[56:59]
  ds_read_b64_tr_b16 v[24:25], v1 offset:3072
  s_xor_b32 s46, s18, 6
  v_mfma_f32_16x16x32_bf16 a[60:63], v[28:31], a[212:215], a[60:63]
  ds_read_b64_tr_b16 v[26:27], v1 offset:3584
  s_waitcnt lgkmcnt(6)
  v_mfma_f32_16x16x32_bf16 a[32:35], v[32:35], a[216:219], a[32:35]
  ds_read_b64_tr_b16 v[28:29], v1 offset:3104
  s_add_u32 m0, s64, 24576
  s_mul_i32 s46, s46, 2359296
  v_mfma_f32_16x16x32_bf16 a[36:39], v[32:35], a[220:223], a[36:39]
  ds_read_b64_tr_b16 v[30:31], v1 offset:3616
  s_xor_b32 s79, s18, 7
  v_mfma_f32_16x16x32_bf16 a[40:43], v[36:39], a[216:219], a[40:43]
  ds_read_b64_tr_b16 v[32:33], v1 offset:2112
  s_mul_i32 s79, s79, 2359296
  v_mfma_f32_16x16x32_bf16 a[44:47], v[36:39], a[220:223], a[44:47]
  buffer_load_dwordx4 v5, s[32:35], s72 offen offset:0 lds
  v_mfma_f32_16x16x32_bf16 a[48:51], v[40:43], a[216:219], a[48:51]
  ds_read_b64_tr_b16 v[34:35], v1 offset:2624
  ds_read_b64_tr_b16 v[36:37], v1 offset:2144
  v_mfma_f32_16x16x32_bf16 a[52:55], v[40:43], a[220:223], a[52:55]
  ds_read_b64_tr_b16 v[38:39], v1 offset:2656
  s_lshl_b32 s3, s18, 11
  v_mfma_f32_16x16x32_bf16 a[56:59], v[44:47], a[216:219], a[56:59]
  ds_read_b64_tr_b16 v[40:41], v1 offset:3136
  v_add_u32 v207, s3, v8
ffn_hop75:
  s_cbranch_execz ffn_hop76
  v_mfma_f32_16x16x32_bf16 a[60:63], v[44:47], a[220:223], a[60:63]
  ds_read_b64_tr_b16 v[42:43], v1 offset:3648
  s_waitcnt lgkmcnt(6)
  s_waitcnt vmcnt(6)
  v_mfma_f32_16x16x32_bf16 a[0:3], v[16:19], a[248:251], a[0:3]
  buffer_load_dwordx4 v6, s[32:35], s72 offen offset:1024 lds
  s_lshl_b32 s74, s18, 5
  s_waitcnt vmcnt(5)
  v_mfma_f32_16x16x32_bf16 a[4:7], v[16:19], a[252:255], a[4:7]
  ds_read_b64_tr_b16 v[44:45], v1 offset:3168
  ds_read_b64_tr_b16 v[46:47], v1 offset:3680
  v_mfma_f32_16x16x32_bf16 a[8:11], v[20:23], a[248:251], a[8:11]
  ds_read_b64_tr_b16 v[16:17], v1 offset:4096
  s_add_u32 s72, s67, 147456
  v_mfma_f32_16x16x32_bf16 a[12:15], v[20:23], a[252:255], a[12:15]
  ds_read_b64_tr_b16 v[18:19], v1 offset:4608
  s_mul_i32 s3, s17, 320
  s_waitcnt vmcnt(3)
  v_mfma_f32_16x16x32_bf16 a[0:3], v[24:27], v[176:179], a[0:3]
  ds_read_b64_tr_b16 v[20:21], v1 offset:4128
  s_add_u32 s72, s72, s38
  s_waitcnt vmcnt(2)
  v_mfma_f32_16x16x32_bf16 a[4:7], v[24:27], v[180:183], a[4:7]
  ds_read_b64_tr_b16 v[22:23], v1 offset:4640
  s_add_u32 s74, s74, s3
  v_mfma_f32_16x16x32_bf16 a[8:11], v[28:31], v[176:179], a[8:11]
  ds_read_b64_tr_b16 v[24:25], v1 offset:4160
  s_lshl_b32 s75, s17, 5
  v_mfma_f32_16x16x32_bf16 a[12:15], v[28:31], v[180:183], a[12:15]
  ds_read_b64_tr_b16 v[26:27], v1 offset:4672
  s_waitcnt lgkmcnt(6)
  v_mfma_f32_16x16x32_bf16 a[16:19], v[32:35], a[248:251], a[16:19]
  ds_read_b64_tr_b16 v[28:29], v1 offset:4192
  s_add_u32 m0, s64, 26624
  s_add_u32 s75, s75, 256
  v_mfma_f32_16x16x32_bf16 a[20:23], v[32:35], a[252:255], a[20:23]
  ds_read_b64_tr_b16 v[30:31], v1 offset:4704
  s_lshr_b32 s3, s18, 1
  v_mfma_f32_16x16x32_bf16 a[24:27], v[36:39], a[248:251], a[24:27]
  buffer_load_dwordx4 v5, s[32:35], s72 offen offset:0 lds
  v_mfma_f32_16x16x32_bf16 a[28:31], v[36:39], a[252:255], a[28:31]
  ds_read_b64_tr_b16 v[32:33], v1 offset:5120
  ds_read_b64_tr_b16 v[34:35], v1 offset:5632
  v_mfma_f32_16x16x32_bf16 a[16:19], v[40:43], v[176:179], a[16:19]
  ds_read_b64_tr_b16 v[36:37], v1 offset:5152
  s_cmp_eq_u32 s3, s16
  s_cselect_b32 s86, 0, 0x80000000
  s_and_b32 s3, s18, 1
  v_mfma_f32_16x16x32_bf16 a[20:23], v[40:43], v[180:183], a[20:23]
  buffer_load_dwordx4 v6, s[32:35], s72 offen offset:1024 lds
  v_lshl_add_u32 v233, s3, 3, v205
  v_mov_b32 v66, 1152
  v_mad_u32_u24 v234, s3, v66, v206
  v_mfma_f32_16x16x32_bf16 a[24:27], v[44:47], v[176:179], a[24:27]
  ds_read_b64_tr_b16 v[38:39], v1 offset:5664
  ds_read_b64_tr_b16 v[40:41], v1 offset:5184
  s_lshl_b32 s3, s3, 10
  v_or_b32 v234, s86, v234
  v_mfma_f32_16x16x32_bf16 a[28:31], v[44:47], v[180:183], a[28:31]
  ds_read_b64_tr_b16 v[42:43], v1 offset:5696
  s_add_u32 s3, s3, 16384
  s_or_b32 s3, s3, s86
  v_add_u32 v232, s3, v8
  s_waitcnt lgkmcnt(6)
  v_mfma_f32_16x16x32_bf16 a[32:35], v[16:19], v[216:219], a[32:35]
  ds_read_b64_tr_b16 v[44:45], v1 offset:5216
  s_add_u32 s72, s68, s38
  v_bfe_u32 v64, v8, 4, 1
  v_lshlrev_b32 v64, 4, v64
  v_mfma_f32_16x16x32_bf16 a[36:39], v[16:19], v[220:223], a[36:39]
  ds_read_b64_tr_b16 v[46:47], v1 offset:5728
  v_mov_b32 v65, 0x3f80
  v_lshlrev_b32 v64, v64, v65
  v_bfe_u32 v65, v8, 5, 3
  v_lshrrev_b32 v66, 8, v8
  v_mfma_f32_16x16x32_bf16 a[40:43], v[20:23], v[216:219], a[40:43]
  ds_read_b64_tr_b16 v[16:17], v1 offset:6144
  s_add_u32 m0, s64, 28672
  v_lshlrev_b32 v66, 1, v66
ffn_hop76:
  s_cbranch_execz ffn_hop77
  v_sub_u32 v65, v65, v66
  v_mfma_f32_16x16x32_bf16 a[44:47], v[20:23], v[220:223], a[44:47]
  ds_read_b64_tr_b16 v[18:19], v1 offset:6656
  v_cmp_eq_u32 vcc, 0, v65
  v_mov_b32 v188, 0
  v_mov_b32 v192, 0
  v_cndmask_b32 v190, 0, v64, vcc
  v_mfma_f32_16x16x32_bf16 a[48:51], v[24:27], v[216:219], a[48:51]
  ds_read_b64_tr_b16 v[20:21], v1 offset:6176
  v_cmp_eq_u32 vcc, 1, v65
  v_mov_b32 v189, 0
  v_mov_b32 v193, 0
  v_cndmask_b32 v191, 0, v64, vcc
  v_mfma_f32_16x16x32_bf16 a[52:55], v[24:27], v[220:223], a[52:55]
  buffer_load_dwordx4 v5, s[32:35], s72 offen offset:0 lds
  s_lshl_b32 s78, s36, 5
  v_accvgpr_read_b32 v48, a0
  v_mfma_f32_16x16x32_bf16 a[56:59], v[28:31], v[216:219], a[56:59]
  ds_read_b64_tr_b16 v[22:23], v1 offset:6688
  ds_read_b64_tr_b16 v[24:25], v1 offset:6208
  v_accvgpr_read_b32 v49, a1
  v_accvgpr_read_b32 v50, a2
  v_mfma_f32_16x16x32_bf16 a[60:63], v[28:31], v[220:223], a[60:63]
  ds_read_b64_tr_b16 v[26:27], v1 offset:6720
  v_accvgpr_read_b32 v51, a3
  v_accvgpr_read_b32 v52, a8
  v_accvgpr_read_b32 v53, a9
  s_waitcnt lgkmcnt(6)
  v_mfma_f32_16x16x32_bf16 a[32:35], v[32:35], v[224:227], a[32:35]
  ds_read_b64_tr_b16 v[28:29], v1 offset:6240
  s_add_u32 s72, s69, s38
  v_accvgpr_read_b32 v54, a10
  v_accvgpr_read_b32 v55, a11
  v_mfma_f32_16x16x32_bf16 a[36:39], v[32:35], v[228:231], a[36:39]
  ds_read_b64_tr_b16 v[30:31], v1 offset:6752
  v_cvt_pk_bf16_f32 v56, v48, v49
  v_cvt_pk_bf16_f32 v57, v50, v51
  v_cvt_pk_bf16_f32 v58, v52, v53
  v_mfma_f32_16x16x32_bf16 a[40:43], v[36:39], v[224:227], a[40:43]
  ds_read_b64_tr_b16 v[32:33], v1 offset:7168
  v_cvt_pk_bf16_f32 v59, v54, v55
  buffer_store_dwordx4 v[56:59], v8, s[56:59], s78 offen offset:0 sc1
  v_accvgpr_read_b32 v64, a4
  v_mfma_f32_16x16x32_bf16 a[44:47], v[36:39], v[228:231], a[44:47]
  ds_read_b64_tr_b16 v[34:35], v1 offset:7680
  s_add_u32 m0, s64, 29696
  v_accvgpr_read_b32 v65, a5
  v_accvgpr_read_b32 v66, a6
  v_accvgpr_read_b32 v67, a7
  v_mfma_f32_16x16x32_bf16 a[48:51], v[40:43], v[224:227], a[48:51]
  ds_read_b64_tr_b16 v[36:37], v1 offset:7200
  v_accvgpr_read_b32 v68, a12
  v_accvgpr_read_b32 v69, a13
  v_accvgpr_read_b32 v70, a14
  v_mfma_f32_16x16x32_bf16 a[52:55], v[40:43], v[228:231], a[52:55]
  ds_read_b64_tr_b16 v[38:39], v1 offset:7712
  v_accvgpr_read_b32 v71, a15
  v_cvt_pk_bf16_f32 v72, v64, v65
  v_cvt_pk_bf16_f32 v73, v66, v67
  v_mfma_f32_16x16x32_bf16 a[56:59], v[44:47], v[224:227], a[56:59]
  ds_read_b64_tr_b16 v[40:41], v1 offset:7232
  v_cvt_pk_bf16_f32 v74, v68, v69
  v_cvt_pk_bf16_f32 v75, v70, v71
  buffer_store_dwordx4 v[72:75], v8, s[56:59], s78 offen offset:1024 sc1
  v_mfma_f32_16x16x32_bf16 a[60:63], v[44:47], v[228:231], a[60:63]
  ds_read_b64_tr_b16 v[42:43], v1 offset:7744
ffn_hop77:
  s_cbranch_execz ffn_hop78
  v_accvgpr_read_b32 v48, a16
  v_accvgpr_read_b32 v49, a17
  s_waitcnt lgkmcnt(6)
  v_mfma_f32_16x16x32_bf16 a[32:35], v[16:19], v[112:115], a[32:35]
  buffer_load_dwordx4 v5, s[32:35], s72 offen offset:0 lds
  v_accvgpr_read_b32 v50, a18
  v_mfma_f32_16x16x32_bf16 a[36:39], v[16:19], v[116:119], a[36:39]
  ds_read_b64_tr_b16 v[44:45], v1 offset:7264
  ds_read_b64_tr_b16 v[46:47], v1 offset:7776
  v_accvgpr_read_b32 v51, a19
  v_mfma_f32_16x16x32_bf16 a[40:43], v[20:23], v[112:115], a[40:43]
  ds_read_b64_tr_b16 v[16:17], v1 offset:8192
  s_add_u32 s72, s67, 221184
  v_accvgpr_read_b32 v52, a24
  v_mfma_f32_16x16x32_bf16 a[44:47], v[20:23], v[116:119], a[44:47]
  ds_read_b64_tr_b16 v[18:19], v1 offset:8704
  v_accvgpr_read_b32 v53, a25
  v_accvgpr_read_b32 v54, a26
  v_mfma_f32_16x16x32_bf16 a[48:51], v[24:27], v[112:115], a[48:51]
  ds_read_b64_tr_b16 v[20:21], v1 offset:8224
  s_add_u32 s72, s72, s38
  v_accvgpr_read_b32 v55, a27
  v_cvt_pk_bf16_f32 v60, v48, v49
  v_mfma_f32_16x16x32_bf16 a[52:55], v[24:27], v[116:119], a[52:55]
  ds_read_b64_tr_b16 v[22:23], v1 offset:8736
  v_cvt_pk_bf16_f32 v61, v50, v51
  v_cvt_pk_bf16_f32 v62, v52, v53
  v_mfma_f32_16x16x32_bf16 a[56:59], v[28:31], v[112:115], a[56:59]
  ds_read_b64_tr_b16 v[24:25], v1 offset:8256
  v_cvt_pk_bf16_f32 v63, v54, v55
  buffer_store_dwordx4 v[60:63], v8, s[56:59], s78 offen offset:2048 sc1
  v_mfma_f32_16x16x32_bf16 a[60:63], v[28:31], v[116:119], a[60:63]
  ds_read_b64_tr_b16 v[26:27], v1 offset:8768
  s_waitcnt lgkmcnt(6)
  v_mfma_f32_16x16x32_bf16 a[32:35], v[32:35], v[120:123], a[32:35]
  ds_read_b64_tr_b16 v[28:29], v1 offset:8288
  s_add_u32 m0, s64, 30720
  v_accvgpr_read_b32 v64, a20
  v_mfma_f32_16x16x32_bf16 a[36:39], v[32:35], v[124:127], a[36:39]
  ds_read_b64_tr_b16 v[30:31], v1 offset:8800
  v_accvgpr_read_b32 v65, a21
  v_accvgpr_read_b32 v66, a22
  v_accvgpr_read_b32 v67, a23
  v_mfma_f32_16x16x32_bf16 a[40:43], v[36:39], v[120:123], a[40:43]
  buffer_load_dwordx4 v5, s[32:35], s72 offen offset:0 lds
  v_accvgpr_read_b32 v68, a28
  v_mfma_f32_16x16x32_bf16 a[44:47], v[36:39], v[124:127], a[44:47]
  ds_read_b64_tr_b16 v[32:33], v1 offset:9216
  ds_read_b64_tr_b16 v[34:35], v1 offset:9728
  v_accvgpr_read_b32 v69, a29
  v_mfma_f32_16x16x32_bf16 a[48:51], v[40:43], v[120:123], a[48:51]
  ds_read_b64_tr_b16 v[36:37], v1 offset:9248
  v_accvgpr_read_b32 v70, a30
  v_accvgpr_read_b32 v71, a31
  v_mfma_f32_16x16x32_bf16 a[52:55], v[40:43], v[124:127], a[52:55]
  buffer_load_dwordx4 v6, s[32:35], s72 offen offset:1024 lds
  v_cvt_pk_bf16_f32 v76, v64, v65
  v_mfma_f32_16x16x32_bf16 a[56:59], v[44:47], v[120:123], a[56:59]
  ds_read_b64_tr_b16 v[38:39], v1 offset:9760
  ds_read_b64_tr_b16 v[40:41], v1 offset:9280
  v_cvt_pk_bf16_f32 v77, v66, v67
  v_cvt_pk_bf16_f32 v78, v68, v69
  v_mfma_f32_16x16x32_bf16 a[60:63], v[44:47], v[124:127], a[60:63]
  ds_read_b64_tr_b16 v[42:43], v1 offset:9792
  v_cvt_pk_bf16_f32 v79, v70, v71
ffn_hop78:
  s_cbranch_execz ffn_hop79
  s_waitcnt lgkmcnt(6)
  v_mfma_f32_16x16x32_bf16 a[32:35], v[16:19], a[232:235], a[32:35]
  ds_read_b64_tr_b16 v[44:45], v1 offset:9312
  buffer_store_dwordx4 v[76:79], v8, s[56:59], s78 offen offset:3072 sc1
  v_mfma_f32_16x16x32_bf16 a[36:39], v[16:19], a[236:239], a[36:39]
  ds_read_b64_tr_b16 v[46:47], v1 offset:9824
  v_mfma_f32_16x16x32_bf16 a[40:43], v[20:23], a[232:235], a[40:43]
  s_barrier
  ds_read_b64_tr_b16 v[16:17], v1 offset:10240
  v_mfma_f32_16x16x32_bf16 a[44:47], v[20:23], a[236:239], a[44:47]
  ds_read_b64_tr_b16 v[18:19], v1 offset:10752
  s_add_u32 s73, s66, 0
  v_mfma_f32_16x16x32_bf16 a[48:51], v[24:27], a[232:235], a[48:51]
  ds_read_b64_tr_b16 v[20:21], v1 offset:10272
  s_add_u32 s73, s73, s39
  v_mfma_f32_16x16x32_bf16 a[52:55], v[24:27], a[236:239], a[52:55]
  ds_read_b64_tr_b16 v[22:23], v1 offset:10784
  v_mfma_f32_16x16x32_bf16 a[56:59], v[28:31], a[232:235], a[56:59]
  ds_read_b64_tr_b16 v[24:25], v1 offset:10304
  s_add_u32 m0, s64, 32768
  v_mfma_f32_16x16x32_bf16 a[60:63], v[28:31], a[236:239], a[60:63]
  ds_read_b64_tr_b16 v[26:27], v1 offset:10816
  s_waitcnt lgkmcnt(6)
  v_mfma_f32_16x16x32_bf16 a[32:35], v[32:35], a[240:243], a[32:35]
  buffer_load_dwordx4 v7, s[32:35], s73 offen offset:0 lds
  v_mfma_f32_16x16x32_bf16 a[36:39], v[32:35], a[244:247], a[36:39]
  ds_read_b64_tr_b16 v[28:29], v1 offset:10336
  ds_read_b64_tr_b16 v[30:31], v1 offset:10848
  v_mfma_f32_16x16x32_bf16 a[40:43], v[36:39], a[240:243], a[40:43]
  ds_read_b64_tr_b16 v[32:33], v1 offset:11264
  s_add_u32 s73, s66, 73728
  v_mfma_f32_16x16x32_bf16 a[44:47], v[36:39], a[244:247], a[44:47]
  ds_read_b64_tr_b16 v[34:35], v1 offset:11776
  v_mfma_f32_16x16x32_bf16 a[48:51], v[40:43], a[240:243], a[48:51]
  ds_read_b64_tr_b16 v[36:37], v1 offset:11296
  s_add_u32 s73, s73, s39
  v_mfma_f32_16x16x32_bf16 a[52:55], v[40:43], a[244:247], a[52:55]
  ds_read_b64_tr_b16 v[38:39], v1 offset:11808
  v_mfma_f32_16x16x32_bf16 a[56:59], v[44:47], a[240:243], a[56:59]
  ds_read_b64_tr_b16 v[40:41], v1 offset:11328
  s_add_u32 m0, s64, 33792
  v_mfma_f32_16x16x32_bf16 a[60:63], v[44:47], a[244:247], a[60:63]
  ds_read_b64_tr_b16 v[42:43], v1 offset:11840
  s_waitcnt lgkmcnt(6)
  v_mfma_f32_16x16x32_bf16 a[32:35], v[16:19], v[208:211], a[32:35]
  buffer_load_dwordx4 v7, s[32:35], s73 offen offset:0 lds
  v_mfma_f32_16x16x32_bf16 a[36:39], v[16:19], v[212:215], a[36:39]
  ds_read_b64_tr_b16 v[44:45], v1 offset:11360
  ds_read_b64_tr_b16 v[46:47], v1 offset:11872
  v_mfma_f32_16x16x32_bf16 a[40:43], v[20:23], v[208:211], a[40:43]
  ds_read_b64_tr_b16 v[16:17], v1 offset:12288
  s_add_u32 s73, s67, 0
  v_mfma_f32_16x16x32_bf16 a[44:47], v[20:23], v[212:215], a[44:47]
  ds_read_b64_tr_b16 v[18:19], v1 offset:12800
  v_mfma_f32_16x16x32_bf16 a[48:51], v[24:27], v[208:211], a[48:51]
  ds_read_b64_tr_b16 v[20:21], v1 offset:12320
  s_add_u32 s73, s73, s39
  v_mfma_f32_16x16x32_bf16 a[52:55], v[24:27], v[212:215], a[52:55]
  ds_read_b64_tr_b16 v[22:23], v1 offset:12832
  v_mfma_f32_16x16x32_bf16 a[56:59], v[28:31], v[208:211], a[56:59]
  ds_read_b64_tr_b16 v[24:25], v1 offset:13312
  s_add_u32 m0, s64, 34816
  v_mfma_f32_16x16x32_bf16 a[60:63], v[28:31], v[212:215], a[60:63]
  ds_read_b64_tr_b16 v[26:27], v1 offset:13824
  s_waitcnt lgkmcnt(6)
  v_mfma_f32_16x16x32_bf16 a[32:35], v[32:35], a[224:227], a[32:35]
  buffer_load_dwordx4 v7, s[32:35], s73 offen offset:0 lds
  v_mfma_f32_16x16x32_bf16 a[36:39], v[32:35], a[228:231], a[36:39]
  ds_read_b64_tr_b16 v[28:29], v1 offset:13344
  ds_read_b64_tr_b16 v[30:31], v1 offset:13856
  v_mfma_f32_16x16x32_bf16 a[40:43], v[36:39], a[224:227], a[40:43]
  ds_read_b64_tr_b16 v[32:33], v1 offset:12352
ffn_hop79:
  s_cbranch_execz ffn_hop80
  s_add_u32 s73, s67, 73728
  v_mfma_f32_16x16x32_bf16 a[44:47], v[36:39], a[228:231], a[44:47]
  ds_read_b64_tr_b16 v[34:35], v1 offset:12864
  v_mfma_f32_16x16x32_bf16 a[48:51], v[40:43], a[224:227], a[48:51]
  ds_read_b64_tr_b16 v[36:37], v1 offset:12384
  s_add_u32 s73, s73, s39
  v_mfma_f32_16x16x32_bf16 a[52:55], v[40:43], a[228:231], a[52:55]
  ds_read_b64_tr_b16 v[38:39], v1 offset:12896
  v_mfma_f32_16x16x32_bf16 a[56:59], v[44:47], a[224:227], a[56:59]
  ds_read_b64_tr_b16 v[40:41], v1 offset:13376
  s_add_u32 m0, s64, 35840
  v_mfma_f32_16x16x32_bf16 a[60:63], v[44:47], a[228:231], a[60:63]
  ds_read_b64_tr_b16 v[42:43], v1 offset:13888
  s_waitcnt lgkmcnt(6)
  v_mfma_f32_16x16x32_bf16 a[32:35], v[16:19], a[248:251], a[32:35]
  buffer_load_dwordx4 v7, s[32:35], s73 offen offset:0 lds
  v_mfma_f32_16x16x32_bf16 a[36:39], v[16:19], a[252:255], a[36:39]
  ds_read_b64_tr_b16 v[44:45], v1 offset:13408
  ds_read_b64_tr_b16 v[46:47], v1 offset:13920
  v_mfma_f32_16x16x32_bf16 a[40:43], v[20:23], a[248:251], a[40:43]
  ds_read_b64_tr_b16 v[16:17], v1 offset:14336
  s_add_u32 s73, s66, 147456
  v_mfma_f32_16x16x32_bf16 a[44:47], v[20:23], a[252:255], a[44:47]
  ds_read_b64_tr_b16 v[18:19], v1 offset:14848
  s_waitcnt vmcnt(4)
  buffer_store_dword v5, off, s[60:63], s84 offset:12 sc1
  v_mfma_f32_16x16x32_bf16 a[32:35], v[24:27], v[176:179], a[32:35]
  ds_read_b64_tr_b16 v[20:21], v1 offset:14368
  s_add_u32 s73, s73, s39
  v_mfma_f32_16x16x32_bf16 a[36:39], v[24:27], v[180:183], a[36:39]
  ds_read_b64_tr_b16 v[22:23], v1 offset:14880
  v_mfma_f32_16x16x32_bf16 a[40:43], v[28:31], v[176:179], a[40:43]
  ds_read_b64_tr_b16 v[24:25], v1 offset:14400
  s_add_u32 m0, s64, 36864
  v_mfma_f32_16x16x32_bf16 a[44:47], v[28:31], v[180:183], a[44:47]
  ds_read_b64_tr_b16 v[26:27], v1 offset:14912
  s_waitcnt lgkmcnt(6)
  v_mfma_f32_16x16x32_bf16 a[48:51], v[32:35], a[248:251], a[48:51]
  buffer_load_dwordx4 v7, s[32:35], s73 offen offset:0 lds
  v_mfma_f32_16x16x32_bf16 a[52:55], v[32:35], a[252:255], a[52:55]
  ds_read_b64_tr_b16 v[28:29], v1 offset:14432
  ds_read_b64_tr_b16 v[30:31], v1 offset:14944
  v_mfma_f32_16x16x32_bf16 a[56:59], v[36:39], a[248:251], a[56:59]
  ds_read_b64_tr_b16 v[32:33], v1 offset:15360
  s_add_u32 s73, s66, 221184
  v_mfma_f32_16x16x32_bf16 a[60:63], v[36:39], a[252:255], a[60:63]
  ds_read_b64_tr_b16 v[34:35], v1 offset:15872
  v_mfma_f32_16x16x32_bf16 a[48:51], v[40:43], v[176:179], a[48:51]
  ds_read_b64_tr_b16 v[36:37], v1 offset:15392
  s_add_u32 s73, s73, s39
  s_lshl_b32 s78, s37, 5
  v_mfma_f32_16x16x32_bf16 a[52:55], v[40:43], v[180:183], a[52:55]
  ds_read_b64_tr_b16 v[38:39], v1 offset:15904
  v_accvgpr_read_b32 v48, a32
  v_accvgpr_read_b32 v49, a33
  v_mfma_f32_16x16x32_bf16 a[56:59], v[44:47], v[176:179], a[56:59]
  ds_read_b64_tr_b16 v[40:41], v1 offset:15424
  s_add_u32 m0, s64, 37888
  v_accvgpr_read_b32 v50, a34
  v_mfma_f32_16x16x32_bf16 a[60:63], v[44:47], v[180:183], a[60:63]
  ds_read_b64_tr_b16 v[42:43], v1 offset:15936
  v_accvgpr_read_b32 v51, a35
  s_waitcnt lgkmcnt(6)
  v_mfma_f32_16x16x32_bf16 v[252:255], v[16:19], v[80:83], 0
  buffer_load_dwordx4 v7, s[32:35], s73 offen offset:0 lds
  v_accvgpr_read_b32 v52, a40
  v_accvgpr_read_b32 v53, a41
  v_mfma_f32_16x16x32_bf16 v[128:131], v[16:19], v[84:87], 0
ffn_hop80:
  s_cbranch_execz ffn_hop81
  ds_read_b64_tr_b16 v[44:45], v1 offset:15456
  ds_read_b64_tr_b16 v[46:47], v1 offset:15968
  v_accvgpr_read_b32 v54, a42
  v_mfma_f32_16x16x32_bf16 v[132:135], v[20:23], v[80:83], 0
  ds_read_b64_tr_b16 v[16:17], v1 offset:16384
  s_add_u32 s73, s67, 147456
  v_accvgpr_read_b32 v55, a43
  v_mfma_f32_16x16x32_bf16 v[136:139], v[20:23], v[84:87], 0
  ds_read_b64_tr_b16 v[18:19], v1 offset:16896
  v_cvt_pk_bf16_f32 v56, v48, v49
  v_cvt_pk_bf16_f32 v57, v50, v51
  v_mfma_f32_16x16x32_bf16 v[140:143], v[24:27], v[80:83], 0
  ds_read_b64_tr_b16 v[20:21], v1 offset:16416
  s_add_u32 s73, s73, s39
  v_cvt_pk_bf16_f32 v58, v52, v53
  v_cvt_pk_bf16_f32 v59, v54, v55
  v_mfma_f32_16x16x32_bf16 v[144:147], v[24:27], v[84:87], 0
  ds_read_b64_tr_b16 v[22:23], v1 offset:16928
  buffer_store_dwordx4 v[56:59], v8, s[56:59], s78 offen offset:0 sc1
  v_mfma_f32_16x16x32_bf16 v[148:151], v[28:31], v[80:83], 0
  ds_read_b64_tr_b16 v[24:25], v1 offset:16448
  s_add_u32 m0, s64, 0
  v_accvgpr_read_b32 v64, a36
  v_mfma_f32_16x16x32_bf16 v[152:155], v[28:31], v[84:87], 0
  ds_read_b64_tr_b16 v[26:27], v1 offset:16960
  v_accvgpr_read_b32 v65, a37
  v_accvgpr_read_b32 v66, a38
  s_waitcnt lgkmcnt(6)
  v_mfma_f32_16x16x32_bf16 v[252:255], v[32:35], v[88:91], v[252:255]
  buffer_load_dwordx4 v7, s[32:35], s73 offen offset:0 lds
  v_accvgpr_read_b32 v67, a39
  v_mfma_f32_16x16x32_bf16 v[128:131], v[32:35], v[92:95], v[128:131]
  ds_read_b64_tr_b16 v[28:29], v1 offset:16480
  ds_read_b64_tr_b16 v[30:31], v1 offset:16992
  v_accvgpr_read_b32 v68, a44
  v_mfma_f32_16x16x32_bf16 v[132:135], v[36:39], v[88:91], v[132:135]
  ds_read_b64_tr_b16 v[32:33], v1 offset:17408
  s_add_u32 s73, s71, s39
  v_accvgpr_read_b32 v69, a45
  v_accvgpr_read_b32 v70, a46
  v_mfma_f32_16x16x32_bf16 v[136:139], v[36:39], v[92:95], v[136:139]
  ds_read_b64_tr_b16 v[34:35], v1 offset:17920
  v_accvgpr_read_b32 v71, a47
  v_cvt_pk_bf16_f32 v72, v64, v65
  v_mfma_f32_16x16x32_bf16 v[140:143], v[40:43], v[88:91], v[140:143]
  ds_read_b64_tr_b16 v[36:37], v1 offset:17440
  s_add_u32 m0, s64, 1024
  v_cvt_pk_bf16_f32 v73, v66, v67
  v_mfma_f32_16x16x32_bf16 v[144:147], v[40:43], v[92:95], v[144:147]
  ds_read_b64_tr_b16 v[38:39], v1 offset:17952
  v_cvt_pk_bf16_f32 v74, v68, v69
  v_cvt_pk_bf16_f32 v75, v70, v71
  buffer_store_dwordx4 v[72:75], v8, s[56:59], s78 offen offset:1024 sc1
  v_mfma_f32_16x16x32_bf16 v[148:151], v[44:47], v[88:91], v[148:151]
  ds_read_b64_tr_b16 v[40:41], v1 offset:17472
  v_accvgpr_read_b32 v48, a48
  v_mfma_f32_16x16x32_bf16 v[152:155], v[44:47], v[92:95], v[152:155]
  ds_read_b64_tr_b16 v[42:43], v1 offset:17984
  v_accvgpr_read_b32 v49, a49
  s_waitcnt lgkmcnt(6)
  v_mfma_f32_16x16x32_bf16 v[252:255], v[16:19], v[96:99], v[252:255]
  buffer_load_dwordx4 v7, s[32:35], s73 offen offset:0 lds
  v_accvgpr_read_b32 v50, a50
  v_accvgpr_read_b32 v51, a51
  v_mfma_f32_16x16x32_bf16 v[128:131], v[16:19], v[100:103], v[128:131]
  ds_read_b64_tr_b16 v[44:45], v1 offset:17504
ffn_hop81:
  s_cbranch_execz ffn_hop82
  ds_read_b64_tr_b16 v[46:47], v1 offset:18016
  v_accvgpr_read_b32 v52, a56
  v_mfma_f32_16x16x32_bf16 v[132:135], v[20:23], v[96:99], v[132:135]
  s_barrier
  ds_read_b64_tr_b16 v[16:17], v1 offset:18432
  v_accvgpr_read_b32 v53, a57
  v_mfma_f32_16x16x32_bf16 v[136:139], v[20:23], v[100:103], v[136:139]
  ds_read_b64_tr_b16 v[18:19], v1 offset:18944
  s_add_u32 s73, s67, 221184
  v_accvgpr_read_b32 v54, a58
  v_accvgpr_read_b32 v55, a59
  v_mfma_f32_16x16x32_bf16 v[140:143], v[24:27], v[96:99], v[140:143]
  ds_read_b64_tr_b16 v[20:21], v1 offset:18464
  s_add_u32 s73, s73, s39
  v_cvt_pk_bf16_f32 v60, v48, v49
  v_mfma_f32_16x16x32_bf16 v[144:147], v[24:27], v[100:103], v[144:147]
  ds_read_b64_tr_b16 v[22:23], v1 offset:18976
  v_cvt_pk_bf16_f32 v61, v50, v51
  v_cvt_pk_bf16_f32 v62, v52, v53
  v_mfma_f32_16x16x32_bf16 v[148:151], v[28:31], v[96:99], v[148:151]
  ds_read_b64_tr_b16 v[24:25], v1 offset:18496
  s_add_u32 m0, s64, 2048
  v_cvt_pk_bf16_f32 v63, v54, v55
  buffer_store_dwordx4 v[60:63], v8, s[56:59], s78 offen offset:2048 sc1
  v_mfma_f32_16x16x32_bf16 v[152:155], v[28:31], v[100:103], v[152:155]
  ds_read_b64_tr_b16 v[26:27], v1 offset:19008
  s_waitcnt lgkmcnt(6)
  v_mfma_f32_16x16x32_bf16 v[252:255], v[32:35], v[104:107], v[252:255]
  buffer_load_dwordx4 v7, s[32:35], s73 offen offset:0 lds
  v_accvgpr_read_b32 v64, a52
  v_mfma_f32_16x16x32_bf16 v[128:131], v[32:35], v[108:111], v[128:131]
  ds_read_b64_tr_b16 v[28:29], v1 offset:18528
  ds_read_b64_tr_b16 v[30:31], v1 offset:19040
  v_accvgpr_read_b32 v65, a53
  v_accvgpr_read_b32 v66, a54
  v_mfma_f32_16x16x32_bf16 v[132:135], v[36:39], v[104:107], v[132:135]
  ds_read_b64_tr_b16 v[32:33], v1 offset:19456
  s_add_u32 s73, s66, 0
  v_accvgpr_read_b32 v67, a55
  v_mfma_f32_16x16x32_bf16 v[136:139], v[36:39], v[108:111], v[136:139]
  ds_read_b64_tr_b16 v[34:35], v1 offset:19968
  v_accvgpr_read_b32 v68, a60
  v_accvgpr_read_b32 v69, a61
  v_mfma_f32_16x16x32_bf16 v[140:143], v[40:43], v[104:107], v[140:143]
  ds_read_b64_tr_b16 v[36:37], v1 offset:19488
  s_add_u32 s73, s73, s70
  v_accvgpr_read_b32 v70, a62
  v_accvgpr_read_b32 v71, a63
  v_mfma_f32_16x16x32_bf16 v[144:147], v[40:43], v[108:111], v[144:147]
  ds_read_b64_tr_b16 v[38:39], v1 offset:20000
  v_cvt_pk_bf16_f32 v76, v64, v65
  v_cvt_pk_bf16_f32 v77, v66, v67
  v_mfma_f32_16x16x32_bf16 v[148:151], v[44:47], v[104:107], v[148:151]
  ds_read_b64_tr_b16 v[40:41], v1 offset:19520
  s_add_u32 m0, s64, 3072
  v_cvt_pk_bf16_f32 v78, v68, v69
  v_mfma_f32_16x16x32_bf16 v[152:155], v[44:47], v[108:111], v[152:155]
  ds_read_b64_tr_b16 v[42:43], v1 offset:20032
  v_cvt_pk_bf16_f32 v79, v70, v71
  buffer_store_dwordx4 v[76:79], v8, s[56:59], s78 offen offset:3072 sc1
  s_waitcnt lgkmcnt(6)
  v_mfma_f32_16x16x32_bf16 v[252:255], v[16:19], a[192:195], v[252:255]
  buffer_load_dwordx4 v7, s[32:35], s73 offen offset:0 lds
  v_mfma_f32_16x16x32_bf16 v[128:131], v[16:19], a[196:199], v[128:131]
  ds_read_b64_tr_b16 v[44:45], v1 offset:19552
  ds_read_b64_tr_b16 v[46:47], v1 offset:20064
ffn_hop82:
  s_cbranch_execz ffn_hop83
  v_mfma_f32_16x16x32_bf16 v[132:135], v[20:23], a[192:195], v[132:135]
  ds_read_b64_tr_b16 v[16:17], v1 offset:20480
  s_add_u32 s73, s66, 73728
  v_mfma_f32_16x16x32_bf16 v[136:139], v[20:23], a[196:199], v[136:139]
  ds_read_b64_tr_b16 v[18:19], v1 offset:20992
  v_mfma_f32_16x16x32_bf16 v[140:143], v[24:27], a[192:195], v[140:143]
  ds_read_b64_tr_b16 v[20:21], v1 offset:20512
  s_add_u32 s73, s73, s70
  v_mfma_f32_16x16x32_bf16 v[144:147], v[24:27], a[196:199], v[144:147]
  ds_read_b64_tr_b16 v[22:23], v1 offset:21024
  v_mfma_f32_16x16x32_bf16 v[148:151], v[28:31], a[192:195], v[148:151]
  ds_read_b64_tr_b16 v[24:25], v1 offset:20544
  s_add_u32 m0, s64, 4096
  v_mfma_f32_16x16x32_bf16 v[152:155], v[28:31], a[196:199], v[152:155]
  ds_read_b64_tr_b16 v[26:27], v1 offset:21056
  s_waitcnt lgkmcnt(6)
  v_mfma_f32_16x16x32_bf16 v[252:255], v[32:35], a[200:203], v[252:255]
  buffer_load_dwordx4 v7, s[32:35], s73 offen offset:0 lds
  v_mfma_f32_16x16x32_bf16 v[128:131], v[32:35], a[204:207], v[128:131]
  ds_read_b64_tr_b16 v[28:29], v1 offset:20576
  ds_read_b64_tr_b16 v[30:31], v1 offset:21088
  v_mfma_f32_16x16x32_bf16 v[132:135], v[36:39], a[200:203], v[132:135]
  ds_read_b64_tr_b16 v[32:33], v1 offset:21504
  s_add_u32 s73, s67, 0
  v_mfma_f32_16x16x32_bf16 v[136:139], v[36:39], a[204:207], v[136:139]
  ds_read_b64_tr_b16 v[34:35], v1 offset:22016
  s_add_u32 s73, s73, s70
  v_mfma_f32_16x16x32_bf16 v[140:143], v[40:43], a[200:203], v[140:143]
  ds_read_b64_tr_b16 v[36:37], v1 offset:21536
  v_mfma_f32_16x16x32_bf16 v[144:147], v[40:43], a[204:207], v[144:147]
  ds_read_b64_tr_b16 v[38:39], v1 offset:22048
  s_add_u32 m0, s64, 5120
  v_mfma_f32_16x16x32_bf16 v[148:151], v[44:47], a[200:203], v[148:151]
  ds_read_b64_tr_b16 v[40:41], v1 offset:21568
  v_mfma_f32_16x16x32_bf16 v[152:155], v[44:47], a[204:207], v[152:155]
  ds_read_b64_tr_b16 v[42:43], v1 offset:22080
  s_waitcnt lgkmcnt(6)
  v_mfma_f32_16x16x32_bf16 v[252:255], v[16:19], a[208:211], v[252:255]
  buffer_load_dwordx4 v7, s[32:35], s73 offen offset:0 lds
  v_mfma_f32_16x16x32_bf16 v[128:131], v[16:19], a[212:215], v[128:131]
  ds_read_b64_tr_b16 v[44:45], v1 offset:21600
  ds_read_b64_tr_b16 v[46:47], v1 offset:22112
  v_mfma_f32_16x16x32_bf16 v[132:135], v[20:23], a[208:211], v[132:135]
  ds_read_b64_tr_b16 v[16:17], v1 offset:22528
  s_add_u32 s73, s67, 73728
  v_mfma_f32_16x16x32_bf16 v[136:139], v[20:23], a[212:215], v[136:139]
  ds_read_b64_tr_b16 v[18:19], v1 offset:23040
  s_add_u32 s73, s73, s70
  v_mfma_f32_16x16x32_bf16 v[140:143], v[24:27], a[208:211], v[140:143]
  ds_read_b64_tr_b16 v[20:21], v1 offset:22560
  v_mfma_f32_16x16x32_bf16 v[144:147], v[24:27], a[212:215], v[144:147]
  ds_read_b64_tr_b16 v[22:23], v1 offset:23072
  s_add_u32 m0, s64, 6144
  v_mfma_f32_16x16x32_bf16 v[148:151], v[28:31], a[208:211], v[148:151]
  ds_read_b64_tr_b16 v[24:25], v1 offset:22592
  v_mfma_f32_16x16x32_bf16 v[152:155], v[28:31], a[212:215], v[152:155]
  ds_read_b64_tr_b16 v[26:27], v1 offset:23104
  s_waitcnt lgkmcnt(6)
  v_mfma_f32_16x16x32_bf16 v[252:255], v[32:35], a[216:219], v[252:255]
  buffer_load_dwordx4 v7, s[32:35], s73 offen offset:0 lds
  v_mfma_f32_16x16x32_bf16 v[128:131], v[32:35], a[220:223], v[128:131]
  ds_read_b64_tr_b16 v[28:29], v1 offset:22624
  ds_read_b64_tr_b16 v[30:31], v1 offset:23136
ffn_hop83:
  s_cbranch_execz ffn_hop84
  v_mfma_f32_16x16x32_bf16 v[132:135], v[36:39], a[216:219], v[132:135]
  ds_read_b64_tr_b16 v[32:33], v1 offset:23552
  s_add_u32 s73, s66, 147456
  v_mfma_f32_16x16x32_bf16 v[136:139], v[36:39], a[220:223], v[136:139]
  ds_read_b64_tr_b16 v[34:35], v1 offset:24064
  s_add_u32 s73, s73, s70
  v_mfma_f32_16x16x32_bf16 v[140:143], v[40:43], a[216:219], v[140:143]
  ds_read_b64_tr_b16 v[36:37], v1 offset:23584
  s_add_u32 m0, s64, 7168
  v_mfma_f32_16x16x32_bf16 v[144:147], v[40:43], a[220:223], v[144:147]
  ds_read_b64_tr_b16 v[38:39], v1 offset:24096
  v_mfma_f32_16x16x32_bf16 v[148:151], v[44:47], a[216:219], v[148:151]
  ds_read_b64_tr_b16 v[40:41], v1 offset:23616
  s_waitcnt vmcnt(4)
  buffer_store_dword v5, off, s[60:63], s84 offset:16 sc1
  v_mfma_f32_16x16x32_bf16 v[152:155], v[44:47], a[220:223], v[152:155]
  ds_read_b64_tr_b16 v[42:43], v1 offset:24128
  s_waitcnt lgkmcnt(6)
  v_mfma_f32_16x16x32_bf16 v[252:255], v[16:19], v[216:219], v[252:255]
  buffer_load_dwordx4 v7, s[32:35], s73 offen offset:0 lds
  v_mfma_f32_16x16x32_bf16 v[128:131], v[16:19], v[220:223], v[128:131]
  ds_read_b64_tr_b16 v[44:45], v1 offset:23648
  ds_read_b64_tr_b16 v[46:47], v1 offset:24160
  v_mfma_f32_16x16x32_bf16 v[132:135], v[20:23], v[216:219], v[132:135]
  ds_read_b64_tr_b16 v[16:17], v1 offset:24576
  s_add_u32 s73, s66, 221184
  v_mfma_f32_16x16x32_bf16 v[136:139], v[20:23], v[220:223], v[136:139]
  ds_read_b64_tr_b16 v[18:19], v1 offset:25088
  s_add_u32 s73, s73, s70
  v_mfma_f32_16x16x32_bf16 v[140:143], v[24:27], v[216:219], v[140:143]
  ds_read_b64_tr_b16 v[20:21], v1 offset:24608
  s_add_u32 m0, s64, 8192
  v_mfma_f32_16x16x32_bf16 v[144:147], v[24:27], v[220:223], v[144:147]
  ds_read_b64_tr_b16 v[22:23], v1 offset:25120
  v_mfma_f32_16x16x32_bf16 v[148:151], v[28:31], v[216:219], v[148:151]
  ds_read_b64_tr_b16 v[24:25], v1 offset:24640
  v_mfma_f32_16x16x32_bf16 v[152:155], v[28:31], v[220:223], v[152:155]
  ds_read_b64_tr_b16 v[26:27], v1 offset:25152
  s_waitcnt lgkmcnt(6)
  v_mfma_f32_16x16x32_bf16 v[252:255], v[32:35], v[224:227], v[252:255]
  buffer_load_dwordx4 v7, s[32:35], s73 offen offset:0 lds
  v_mfma_f32_16x16x32_bf16 v[128:131], v[32:35], v[228:231], v[128:131]
  ds_read_b64_tr_b16 v[28:29], v1 offset:24672
  ds_read_b64_tr_b16 v[30:31], v1 offset:25184
  v_mfma_f32_16x16x32_bf16 v[132:135], v[36:39], v[224:227], v[132:135]
  ds_read_b64_tr_b16 v[32:33], v1 offset:25600
  s_add_u32 s73, s67, 147456
  v_mfma_f32_16x16x32_bf16 v[136:139], v[36:39], v[228:231], v[136:139]
  ds_read_b64_tr_b16 v[34:35], v1 offset:26112
  s_add_u32 s73, s73, s70
  v_mfma_f32_16x16x32_bf16 v[140:143], v[40:43], v[224:227], v[140:143]
  ds_read_b64_tr_b16 v[36:37], v1 offset:25632
  s_add_u32 m0, s64, 9216
  v_mfma_f32_16x16x32_bf16 v[144:147], v[40:43], v[228:231], v[144:147]
  ds_read_b64_tr_b16 v[38:39], v1 offset:26144
  v_mfma_f32_16x16x32_bf16 v[148:151], v[44:47], v[224:227], v[148:151]
  ds_read_b64_tr_b16 v[40:41], v1 offset:25664
  v_mfma_f32_16x16x32_bf16 v[152:155], v[44:47], v[228:231], v[152:155]
  ds_read_b64_tr_b16 v[42:43], v1 offset:26176
  s_waitcnt lgkmcnt(6)
  v_mfma_f32_16x16x32_bf16 v[252:255], v[16:19], v[112:115], v[252:255]
  buffer_load_dwordx4 v7, s[32:35], s73 offen offset:0 lds
  v_mfma_f32_16x16x32_bf16 v[128:131], v[16:19], v[116:119], v[128:131]
  ds_read_b64_tr_b16 v[44:45], v1 offset:25696
  ds_read_b64_tr_b16 v[46:47], v1 offset:26208
  v_mfma_f32_16x16x32_bf16 v[132:135], v[20:23], v[112:115], v[132:135]
  s_barrier
  ds_read_b64_tr_b16 v[16:17], v1 offset:26624
ffn_hop84:
  s_cbranch_execz ffn_hop85
  v_mfma_f32_16x16x32_bf16 v[136:139], v[20:23], v[116:119], v[136:139]
  ds_read_b64_tr_b16 v[18:19], v1 offset:27136
  s_add_u32 s73, s71, s70
  v_mfma_f32_16x16x32_bf16 v[140:143], v[24:27], v[112:115], v[140:143]
  ds_read_b64_tr_b16 v[20:21], v1 offset:26656
  s_add_u32 m0, s64, 10240
  v_mfma_f32_16x16x32_bf16 v[144:147], v[24:27], v[116:119], v[144:147]
  ds_read_b64_tr_b16 v[22:23], v1 offset:27168
  v_mfma_f32_16x16x32_bf16 v[148:151], v[28:31], v[112:115], v[148:151]
  ds_read_b64_tr_b16 v[24:25], v1 offset:26688
  v_mfma_f32_16x16x32_bf16 v[152:155], v[28:31], v[116:119], v[152:155]
  ds_read_b64_tr_b16 v[26:27], v1 offset:27200
  s_waitcnt lgkmcnt(6)
  v_mfma_f32_16x16x32_bf16 v[252:255], v[32:35], v[120:123], v[252:255]
  buffer_load_dwordx4 v7, s[32:35], s73 offen offset:0 lds
  v_mfma_f32_16x16x32_bf16 v[128:131], v[32:35], v[124:127], v[128:131]
  ds_read_b64_tr_b16 v[28:29], v1 offset:26720
  ds_read_b64_tr_b16 v[30:31], v1 offset:27232
  v_mfma_f32_16x16x32_bf16 v[132:135], v[36:39], v[120:123], v[132:135]
  ds_read_b64_tr_b16 v[32:33], v1 offset:27648
  s_add_u32 s73, s67, 221184
  v_mfma_f32_16x16x32_bf16 v[136:139], v[36:39], v[124:127], v[136:139]
  ds_read_b64_tr_b16 v[34:35], v1 offset:28160
  s_add_u32 s73, s73, s70
  v_mfma_f32_16x16x32_bf16 v[140:143], v[40:43], v[120:123], v[140:143]
  ds_read_b64_tr_b16 v[36:37], v1 offset:27680
  s_add_u32 m0, s64, 11264
  v_mfma_f32_16x16x32_bf16 v[144:147], v[40:43], v[124:127], v[144:147]
  ds_read_b64_tr_b16 v[38:39], v1 offset:28192
  v_mfma_f32_16x16x32_bf16 v[148:151], v[44:47], v[120:123], v[148:151]
  ds_read_b64_tr_b16 v[40:41], v1 offset:27712
  v_mfma_f32_16x16x32_bf16 v[152:155], v[44:47], v[124:127], v[152:155]
  ds_read_b64_tr_b16 v[42:43], v1 offset:28224
  s_waitcnt lgkmcnt(6)
  v_mfma_f32_16x16x32_bf16 v[252:255], v[16:19], a[232:235], v[252:255]
  buffer_load_dwordx4 v7, s[32:35], s73 offen offset:0 lds
  v_mfma_f32_16x16x32_bf16 v[128:131], v[16:19], a[236:239], v[128:131]
  ds_read_b64_tr_b16 v[44:45], v1 offset:27744
  ds_read_b64_tr_b16 v[46:47], v1 offset:28256
  v_mfma_f32_16x16x32_bf16 v[132:135], v[20:23], a[232:235], v[132:135]
  ds_read_b64_tr_b16 v[16:17], v1 offset:28672
  s_add_u32 s73, s66, 0
  v_mfma_f32_16x16x32_bf16 v[136:139], v[20:23], a[236:239], v[136:139]
  ds_read_b64_tr_b16 v[18:19], v1 offset:29184
  s_add_u32 s73, s73, s47
  v_mfma_f32_16x16x32_bf16 v[140:143], v[24:27], a[232:235], v[140:143]
  ds_read_b64_tr_b16 v[20:21], v1 offset:28704
  s_add_u32 m0, s64, 12288
  v_mfma_f32_16x16x32_bf16 v[144:147], v[24:27], a[236:239], v[144:147]
  v_mov_b32 v184, 0
  buffer_atomic_or v184, v204, s[60:63], 0 offen offset:12 sc0
  v_mfma_f32_16x16x32_bf16 v[148:151], v[28:31], a[232:235], v[148:151]
  ds_read_b64_tr_b16 v[22:23], v1 offset:29216
  ds_read_b64_tr_b16 v[24:25], v1 offset:28736
  v_mfma_f32_16x16x32_bf16 v[152:155], v[28:31], a[236:239], v[152:155]
  ds_read_b64_tr_b16 v[26:27], v1 offset:29248
  s_waitcnt lgkmcnt(6)
  v_mfma_f32_16x16x32_bf16 v[252:255], v[32:35], a[240:243], v[252:255]
  buffer_load_dwordx4 v7, s[32:35], s73 offen offset:0 lds
  v_mfma_f32_16x16x32_bf16 v[128:131], v[32:35], a[244:247], v[128:131]
  ds_read_b64_tr_b16 v[28:29], v1 offset:28768
  ds_read_b64_tr_b16 v[30:31], v1 offset:29280
  v_mfma_f32_16x16x32_bf16 v[132:135], v[36:39], a[240:243], v[132:135]
  ds_read_b64_tr_b16 v[32:33], v1 offset:29696
  s_add_u32 s73, s66, 73728
  v_mfma_f32_16x16x32_bf16 v[136:139], v[36:39], a[244:247], v[136:139]
  ds_read_b64_tr_b16 v[34:35], v1 offset:30208
  s_add_u32 s73, s73, s47
  v_mfma_f32_16x16x32_bf16 v[140:143], v[40:43], a[240:243], v[140:143]
  ds_read_b64_tr_b16 v[36:37], v1 offset:29728
  s_add_u32 m0, s64, 13312
  v_mfma_f32_16x16x32_bf16 v[144:147], v[40:43], a[244:247], v[144:147]
ffn_hop85:
  s_cbranch_execz ffn_hop86
  ds_read_b64_tr_b16 v[38:39], v1 offset:30240
  v_mfma_f32_16x16x32_bf16 v[148:151], v[44:47], a[240:243], v[148:151]
  ds_read_b64_tr_b16 v[40:41], v1 offset:29760
  v_mfma_f32_16x16x32_bf16 v[152:155], v[44:47], a[244:247], v[152:155]
  ds_read_b64_tr_b16 v[42:43], v1 offset:30272
  s_waitcnt lgkmcnt(6)
  v_mfma_f32_16x16x32_bf16 v[252:255], v[16:19], v[208:211], v[252:255]
  buffer_load_dwordx4 v7, s[32:35], s73 offen offset:0 lds
  v_mfma_f32_16x16x32_bf16 v[128:131], v[16:19], v[212:215], v[128:131]
  ds_read_b64_tr_b16 v[44:45], v1 offset:29792
  ds_read_b64_tr_b16 v[46:47], v1 offset:30304
  v_mfma_f32_16x16x32_bf16 v[132:135], v[20:23], v[208:211], v[132:135]
  ds_read_b64_tr_b16 v[16:17], v1 offset:30720
  s_add_u32 s73, s67, 0
  v_mfma_f32_16x16x32_bf16 v[136:139], v[20:23], v[212:215], v[136:139]
  ds_read_b64_tr_b16 v[18:19], v1 offset:31232
  s_add_u32 s73, s73, s47
  v_mfma_f32_16x16x32_bf16 v[140:143], v[24:27], v[208:211], v[140:143]
  ds_read_b64_tr_b16 v[20:21], v1 offset:30752
  s_add_u32 m0, s64, 14336
  v_mfma_f32_16x16x32_bf16 v[144:147], v[24:27], v[212:215], v[144:147]
  ds_read_b64_tr_b16 v[22:23], v1 offset:31264
  v_mfma_f32_16x16x32_bf16 v[148:151], v[28:31], v[208:211], v[148:151]
  ds_read_b64_tr_b16 v[24:25], v1 offset:31744
  v_mfma_f32_16x16x32_bf16 v[152:155], v[28:31], v[212:215], v[152:155]
  ds_read_b64_tr_b16 v[26:27], v1 offset:32256
  s_waitcnt lgkmcnt(6)
  v_mfma_f32_16x16x32_bf16 v[252:255], v[32:35], a[224:227], v[252:255]
  buffer_load_dwordx4 v7, s[32:35], s73 offen offset:0 lds
  v_mfma_f32_16x16x32_bf16 v[128:131], v[32:35], a[228:231], v[128:131]
  ds_read_b64_tr_b16 v[28:29], v1 offset:31776
  ds_read_b64_tr_b16 v[30:31], v1 offset:32288
  v_mfma_f32_16x16x32_bf16 v[132:135], v[36:39], a[224:227], v[132:135]
  ds_read_b64_tr_b16 v[32:33], v1 offset:30784
  s_add_u32 s73, s67, 73728
  v_mfma_f32_16x16x32_bf16 v[136:139], v[36:39], a[228:231], v[136:139]
  ds_read_b64_tr_b16 v[34:35], v1 offset:31296
  s_add_u32 s73, s73, s47
  v_mfma_f32_16x16x32_bf16 v[140:143], v[40:43], a[224:227], v[140:143]
  ds_read_b64_tr_b16 v[36:37], v1 offset:30816
  s_add_u32 m0, s64, 15360
  v_mfma_f32_16x16x32_bf16 v[144:147], v[40:43], a[228:231], v[144:147]
  ds_read_b64_tr_b16 v[38:39], v1 offset:31328
  v_mfma_f32_16x16x32_bf16 v[148:151], v[44:47], a[224:227], v[148:151]
  ds_read_b64_tr_b16 v[40:41], v1 offset:31808
  v_mfma_f32_16x16x32_bf16 v[152:155], v[44:47], a[228:231], v[152:155]
  ds_read_b64_tr_b16 v[42:43], v1 offset:32320
  s_waitcnt lgkmcnt(6)
  v_mfma_f32_16x16x32_bf16 v[252:255], v[16:19], a[248:251], v[252:255]
  buffer_load_dwordx4 v7, s[32:35], s73 offen offset:0 lds
  v_mfma_f32_16x16x32_bf16 v[128:131], v[16:19], a[252:255], v[128:131]
  ds_read_b64_tr_b16 v[44:45], v1 offset:31840
  ds_read_b64_tr_b16 v[46:47], v1 offset:32352
  v_mfma_f32_16x16x32_bf16 v[132:135], v[20:23], a[248:251], v[132:135]
  ds_read_b64_tr_b16 v[16:17], v2 offset:32768
  s_add_u32 s73, s66, 147456
  v_mfma_f32_16x16x32_bf16 v[136:139], v[20:23], a[252:255], v[136:139]
  ds_read_b64_tr_b16 v[18:19], v2 offset:33280
  s_add_u32 s73, s73, s47
  v_mfma_f32_16x16x32_bf16 v[252:255], v[24:27], v[176:179], v[252:255]
  ds_read_b64_tr_b16 v[20:21], v2 offset:32800
  s_add_u32 m0, s64, 16384
  v_mfma_f32_16x16x32_bf16 v[128:131], v[24:27], v[180:183], v[128:131]
ffn_hop86:
  s_cbranch_execz ffn_hop87
  ds_read_b64_tr_b16 v[22:23], v2 offset:33312
  v_mfma_f32_16x16x32_bf16 v[132:135], v[28:31], v[176:179], v[132:135]
  ds_read_b64_tr_b16 v[24:25], v3 offset:32768
  v_mfma_f32_16x16x32_bf16 v[136:139], v[28:31], v[180:183], v[136:139]
  ds_read_b64_tr_b16 v[26:27], v3 offset:33280
  s_waitcnt lgkmcnt(6)
  v_mfma_f32_16x16x32_bf16 v[140:143], v[32:35], a[248:251], v[140:143]
  buffer_load_dwordx4 v7, s[32:35], s73 offen offset:0 lds
  s_waitcnt vmcnt(5)
  v_cmp_eq_u32 vcc, 0, v184
  v_mfma_f32_16x16x32_bf16 v[144:147], v[32:35], a[252:255], v[144:147]
  ds_read_b64_tr_b16 v[28:29], v3 offset:32800
  ds_read_b64_tr_b16 v[30:31], v3 offset:33312
  v_mfma_f32_16x16x32_bf16 v[148:151], v[36:39], a[248:251], v[148:151]
  ds_read_b64_tr_b16 v[32:33], v2 offset:33792
  s_add_u32 s73, s66, 221184
  s_and_b32 s48, vcc_lo, s4
  s_cselect_b32 s48, 0x80000000, 0
  v_mfma_f32_16x16x32_bf16 v[152:155], v[36:39], a[252:255], v[152:155]
  ds_read_b64_tr_b16 v[34:35], v2 offset:34304
  s_add_u32 s73, s73, s47
  v_mfma_f32_16x16x32_bf16 v[140:143], v[40:43], v[176:179], v[140:143]
  ds_read_b64_tr_b16 v[36:37], v2 offset:33824
  s_add_u32 m0, s64, 17408
  v_mfma_f32_16x16x32_bf16 v[144:147], v[40:43], v[180:183], v[144:147]
  ds_read_b64_tr_b16 v[38:39], v2 offset:34336
  s_lshl_b32 s78, s38, 5
  v_or_b32 v248, s48, v207
  v_mfma_f32_16x16x32_bf16 v[148:151], v[44:47], v[176:179], v[148:151]
  ds_read_b64_tr_b16 v[40:41], v3 offset:33792
  v_cvt_pk_bf16_f32 v56, v252, v253
  v_cvt_pk_bf16_f32 v57, v254, v255
  v_mfma_f32_16x16x32_bf16 v[152:155], v[44:47], v[180:183], v[152:155]
  ds_read_b64_tr_b16 v[42:43], v3 offset:34304
  buffer_load_dwordx4 a[144:147], v248, s[24:27], s22 offen offset:0 sc1 nt
  v_cvt_pk_bf16_f32 v58, v132, v133
  s_waitcnt lgkmcnt(6)
  v_mfma_f32_16x16x32_bf16 v[172:175], v[16:19], v[80:83], 0
  buffer_load_dwordx4 v7, s[32:35], s73 offen offset:0 lds
  v_cvt_pk_bf16_f32 v59, v134, v135
  v_mfma_f32_16x16x32_bf16 v[168:171], v[16:19], v[84:87], 0
  ds_read_b64_tr_b16 v[44:45], v3 offset:33824
  ds_read_b64_tr_b16 v[46:47], v3 offset:34336
  buffer_store_dwordx4 v[56:59], v8, s[56:59], s78 offen offset:0 sc1
  v_mfma_f32_16x16x32_bf16 v[164:167], v[20:23], v[80:83], 0
  s_barrier
  ds_read_b64_tr_b16 v[16:17], v2 offset:34816
  v_mfma_f32_16x16x32_bf16 v[160:163], v[20:23], v[84:87], 0
  ds_read_b64_tr_b16 v[18:19], v2 offset:35328
  s_add_u32 s73, s67, 147456
  v_cvt_pk_bf16_f32 v72, v128, v129
  v_mfma_f32_16x16x32_bf16 v[172:175], v[24:27], v[88:91], v[172:175]
  buffer_load_dwordx4 a[148:151], v248, s[24:27], s22 offen offset:1024 sc1 nt
  v_cvt_pk_bf16_f32 v73, v130, v131
  v_mfma_f32_16x16x32_bf16 v[168:171], v[24:27], v[92:95], v[168:171]
  ds_read_b64_tr_b16 v[20:21], v2 offset:34848
  ds_read_b64_tr_b16 v[22:23], v2 offset:35360
  v_cvt_pk_bf16_f32 v74, v136, v137
  v_mfma_f32_16x16x32_bf16 v[164:167], v[28:31], v[88:91], v[164:167]
  ds_read_b64_tr_b16 v[24:25], v3 offset:34816
  v_cvt_pk_bf16_f32 v75, v138, v139
  buffer_store_dwordx4 v[72:75], v8, s[56:59], s78 offen offset:1024 sc1
  v_mfma_f32_16x16x32_bf16 v[160:163], v[28:31], v[92:95], v[160:163]
  ds_read_b64_tr_b16 v[26:27], v3 offset:35328
  s_waitcnt lgkmcnt(6)
  v_mfma_f32_16x16x32_bf16 v[172:175], v[32:35], v[96:99], v[172:175]
  ds_read_b64_tr_b16 v[28:29], v3 offset:34848
  s_add_u32 s73, s73, s47
  v_cvt_pk_bf16_f32 v60, v140, v141
ffn_hop87:
  s_cbranch_execz ffn_hop88
  v_mfma_f32_16x16x32_bf16 v[168:171], v[32:35], v[100:103], v[168:171]
  buffer_load_dwordx4 a[152:155], v248, s[24:27], s23 offen offset:0 sc1 nt
  v_mfma_f32_16x16x32_bf16 v[164:167], v[36:39], v[96:99], v[164:167]
  ds_read_b64_tr_b16 v[30:31], v3 offset:35360
  ds_read_b64_tr_b16 v[32:33], v2 offset:35840
  v_cvt_pk_bf16_f32 v61, v142, v143
  v_mfma_f32_16x16x32_bf16 v[160:163], v[36:39], v[100:103], v[160:163]
  ds_read_b64_tr_b16 v[34:35], v2 offset:36352
  v_cvt_pk_bf16_f32 v62, v148, v149
  v_cvt_pk_bf16_f32 v63, v150, v151
  v_mfma_f32_16x16x32_bf16 v[172:175], v[40:43], v[104:107], v[172:175]
  ds_read_b64_tr_b16 v[36:37], v2 offset:35872
  buffer_store_dwordx4 v[60:63], v8, s[56:59], s78 offen offset:2048 sc1
  v_mfma_f32_16x16x32_bf16 v[168:171], v[40:43], v[108:111], v[168:171]
  ds_read_b64_tr_b16 v[38:39], v2 offset:36384
  v_cvt_pk_bf16_f32 v76, v144, v145
  v_mfma_f32_16x16x32_bf16 v[164:167], v[44:47], v[104:107], v[164:167]
  ds_read_b64_tr_b16 v[40:41], v3 offset:35840
  s_add_u32 m0, s64, 18432
  v_cvt_pk_bf16_f32 v77, v146, v147
  v_mfma_f32_16x16x32_bf16 v[160:163], v[44:47], v[108:111], v[160:163]
  ds_read_b64_tr_b16 v[42:43], v3 offset:36352
  v_cvt_pk_bf16_f32 v78, v152, v153
  s_waitcnt lgkmcnt(6)
  v_mfma_f32_16x16x32_bf16 v[172:175], v[16:19], a[192:195], v[172:175]
  buffer_load_dwordx4 a[156:159], v248, s[24:27], s23 offen offset:1024 sc1 nt
  v_mfma_f32_16x16x32_bf16 v[168:171], v[16:19], a[196:199], v[168:171]
  ds_read_b64_tr_b16 v[44:45], v3 offset:35872
  ds_read_b64_tr_b16 v[46:47], v3 offset:36384
  v_cvt_pk_bf16_f32 v79, v154, v155
  v_mfma_f32_16x16x32_bf16 v[164:167], v[20:23], a[192:195], v[164:167]
  ds_read_b64_tr_b16 v[16:17], v2 offset:36864
  buffer_store_dwordx4 v[76:79], v8, s[56:59], s78 offen offset:3072 sc1
  v_mfma_f32_16x16x32_bf16 v[160:163], v[20:23], a[196:199], v[160:163]
  buffer_load_dwordx4 v7, s[32:35], s73 offen offset:0 lds
  v_mfma_f32_16x16x32_bf16 v[172:175], v[24:27], a[200:203], v[172:175]
  ds_read_b64_tr_b16 v[18:19], v2 offset:37376
  ds_read_b64_tr_b16 v[20:21], v2 offset:36896
  v_mfma_f32_16x16x32_bf16 v[168:171], v[24:27], a[204:207], v[168:171]
  ds_read_b64_tr_b16 v[22:23], v2 offset:37408
  v_mfma_f32_16x16x32_bf16 v[164:167], v[28:31], a[200:203], v[164:167]
  ds_read_b64_tr_b16 v[24:25], v3 offset:36864
  v_mfma_f32_16x16x32_bf16 v[160:163], v[28:31], a[204:207], v[160:163]
  ds_read_b64_tr_b16 v[26:27], v3 offset:37376
  s_waitcnt lgkmcnt(6)
  v_mfma_f32_16x16x32_bf16 v[172:175], v[32:35], a[208:211], v[172:175]
  ds_read_b64_tr_b16 v[28:29], v3 offset:36896
  v_mfma_f32_16x16x32_bf16 v[168:171], v[32:35], a[212:215], v[168:171]
  ds_read_b64_tr_b16 v[30:31], v3 offset:37408
  s_add_u32 s73, s71, s47
  v_mfma_f32_16x16x32_bf16 v[164:167], v[36:39], a[208:211], v[164:167]
  ds_read_b64_tr_b16 v[32:33], v2 offset:37888
  v_mfma_f32_16x16x32_bf16 v[160:163], v[36:39], a[212:215], v[160:163]
  ds_read_b64_tr_b16 v[34:35], v2 offset:38400
  v_mfma_f32_16x16x32_bf16 v[172:175], v[40:43], a[216:219], v[172:175]
  v_mov_b32 v185, 0
  buffer_atomic_or v185, v204, s[60:63], 0 offen offset:16 sc0
  v_mfma_f32_16x16x32_bf16 v[168:171], v[40:43], a[220:223], v[168:171]
  ds_read_b64_tr_b16 v[36:37], v2 offset:37920
  ds_read_b64_tr_b16 v[38:39], v2 offset:38432
  v_mfma_f32_16x16x32_bf16 v[164:167], v[44:47], a[216:219], v[164:167]
  ds_read_b64_tr_b16 v[40:41], v3 offset:37888
  s_add_u32 m0, s64, 19456
  v_mfma_f32_16x16x32_bf16 v[160:163], v[44:47], a[220:223], v[160:163]
  ds_read_b64_tr_b16 v[42:43], v3 offset:38400
  s_waitcnt lgkmcnt(6)
  v_mfma_f32_16x16x32_bf16 v[172:175], v[16:19], v[216:219], v[172:175]
  ds_read_b64_tr_b16 v[44:45], v3 offset:37920
  v_mfma_f32_16x16x32_bf16 v[168:171], v[16:19], v[220:223], v[168:171]
  ds_read_b64_tr_b16 v[46:47], v3 offset:38432
ffn_hop88:
  s_cbranch_execz ffn_hop89
  v_mfma_f32_16x16x32_bf16 v[164:167], v[20:23], v[216:219], v[164:167]
  ds_read_b64_tr_b16 v[16:17], v2 offset:0
  v_mfma_f32_16x16x32_bf16 v[160:163], v[20:23], v[220:223], v[160:163]
  ds_read_b64_tr_b16 v[18:19], v2 offset:512
  v_mfma_f32_16x16x32_bf16 v[172:175], v[24:27], v[224:227], v[172:175]
  buffer_load_dwordx4 v7, s[32:35], s73 offen offset:0 lds
  v_mfma_f32_16x16x32_bf16 v[168:171], v[24:27], v[228:231], v[168:171]
  ds_read_b64_tr_b16 v[20:21], v2 offset:32
  ds_read_b64_tr_b16 v[22:23], v2 offset:544
  v_mfma_f32_16x16x32_bf16 v[164:167], v[28:31], v[224:227], v[164:167]
  ds_read_b64_tr_b16 v[24:25], v3 offset:0
  v_mfma_f32_16x16x32_bf16 v[160:163], v[28:31], v[228:231], v[160:163]
  ds_read_b64_tr_b16 v[26:27], v3 offset:512
  s_waitcnt lgkmcnt(6)
  v_mfma_f32_16x16x32_bf16 v[172:175], v[32:35], v[112:115], v[172:175]
  ds_read_b64_tr_b16 v[28:29], v3 offset:32
  v_mfma_f32_16x16x32_bf16 v[168:171], v[32:35], v[116:119], v[168:171]
  ds_read_b64_tr_b16 v[30:31], v3 offset:544
  s_add_u32 s73, s67, 221184
  v_mfma_f32_16x16x32_bf16 v[164:167], v[36:39], v[112:115], v[164:167]
  ds_read_b64_tr_b16 v[32:33], v2 offset:1024
  v_mfma_f32_16x16x32_bf16 v[160:163], v[36:39], v[116:119], v[160:163]
  ds_read_b64_tr_b16 v[34:35], v2 offset:1536
  v_mfma_f32_16x16x32_bf16 v[172:175], v[40:43], v[120:123], v[172:175]
  ds_read_b64_tr_b16 v[36:37], v2 offset:1056
  v_mfma_f32_16x16x32_bf16 v[168:171], v[40:43], v[124:127], v[168:171]
  ds_read_b64_tr_b16 v[38:39], v2 offset:1568
  v_mfma_f32_16x16x32_bf16 v[164:167], v[44:47], v[120:123], v[164:167]
  ds_read_b64_tr_b16 v[40:41], v3 offset:1024
  v_mfma_f32_16x16x32_bf16 v[160:163], v[44:47], v[124:127], v[160:163]
  ds_read_b64_tr_b16 v[42:43], v3 offset:1536
  s_waitcnt lgkmcnt(6)
  v_mfma_f32_16x16x32_bf16 v[172:175], v[16:19], a[232:235], v[172:175]
  ds_read_b64_tr_b16 v[44:45], v3 offset:1056
  s_add_u32 s73, s73, s47
  v_mfma_f32_16x16x32_bf16 v[168:171], v[16:19], a[236:239], v[168:171]
  s_waitcnt vmcnt(3)
  buffer_store_dword v5, off, s[60:63], s84 offset:20 sc1
  v_mfma_f32_16x16x32_bf16 v[164:167], v[20:23], a[232:235], v[164:167]
  ds_read_b64_tr_b16 v[46:47], v3 offset:1568
  ds_read_b64_tr_b16 v[16:17], v2 offset:2048
  v_mfma_f32_16x16x32_bf16 v[160:163], v[20:23], a[236:239], v[160:163]
  ds_read_b64_tr_b16 v[18:19], v2 offset:2560
  v_mfma_f32_16x16x32_bf16 v[172:175], v[24:27], a[240:243], v[172:175]
  ds_read_b64_tr_b16 v[20:21], v2 offset:2080
  s_add_u32 m0, s64, 20480
  v_mfma_f32_16x16x32_bf16 v[168:171], v[24:27], a[244:247], v[168:171]
  ds_read_b64_tr_b16 v[22:23], v2 offset:2592
  v_mfma_f32_16x16x32_bf16 v[164:167], v[28:31], a[240:243], v[164:167]
  ds_read_b64_tr_b16 v[24:25], v3 offset:2048
  v_mfma_f32_16x16x32_bf16 v[160:163], v[28:31], a[244:247], v[160:163]
  ds_read_b64_tr_b16 v[26:27], v3 offset:2560
  s_waitcnt lgkmcnt(6)
  v_mfma_f32_16x16x32_bf16 v[172:175], v[32:35], v[208:211], v[172:175]
  ds_read_b64_tr_b16 v[28:29], v3 offset:2080
  v_mfma_f32_16x16x32_bf16 v[168:171], v[32:35], v[212:215], v[168:171]
  ds_read_b64_tr_b16 v[30:31], v3 offset:2592
  v_mfma_f32_16x16x32_bf16 v[164:167], v[36:39], v[208:211], v[164:167]
  buffer_load_dwordx4 v7, s[32:35], s73 offen offset:0 lds
  v_mfma_f32_16x16x32_bf16 v[160:163], v[36:39], v[212:215], v[160:163]
  ds_read_b64_tr_b16 v[32:33], v2 offset:3072
  ds_read_b64_tr_b16 v[34:35], v2 offset:3584
  v_mfma_f32_16x16x32_bf16 v[172:175], v[40:43], a[224:227], v[172:175]
  ds_read_b64_tr_b16 v[36:37], v2 offset:3104
  v_mfma_f32_16x16x32_bf16 v[168:171], v[40:43], a[228:231], v[168:171]
  ds_read_b64_tr_b16 v[38:39], v2 offset:3616
ffn_hop89:
  s_cbranch_execz ffn_hop90
  v_mfma_f32_16x16x32_bf16 v[164:167], v[44:47], a[224:227], v[164:167]
  ds_read_b64_tr_b16 v[40:41], v3 offset:3072
  v_mfma_f32_16x16x32_bf16 v[160:163], v[44:47], a[228:231], v[160:163]
  ds_read_b64_tr_b16 v[42:43], v3 offset:3584
  s_waitcnt lgkmcnt(6)
  v_mfma_f32_16x16x32_bf16 v[172:175], v[16:19], a[248:251], v[172:175]
  ds_read_b64_tr_b16 v[44:45], v3 offset:3104
  s_waitcnt vmcnt(3)
  v_cmp_eq_u32 vcc, 0, v185
  v_mfma_f32_16x16x32_bf16 v[168:171], v[16:19], a[252:255], v[168:171]
  ds_read_b64_tr_b16 v[46:47], v3 offset:3616
  v_mfma_f32_16x16x32_bf16 v[164:167], v[20:23], a[248:251], v[164:167]
  s_barrier
  ds_read_b64_tr_b16 v[16:17], v2 offset:4096
  v_mfma_f32_16x16x32_bf16 v[160:163], v[20:23], a[252:255], v[160:163]
  s_and_b32 s49, vcc_lo, s5
  s_cselect_b32 s49, 0x80000000, 0
  v_mfma_f32_16x16x32_bf16 v[172:175], v[24:27], v[176:179], v[172:175]
  ds_read_b64_tr_b16 v[18:19], v2 offset:4608
  ds_read_b64_tr_b16 v[20:21], v2 offset:4128
  v_mfma_f32_16x16x32_bf16 v[168:171], v[24:27], v[180:183], v[168:171]
  ds_read_b64_tr_b16 v[22:23], v2 offset:4640
  v_or_b32 v248, s49, v207
  v_mfma_f32_16x16x32_bf16 v[164:167], v[28:31], v[176:179], v[164:167]
  ds_read_b64_tr_b16 v[24:25], v3 offset:4096
  v_mfma_f32_16x16x32_bf16 v[160:163], v[28:31], v[180:183], v[160:163]
  ds_read_b64_tr_b16 v[26:27], v3 offset:4608
  s_waitcnt lgkmcnt(6)
  v_mfma_f32_16x16x32_bf16 v[252:255], v[32:35], v[80:83], 0
  buffer_load_dwordx4 a[160:163], v248, s[24:27], s44 offen offset:0 sc1 nt
  v_mfma_f32_16x16x32_bf16 v[128:131], v[32:35], v[84:87], 0
  ds_read_b64_tr_b16 v[28:29], v3 offset:4128
  ds_read_b64_tr_b16 v[30:31], v3 offset:4640
  v_mfma_f32_16x16x32_bf16 v[132:135], v[36:39], v[80:83], 0
  ds_read_b64_tr_b16 v[32:33], v2 offset:5120
  v_mfma_f32_16x16x32_bf16 v[136:139], v[36:39], v[84:87], 0
  ds_read_b64_tr_b16 v[34:35], v2 offset:5632
  v_mfma_f32_16x16x32_bf16 v[252:255], v[40:43], v[88:91], v[252:255]
  buffer_load_dwordx4 a[164:167], v248, s[24:27], s44 offen offset:1024 sc1 nt
  v_mfma_f32_16x16x32_bf16 v[128:131], v[40:43], v[92:95], v[128:131]
  ds_read_b64_tr_b16 v[36:37], v2 offset:5152
  ds_read_b64_tr_b16 v[38:39], v2 offset:5664
  v_cvt_pk_bf16_f32 v56, v172, v173
  v_mfma_f32_16x16x32_bf16 v[132:135], v[44:47], v[88:91], v[132:135]
  ds_read_b64_tr_b16 v[40:41], v3 offset:5120
  v_cvt_pk_bf16_f32 v57, v174, v175
  v_cvt_pk_bf16_f32 v58, v164, v165
  v_mfma_f32_16x16x32_bf16 v[136:139], v[44:47], v[92:95], v[136:139]
  ds_read_b64_tr_b16 v[42:43], v3 offset:5632
  s_waitcnt lgkmcnt(6)
  v_mfma_f32_16x16x32_bf16 v[252:255], v[16:19], v[96:99], v[252:255]
  buffer_load_dwordx4 a[168:171], v248, s[24:27], s45 offen offset:0 sc1 nt
  v_cvt_pk_bf16_f32 v59, v166, v167
  v_mfma_f32_16x16x32_bf16 v[128:131], v[16:19], v[100:103], v[128:131]
  ds_read_b64_tr_b16 v[44:45], v3 offset:5152
  ds_read_b64_tr_b16 v[46:47], v3 offset:5664
  buffer_store_dwordx4 v[56:59], v8, s[56:59], s83 offen offset:0 sc1
  v_mfma_f32_16x16x32_bf16 v[132:135], v[20:23], v[96:99], v[132:135]
  ds_read_b64_tr_b16 v[16:17], v2 offset:6144
  v_cvt_pk_bf16_f32 v72, v168, v169
  v_mfma_f32_16x16x32_bf16 v[136:139], v[20:23], v[100:103], v[136:139]
  ds_read_b64_tr_b16 v[18:19], v2 offset:6656
  v_cvt_pk_bf16_f32 v73, v170, v171
ffn_hop90:
  s_cbranch_execz ffn_hop91
  v_mfma_f32_16x16x32_bf16 v[252:255], v[24:27], v[104:107], v[252:255]
  buffer_load_dwordx4 a[172:175], v248, s[24:27], s45 offen offset:1024 sc1 nt
  v_cvt_pk_bf16_f32 v74, v160, v161
  v_mfma_f32_16x16x32_bf16 v[128:131], v[24:27], v[108:111], v[128:131]
  ds_read_b64_tr_b16 v[20:21], v2 offset:6176
  ds_read_b64_tr_b16 v[22:23], v2 offset:6688
  v_mfma_f32_16x16x32_bf16 v[132:135], v[28:31], v[104:107], v[132:135]
  ds_read_b64_tr_b16 v[24:25], v3 offset:6144
  v_cvt_pk_bf16_f32 v75, v162, v163
  buffer_store_dwordx4 v[72:75], v8, s[56:59], s83 offen offset:1024 sc1
  v_mfma_f32_16x16x32_bf16 v[136:139], v[28:31], v[108:111], v[136:139]
  ds_read_b64_tr_b16 v[26:27], v3 offset:6656
  s_waitcnt lgkmcnt(6)
  v_mfma_f32_16x16x32_bf16 v[252:255], v[32:35], a[192:195], v[252:255]
  ds_read_b64_tr_b16 v[28:29], v3 offset:6176
  v_mfma_f32_16x16x32_bf16 v[128:131], v[32:35], a[196:199], v[128:131]
  ds_read_b64_tr_b16 v[30:31], v3 offset:6688
  v_mfma_f32_16x16x32_bf16 v[132:135], v[36:39], a[192:195], v[132:135]
  ds_read_b64_tr_b16 v[32:33], v2 offset:7168
  v_mfma_f32_16x16x32_bf16 v[136:139], v[36:39], a[196:199], v[136:139]
  ds_read_b64_tr_b16 v[34:35], v2 offset:7680
  v_mfma_f32_16x16x32_bf16 v[252:255], v[40:43], a[200:203], v[252:255]
  ds_read_b64_tr_b16 v[36:37], v2 offset:7200
  v_mfma_f32_16x16x32_bf16 v[128:131], v[40:43], a[204:207], v[128:131]
  ds_read_b64_tr_b16 v[38:39], v2 offset:7712
  v_mfma_f32_16x16x32_bf16 v[132:135], v[44:47], a[200:203], v[132:135]
  ds_read_b64_tr_b16 v[40:41], v3 offset:7168
  v_mfma_f32_16x16x32_bf16 v[136:139], v[44:47], a[204:207], v[136:139]
  ds_read_b64_tr_b16 v[42:43], v3 offset:7680
  s_waitcnt lgkmcnt(6)
  v_mfma_f32_16x16x32_bf16 v[252:255], v[16:19], a[208:211], v[252:255]
  ds_read_b64_tr_b16 v[44:45], v3 offset:7200
  v_mfma_f32_16x16x32_bf16 v[128:131], v[16:19], a[212:215], v[128:131]
  ds_read_b64_tr_b16 v[46:47], v3 offset:7712
  v_mfma_f32_16x16x32_bf16 v[132:135], v[20:23], a[208:211], v[132:135]
  ds_read_b64_tr_b16 v[16:17], v2 offset:8192
  v_mfma_f32_16x16x32_bf16 v[136:139], v[20:23], a[212:215], v[136:139]
  s_lshl_b32 s3, s74, 12
  buffer_load_dwordx4 v[236:239], v205, s[40:43], s3 offen
  v_mfma_f32_16x16x32_bf16 v[252:255], v[24:27], a[216:219], v[252:255]
  ds_read_b64_tr_b16 v[18:19], v2 offset:8704
  ds_read_b64_tr_b16 v[20:21], v2 offset:8224
  v_mfma_f32_16x16x32_bf16 v[128:131], v[24:27], a[220:223], v[128:131]
  ds_read_b64_tr_b16 v[22:23], v2 offset:8736
  v_mfma_f32_16x16x32_bf16 v[132:135], v[28:31], a[216:219], v[132:135]
  ds_read_b64_tr_b16 v[24:25], v3 offset:8192
  v_mfma_f32_16x16x32_bf16 v[136:139], v[28:31], a[220:223], v[136:139]
  ds_read_b64_tr_b16 v[26:27], v3 offset:8704
  s_waitcnt lgkmcnt(6)
  v_mfma_f32_16x16x32_bf16 v[252:255], v[32:35], v[216:219], v[252:255]
  s_add_u32 s3, s3, 65536
  buffer_load_dwordx4 v[240:243], v205, s[40:43], s3 offen
  v_mfma_f32_16x16x32_bf16 v[128:131], v[32:35], v[220:223], v[128:131]
  ds_read_b64_tr_b16 v[28:29], v3 offset:8224
  ds_read_b64_tr_b16 v[30:31], v3 offset:8736
  v_mfma_f32_16x16x32_bf16 v[132:135], v[36:39], v[216:219], v[132:135]
  ds_read_b64_tr_b16 v[32:33], v2 offset:9216
  v_mfma_f32_16x16x32_bf16 v[136:139], v[36:39], v[220:223], v[136:139]
  s_lshl_b32 s3, s75, 12
  buffer_load_dwordx2 v[244:245], v233, s[40:43], s3 offen
  v_mfma_f32_16x16x32_bf16 v[252:255], v[40:43], v[224:227], v[252:255]
  ds_read_b64_tr_b16 v[34:35], v2 offset:9728
  ds_read_b64_tr_b16 v[36:37], v2 offset:9248
  v_mfma_f32_16x16x32_bf16 v[128:131], v[40:43], v[228:231], v[128:131]
  ds_read_b64_tr_b16 v[38:39], v2 offset:9760
  v_mfma_f32_16x16x32_bf16 v[132:135], v[44:47], v[224:227], v[132:135]
ffn_hop91:
  s_cbranch_execz ffn_hop92
  ds_read_b64_tr_b16 v[40:41], v3 offset:9216
  v_mfma_f32_16x16x32_bf16 v[136:139], v[44:47], v[228:231], v[136:139]
  ds_read_b64_tr_b16 v[42:43], v3 offset:9728
  s_waitcnt lgkmcnt(6)
  v_mfma_f32_16x16x32_bf16 v[252:255], v[16:19], v[112:115], v[252:255]
  s_add_u32 s3, s3, 65536
  buffer_load_dwordx2 v[246:247], v233, s[40:43], s3 offen
  v_mfma_f32_16x16x32_bf16 v[128:131], v[16:19], v[116:119], v[128:131]
  ds_read_b64_tr_b16 v[44:45], v3 offset:9248
  ds_read_b64_tr_b16 v[46:47], v3 offset:9760
  v_mfma_f32_16x16x32_bf16 v[132:135], v[20:23], v[112:115], v[132:135]
  ds_read_b64_tr_b16 v[16:17], v2 offset:10240
  v_mfma_f32_16x16x32_bf16 v[136:139], v[20:23], v[116:119], v[136:139]
  ds_read_b64_tr_b16 v[18:19], v2 offset:10752
  v_mfma_f32_16x16x32_bf16 v[252:255], v[24:27], v[120:123], v[252:255]
  ds_read_b64_tr_b16 v[20:21], v2 offset:10272
  v_mfma_f32_16x16x32_bf16 v[128:131], v[24:27], v[124:127], v[128:131]
  s_waitcnt vmcnt(4)
  buffer_store_dword v5, off, s[60:63], s84 offset:24 sc1
  v_mfma_f32_16x16x32_bf16 v[132:135], v[28:31], v[120:123], v[132:135]
  ds_read_b64_tr_b16 v[22:23], v2 offset:10784
  ds_read_b64_tr_b16 v[24:25], v3 offset:10240
  v_mfma_f32_16x16x32_bf16 v[136:139], v[28:31], v[124:127], v[136:139]
  ds_read_b64_tr_b16 v[26:27], v3 offset:10752
  s_waitcnt lgkmcnt(6)
  v_mfma_f32_16x16x32_bf16 v[252:255], v[32:35], a[232:235], v[252:255]
  ds_read_b64_tr_b16 v[28:29], v3 offset:10272
  v_mfma_f32_16x16x32_bf16 v[128:131], v[32:35], a[236:239], v[128:131]
  ds_read_b64_tr_b16 v[30:31], v3 offset:10784
  v_mfma_f32_16x16x32_bf16 v[132:135], v[36:39], a[232:235], v[132:135]
  ds_read_b64_tr_b16 v[32:33], v2 offset:11264
  v_mfma_f32_16x16x32_bf16 v[136:139], v[36:39], a[236:239], v[136:139]
  ds_read_b64_tr_b16 v[34:35], v2 offset:11776
  v_mfma_f32_16x16x32_bf16 v[252:255], v[40:43], a[240:243], v[252:255]
  ds_read_b64_tr_b16 v[36:37], v2 offset:11296
  v_mfma_f32_16x16x32_bf16 v[128:131], v[40:43], a[244:247], v[128:131]
  ds_read_b64_tr_b16 v[38:39], v2 offset:11808
  v_mfma_f32_16x16x32_bf16 v[132:135], v[44:47], a[240:243], v[132:135]
  ds_read_b64_tr_b16 v[40:41], v3 offset:11264
  v_mfma_f32_16x16x32_bf16 v[136:139], v[44:47], a[244:247], v[136:139]
  ds_read_b64_tr_b16 v[42:43], v3 offset:11776
  s_waitcnt lgkmcnt(6)
  v_mfma_f32_16x16x32_bf16 v[252:255], v[16:19], v[208:211], v[252:255]
  ds_read_b64_tr_b16 v[44:45], v3 offset:11296
  v_mfma_f32_16x16x32_bf16 v[128:131], v[16:19], v[212:215], v[128:131]
  ds_read_b64_tr_b16 v[46:47], v3 offset:11808
  v_mfma_f32_16x16x32_bf16 v[132:135], v[20:23], v[208:211], v[132:135]
  s_barrier
  ds_read_b64_tr_b16 v[16:17], v2 offset:12288
  v_mfma_f32_16x16x32_bf16 v[136:139], v[20:23], v[212:215], v[136:139]
  ds_read_b64_tr_b16 v[18:19], v2 offset:12800
  v_mfma_f32_16x16x32_bf16 v[252:255], v[24:27], a[224:227], v[252:255]
  ds_read_b64_tr_b16 v[20:21], v2 offset:12320
  v_mfma_f32_16x16x32_bf16 v[128:131], v[24:27], a[228:231], v[128:131]
  ds_read_b64_tr_b16 v[22:23], v2 offset:12832
  v_mfma_f32_16x16x32_bf16 v[132:135], v[28:31], a[224:227], v[132:135]
  ds_read_b64_tr_b16 v[24:25], v3 offset:12288
  v_mfma_f32_16x16x32_bf16 v[136:139], v[28:31], a[228:231], v[136:139]
  ds_read_b64_tr_b16 v[26:27], v3 offset:12800
  s_waitcnt lgkmcnt(6)
  v_mfma_f32_16x16x32_bf16 v[252:255], v[32:35], a[248:251], v[252:255]
  ds_read_b64_tr_b16 v[28:29], v3 offset:12320
  v_mfma_f32_16x16x32_bf16 v[128:131], v[32:35], a[252:255], v[128:131]
  ds_read_b64_tr_b16 v[30:31], v3 offset:12832
  v_mfma_f32_16x16x32_bf16 v[132:135], v[36:39], a[248:251], v[132:135]
  ds_read_b64_tr_b16 v[32:33], v2 offset:13312
  v_mfma_f32_16x16x32_bf16 v[136:139], v[36:39], a[252:255], v[136:139]
ffn_hop92:
  s_cbranch_execz ffn_hop93
  ds_read_b64_tr_b16 v[34:35], v2 offset:13824
  v_mfma_f32_16x16x32_bf16 v[252:255], v[40:43], v[176:179], v[252:255]
  ds_read_b64_tr_b16 v[36:37], v2 offset:13344
  v_mfma_f32_16x16x32_bf16 v[128:131], v[40:43], v[180:183], v[128:131]
  ds_read_b64_tr_b16 v[38:39], v2 offset:13856
  v_mfma_f32_16x16x32_bf16 v[132:135], v[44:47], v[176:179], v[132:135]
  ds_read_b64_tr_b16 v[40:41], v3 offset:13312
  v_mfma_f32_16x16x32_bf16 v[136:139], v[44:47], v[180:183], v[136:139]
  ds_read_b64_tr_b16 v[42:43], v3 offset:13824
  s_waitcnt lgkmcnt(6)
  v_mfma_f32_16x16x32_bf16 v[172:175], v[16:19], v[80:83], 0
  ds_read_b64_tr_b16 v[44:45], v3 offset:13344
  v_mfma_f32_16x16x32_bf16 v[168:171], v[16:19], v[84:87], 0
  ds_read_b64_tr_b16 v[46:47], v3 offset:13856
  v_mfma_f32_16x16x32_bf16 v[164:167], v[20:23], v[80:83], 0
  ds_read_b64_tr_b16 v[16:17], v2 offset:14336
  v_mfma_f32_16x16x32_bf16 v[160:163], v[20:23], v[84:87], 0
  ds_read_b64_tr_b16 v[18:19], v2 offset:14848
  v_mfma_f32_16x16x32_bf16 v[172:175], v[24:27], v[88:91], v[172:175]
  ds_read_b64_tr_b16 v[20:21], v2 offset:14368
  s_xor_b32 s78, s18, 1
  v_mfma_f32_16x16x32_bf16 v[168:171], v[24:27], v[92:95], v[168:171]
  ds_read_b64_tr_b16 v[22:23], v2 offset:14880
  s_lshl_b32 s78, s78, 11
  v_mfma_f32_16x16x32_bf16 v[164:167], v[28:31], v[88:91], v[164:167]
  ds_read_b64_tr_b16 v[24:25], v3 offset:14336
  v_cvt_pk_bf16_f32 v60, v252, v253
  v_cvt_pk_bf16_f32 v61, v254, v255
  v_mfma_f32_16x16x32_bf16 v[160:163], v[28:31], v[92:95], v[160:163]
  ds_read_b64_tr_b16 v[26:27], v3 offset:14848
  s_waitcnt lgkmcnt(6)
  v_mfma_f32_16x16x32_bf16 v[172:175], v[32:35], v[96:99], v[172:175]
  ds_read_b64_tr_b16 v[28:29], v3 offset:14368
  v_cvt_pk_bf16_f32 v62, v132, v133
  v_mfma_f32_16x16x32_bf16 v[168:171], v[32:35], v[100:103], v[168:171]
  ds_read_b64_tr_b16 v[30:31], v3 offset:14880
  v_cvt_pk_bf16_f32 v63, v134, v135
  buffer_store_dwordx4 v[60:63], v8, s[56:59], s78 offen offset:0 sc1
  v_mfma_f32_16x16x32_bf16 v[164:167], v[36:39], v[96:99], v[164:167]
  ds_read_b64_tr_b16 v[32:33], v2 offset:15360
  v_cvt_pk_bf16_f32 v76, v128, v129
  v_mfma_f32_16x16x32_bf16 v[160:163], v[36:39], v[100:103], v[160:163]
  ds_read_b64_tr_b16 v[34:35], v2 offset:15872
  v_cvt_pk_bf16_f32 v77, v130, v131
  v_mfma_f32_16x16x32_bf16 v[172:175], v[40:43], v[104:107], v[172:175]
  ds_read_b64_tr_b16 v[36:37], v2 offset:15392
  v_cvt_pk_bf16_f32 v78, v136, v137
  v_mfma_f32_16x16x32_bf16 v[168:171], v[40:43], v[108:111], v[168:171]
  ds_read_b64_tr_b16 v[38:39], v2 offset:15904
  v_cvt_pk_bf16_f32 v79, v138, v139
  v_mfma_f32_16x16x32_bf16 v[164:167], v[44:47], v[104:107], v[164:167]
  ds_read_b64_tr_b16 v[40:41], v3 offset:15360
  buffer_store_dwordx4 v[76:79], v8, s[56:59], s78 offen offset:1024 sc1
  v_mfma_f32_16x16x32_bf16 v[160:163], v[44:47], v[108:111], v[160:163]
  ds_read_b64_tr_b16 v[42:43], v3 offset:15872
  s_waitcnt lgkmcnt(6)
  v_mfma_f32_16x16x32_bf16 v[172:175], v[16:19], a[192:195], v[172:175]
  v_mov_b32 v186, 0
  buffer_atomic_or v186, v204, s[60:63], 0 offen offset:20 sc0
  v_mfma_f32_16x16x32_bf16 v[168:171], v[16:19], a[196:199], v[168:171]
  ds_read_b64_tr_b16 v[44:45], v3 offset:15392
  ds_read_b64_tr_b16 v[46:47], v3 offset:15904
  v_mfma_f32_16x16x32_bf16 v[164:167], v[20:23], a[192:195], v[164:167]
  ds_read_b64_tr_b16 v[16:17], v2 offset:16384
  v_mfma_f32_16x16x32_bf16 v[160:163], v[20:23], a[196:199], v[160:163]
  ds_read_b64_tr_b16 v[18:19], v2 offset:16896
ffn_hop93:
  s_cbranch_execz ffn_hop94
  v_mfma_f32_16x16x32_bf16 v[172:175], v[24:27], a[200:203], v[172:175]
  ds_read_b64_tr_b16 v[20:21], v2 offset:16416
  v_mfma_f32_16x16x32_bf16 v[168:171], v[24:27], a[204:207], v[168:171]
  ds_read_b64_tr_b16 v[22:23], v2 offset:16928
  v_mfma_f32_16x16x32_bf16 v[164:167], v[28:31], a[200:203], v[164:167]
  ds_read_b64_tr_b16 v[24:25], v3 offset:16384
  v_mfma_f32_16x16x32_bf16 v[160:163], v[28:31], a[204:207], v[160:163]
  ds_read_b64_tr_b16 v[26:27], v3 offset:16896
  s_waitcnt lgkmcnt(6)
  v_mfma_f32_16x16x32_bf16 v[172:175], v[32:35], a[208:211], v[172:175]
  ds_read_b64_tr_b16 v[28:29], v3 offset:16416
  v_mfma_f32_16x16x32_bf16 v[168:171], v[32:35], a[212:215], v[168:171]
  ds_read_b64_tr_b16 v[30:31], v3 offset:16928
  v_mfma_f32_16x16x32_bf16 v[164:167], v[36:39], a[208:211], v[164:167]
  ds_read_b64_tr_b16 v[32:33], v2 offset:17408
  v_mfma_f32_16x16x32_bf16 v[160:163], v[36:39], a[212:215], v[160:163]
  ds_read_b64_tr_b16 v[34:35], v2 offset:17920
  v_mfma_f32_16x16x32_bf16 v[172:175], v[40:43], a[216:219], v[172:175]
  ds_read_b64_tr_b16 v[36:37], v2 offset:17440
  v_mfma_f32_16x16x32_bf16 v[168:171], v[40:43], a[220:223], v[168:171]
  ds_read_b64_tr_b16 v[38:39], v2 offset:17952
  v_mfma_f32_16x16x32_bf16 v[164:167], v[44:47], a[216:219], v[164:167]
  ds_read_b64_tr_b16 v[40:41], v3 offset:17408
  v_mfma_f32_16x16x32_bf16 v[160:163], v[44:47], a[220:223], v[160:163]
  ds_read_b64_tr_b16 v[42:43], v3 offset:17920
  s_waitcnt lgkmcnt(6)
  v_mfma_f32_16x16x32_bf16 v[172:175], v[16:19], v[216:219], v[172:175]
  ds_read_b64_tr_b16 v[44:45], v3 offset:17440
  v_mfma_f32_16x16x32_bf16 v[168:171], v[16:19], v[220:223], v[168:171]
  ds_read_b64_tr_b16 v[46:47], v3 offset:17952
  v_mfma_f32_16x16x32_bf16 v[164:167], v[20:23], v[216:219], v[164:167]
  ds_read_b64_tr_b16 v[16:17], v2 offset:18432
  v_mfma_f32_16x16x32_bf16 v[160:163], v[20:23], v[220:223], v[160:163]
  ds_read_b64_tr_b16 v[18:19], v2 offset:18944
  v_mfma_f32_16x16x32_bf16 v[172:175], v[24:27], v[224:227], v[172:175]
  ds_read_b64_tr_b16 v[20:21], v2 offset:18464
  v_mfma_f32_16x16x32_bf16 v[168:171], v[24:27], v[228:231], v[168:171]
  ds_read_b64_tr_b16 v[22:23], v2 offset:18976
  v_mfma_f32_16x16x32_bf16 v[164:167], v[28:31], v[224:227], v[164:167]
  ds_read_b64_tr_b16 v[24:25], v3 offset:18432
  v_mfma_f32_16x16x32_bf16 v[160:163], v[28:31], v[228:231], v[160:163]
  ds_read_b64_tr_b16 v[26:27], v3 offset:18944
  s_waitcnt lgkmcnt(6)
  v_mfma_f32_16x16x32_bf16 v[172:175], v[32:35], v[112:115], v[172:175]
  ds_read_b64_tr_b16 v[28:29], v3 offset:18464
  v_mfma_f32_16x16x32_bf16 v[168:171], v[32:35], v[116:119], v[168:171]
  ds_read_b64_tr_b16 v[30:31], v3 offset:18976
  v_mfma_f32_16x16x32_bf16 v[164:167], v[36:39], v[112:115], v[164:167]
  ds_read_b64_tr_b16 v[32:33], v2 offset:19456
  v_mfma_f32_16x16x32_bf16 v[160:163], v[36:39], v[116:119], v[160:163]
  ds_read_b64_tr_b16 v[34:35], v2 offset:19968
  v_mfma_f32_16x16x32_bf16 v[172:175], v[40:43], v[120:123], v[172:175]
  ds_read_b64_tr_b16 v[36:37], v2 offset:19488
  v_mfma_f32_16x16x32_bf16 v[168:171], v[40:43], v[124:127], v[168:171]
  s_waitcnt vmcnt(1)
  buffer_store_dword v5, off, s[60:63], s84 offset:28 sc1
  v_mfma_f32_16x16x32_bf16 v[164:167], v[44:47], v[120:123], v[164:167]
  ds_read_b64_tr_b16 v[38:39], v2 offset:20000
  ds_read_b64_tr_b16 v[40:41], v3 offset:19456
  v_mfma_f32_16x16x32_bf16 v[160:163], v[44:47], v[124:127], v[160:163]
  ds_read_b64_tr_b16 v[42:43], v3 offset:19968
  s_waitcnt lgkmcnt(6)
  v_mfma_f32_16x16x32_bf16 v[172:175], v[16:19], a[232:235], v[172:175]
  ds_read_b64_tr_b16 v[44:45], v3 offset:19488
  v_mfma_f32_16x16x32_bf16 v[168:171], v[16:19], a[236:239], v[168:171]
  ds_read_b64_tr_b16 v[46:47], v3 offset:20000
ffn_hop94:
  s_cbranch_execz ffn_hop95
  v_mfma_f32_16x16x32_bf16 v[164:167], v[20:23], a[232:235], v[164:167]
  ds_read_b64_tr_b16 v[16:17], v2 offset:20480
  v_mfma_f32_16x16x32_bf16 v[160:163], v[20:23], a[236:239], v[160:163]
  ds_read_b64_tr_b16 v[18:19], v2 offset:20992
  v_mfma_f32_16x16x32_bf16 v[172:175], v[24:27], a[240:243], v[172:175]
  ds_read_b64_tr_b16 v[20:21], v2 offset:20512
  v_mfma_f32_16x16x32_bf16 v[168:171], v[24:27], a[244:247], v[168:171]
  ds_read_b64_tr_b16 v[22:23], v2 offset:21024
  v_mfma_f32_16x16x32_bf16 v[164:167], v[28:31], a[240:243], v[164:167]
  ds_read_b64_tr_b16 v[24:25], v3 offset:20480
  v_mfma_f32_16x16x32_bf16 v[160:163], v[28:31], a[244:247], v[160:163]
  ds_read_b64_tr_b16 v[26:27], v3 offset:20992
  s_waitcnt lgkmcnt(6)
  v_mfma_f32_16x16x32_bf16 v[172:175], v[32:35], v[208:211], v[172:175]
  ds_read_b64_tr_b16 v[28:29], v3 offset:20512
  v_mfma_f32_16x16x32_bf16 v[168:171], v[32:35], v[212:215], v[168:171]
  ds_read_b64_tr_b16 v[30:31], v3 offset:21024
  v_mfma_f32_16x16x32_bf16 v[164:167], v[36:39], v[208:211], v[164:167]
  v_mfma_f32_16x16x32_bf16 v[160:163], v[36:39], v[212:215], v[160:163]
  v_mfma_f32_16x16x32_bf16 v[172:175], v[40:43], a[224:227], v[172:175]
  v_mfma_f32_16x16x32_bf16 v[168:171], v[40:43], a[228:231], v[168:171]
  v_mfma_f32_16x16x32_bf16 v[164:167], v[44:47], a[224:227], v[164:167]
  v_mfma_f32_16x16x32_bf16 v[160:163], v[44:47], a[228:231], v[160:163]
  s_waitcnt lgkmcnt(0)
  v_mfma_f32_16x16x32_bf16 v[172:175], v[16:19], a[248:251], v[172:175]
  v_mfma_f32_16x16x32_bf16 v[168:171], v[16:19], a[252:255], v[168:171]
  v_mfma_f32_16x16x32_bf16 v[164:167], v[20:23], a[248:251], v[164:167]
  v_mfma_f32_16x16x32_bf16 v[160:163], v[20:23], a[252:255], v[160:163]
  v_mfma_f32_16x16x32_bf16 v[172:175], v[24:27], v[176:179], v[172:175]
  v_mfma_f32_16x16x32_bf16 v[168:171], v[24:27], v[180:183], v[168:171]
  v_mfma_f32_16x16x32_bf16 v[164:167], v[28:31], v[176:179], v[164:167]
  v_mfma_f32_16x16x32_bf16 v[160:163], v[28:31], v[180:183], v[160:163]
  v_mov_b32 v187, 0
  buffer_atomic_or v187, v204, s[60:63], 0 offen offset:24 sc0
  v_mov_b32 v235, 0
  buffer_atomic_or v235, v204, s[60:63], 0 offen offset:28 sc0
  s_mov_b32 s3, s48
  s_or_b32 s3, s3, s49
  s_cmp_lg_u32 s3, 0
  s_cbranch_scc1 ffn_redo
ffn_redone:
  v_mul_f32 v40, v11, v11
  v_mul_f32 v41, v13, v13
  v_mul_f32 v40, 0.48045301391820144, v40
  v_mul_f32 v41, 0.48045301391820144, v41
  s_bitcmp1_b32 s18, 0
  s_cselect_b64 vcc, -1, 0
  v_cndmask_b32 v42, v40, v41, vcc
  v_mfma_f32_16x16x32_bf16 v[172:175], v[190:193], a[144:147], v[172:175]
  v_mfma_f32_16x16x32_bf16 v[164:167], v[188:191], a[144:147], v[164:167]
  v_mfma_f32_16x16x32_bf16 v[172:175], v[190:193], a[152:155], v[172:175]
  v_mfma_f32_16x16x32_bf16 v[164:167], v[188:191], a[152:155], v[164:167]
  v_mfma_f32_16x16x32_bf16 v[168:171], v[190:193], a[148:151], v[168:171]
  v_mfma_f32_16x16x32_bf16 v[160:163], v[188:191], a[148:151], v[160:163]
  v_mfma_f32_16x16x32_bf16 v[168:171], v[190:193], a[156:159], v[168:171]
  v_mfma_f32_16x16x32_bf16 v[160:163], v[188:191], a[156:159], v[160:163]
  v_mfma_f32_16x16x32_bf16 v[172:175], v[190:193], a[160:163], v[172:175]
  v_mfma_f32_16x16x32_bf16 v[164:167], v[188:191], a[160:163], v[164:167]
  v_mfma_f32_16x16x32_bf16 v[172:175], v[190:193], a[168:171], v[172:175]
  v_mfma_f32_16x16x32_bf16 v[164:167], v[188:191], a[168:171], v[164:167]
  v_mfma_f32_16x16x32_bf16 v[168:171], v[190:193], a[164:167], v[168:171]
  v_mfma_f32_16x16x32_bf16 v[160:163], v[188:191], a[164:167], v[160:163]
  v_mfma_f32_16x16x32_bf16 v[168:171], v[190:193], a[172:175], v[168:171]
  v_mfma_f32_16x16x32_bf16 v[160:163], v[188:191], a[172:175], v[160:163]
  s_waitcnt vmcnt(3)
  v_cmp_eq_u32 vcc, 0, v186
  s_nop 1
  s_and_b32 s50, vcc_lo, s8
  s_cbranch_scc1 ffn_rwC
ffn_rbC:
  buffer_load_dwordx4 a[176:179], v207, s[24:27], s46 offen offset:0 sc1 nt
  buffer_load_dwordx4 a[180:183], v207, s[24:27], s46 offen offset:1024 sc1 nt
  buffer_load_dwordx4 a[184:187], v207, s[24:27], s79 offen offset:0 sc1 nt
  buffer_load_dwordx4 a[188:191], v207, s[24:27], s79 offen offset:1024 sc1 nt
  s_waitcnt vmcnt(5)
ffn_hop95:
  s_cbranch_execz ffn_hop96
  v_cmp_eq_u32 vcc, 0, v187
  s_nop 1
  s_and_b32 s51, vcc_lo, s9
  s_cbranch_scc1 ffn_rwD
ffn_rbD:
  buffer_load_dwordx4 a[136:139], v232, s[24:27], s20 offen sc1 nt
  buffer_load_dwordx4 a[140:143], v232, s[24:27], s21 offen sc1 nt
  buffer_load_dwordx4 a[0:3], v232, s[24:27], s22 offen sc1 nt
  buffer_load_dwordx4 a[4:7], v232, s[24:27], s23 offen sc1 nt
  buffer_load_dwordx4 a[8:11], v232, s[24:27], s44 offen sc1 nt
  buffer_load_dwordx4 a[12:15], v232, s[24:27], s45 offen sc1 nt
  buffer_load_dwordx4 a[16:19], v232, s[24:27], s46 offen sc1 nt
  buffer_load_dwordx4 a[20:23], v232, s[24:27], s79 offen sc1 nt
  s_waitcnt vmcnt(12)
  v_cmp_eq_u32 vcc, 0, v235
  s_nop 1
  s_and_b32 s65, vcc_lo, s13
  s_cbranch_scc1 ffn_rwE
ffn_rbE:
  buffer_load_dwordx4 a[128:131], v207, s[24:27], s21 offen offset:0 sc1 nt
  buffer_load_dwordx4 a[132:135], v207, s[24:27], s21 offen offset:1024 sc1 nt
  s_waitcnt vmcnt(13)
  v_mfma_f32_16x16x32_bf16 v[172:175], v[190:193], a[176:179], v[172:175]
  v_mfma_f32_16x16x32_bf16 v[164:167], v[188:191], a[176:179], v[164:167]
  s_waitcnt vmcnt(11)
  v_mfma_f32_16x16x32_bf16 v[172:175], v[190:193], a[184:187], v[172:175]
  v_mfma_f32_16x16x32_bf16 v[164:167], v[188:191], a[184:187], v[164:167]
  v_mfma_f32_16x16x32_bf16 v[168:171], v[190:193], a[180:183], v[168:171]
  v_mfma_f32_16x16x32_bf16 v[160:163], v[188:191], a[180:183], v[160:163]
  s_waitcnt vmcnt(10)
  v_mfma_f32_16x16x32_bf16 v[168:171], v[190:193], a[188:191], v[168:171]
  v_mfma_f32_16x16x32_bf16 v[160:163], v[188:191], a[188:191], v[160:163]
  s_waitcnt vmcnt(9)
  v_mfma_f32_16x16x32_bf16 v[196:199], v[190:193], a[136:139], 0
  v_mfma_f32_16x16x32_bf16 v[200:203], v[188:191], a[136:139], 0
  s_waitcnt vmcnt(8)
  v_mfma_f32_16x16x32_bf16 v[196:199], v[190:193], a[140:143], v[196:199]
  v_mfma_f32_16x16x32_bf16 v[200:203], v[188:191], a[140:143], v[200:203]
  s_waitcnt vmcnt(7)
  v_mfma_f32_16x16x32_bf16 v[196:199], v[190:193], a[0:3], v[196:199]
  v_mfma_f32_16x16x32_bf16 v[200:203], v[188:191], a[0:3], v[200:203]
  s_waitcnt vmcnt(6)
  v_mfma_f32_16x16x32_bf16 v[196:199], v[190:193], a[4:7], v[196:199]
  v_mfma_f32_16x16x32_bf16 v[200:203], v[188:191], a[4:7], v[200:203]
  s_waitcnt vmcnt(5)
  v_mfma_f32_16x16x32_bf16 v[196:199], v[190:193], a[8:11], v[196:199]
  v_mfma_f32_16x16x32_bf16 v[200:203], v[188:191], a[8:11], v[200:203]
  s_waitcnt vmcnt(4)
  v_mfma_f32_16x16x32_bf16 v[196:199], v[190:193], a[12:15], v[196:199]
  v_mfma_f32_16x16x32_bf16 v[200:203], v[188:191], a[12:15], v[200:203]
  s_waitcnt vmcnt(3)
  v_mfma_f32_16x16x32_bf16 v[196:199], v[190:193], a[16:19], v[196:199]
  v_mfma_f32_16x16x32_bf16 v[200:203], v[188:191], a[16:19], v[200:203]
  s_waitcnt vmcnt(2)
  v_mfma_f32_16x16x32_bf16 v[196:199], v[190:193], a[20:23], v[196:199]
  v_mfma_f32_16x16x32_bf16 v[200:203], v[188:191], a[20:23], v[200:203]
  v_lshlrev_b32 v64, 16, v244
  v_and_b32 v65, 0xffff0000, v244
  v_lshlrev_b32 v66, 16, v245
  v_and_b32 v67, 0xffff0000, v245
  v_lshlrev_b32 v68, 16, v246
  v_and_b32 v69, 0xffff0000, v246
  v_lshlrev_b32 v70, 16, v247
  v_and_b32 v71, 0xffff0000, v247
  v_fmac_f32 v64, v42, v196
  v_fmac_f32 v65, v42, v197
  v_fmac_f32 v66, v42, v198
  v_fmac_f32 v67, v42, v199
  v_fmac_f32 v68, v42, v200
  v_fmac_f32 v69, v42, v201
  v_fmac_f32 v70, v42, v202
  v_fmac_f32 v71, v42, v203
  v_cvt_pk_bf16_f32 v56, v64, v65
  v_cvt_pk_bf16_f32 v57, v66, v67
  v_cvt_pk_bf16_f32 v58, v68, v69
  v_cvt_pk_bf16_f32 v59, v70, v71
  s_lshl_b32 s3, s75, 1
  v_permlane16_swap_b32 v56, v58
  v_permlane16_swap_b32 v57, v59
  buffer_store_dwordx4 v[56:59], v234, s[28:31], s3 offen offset:0
  s_waitcnt vmcnt(2)
  v_mfma_f32_16x16x32_bf16 v[172:175], v[190:193], a[128:131], v[172:175]
  v_mfma_f32_16x16x32_bf16 v[164:167], v[188:191], a[128:131], v[164:167]
  s_waitcnt vmcnt(1)
ffn_hop96:
  s_cbranch_execz ffn_hopret
  v_mfma_f32_16x16x32_bf16 v[168:171], v[190:193], a[132:135], v[168:171]
  v_mfma_f32_16x16x32_bf16 v[160:163], v[188:191], a[132:135], v[160:163]
  v_lshlrev_b32 v64, 16, v236
  v_and_b32 v65, 0xffff0000, v236
  v_lshlrev_b32 v66, 16, v237
  v_and_b32 v67, 0xffff0000, v237
  v_lshlrev_b32 v68, 16, v240
  v_and_b32 v69, 0xffff0000, v240
  v_lshlrev_b32 v70, 16, v241
  v_and_b32 v71, 0xffff0000, v241
  v_fmac_f32 v64, v40, v172
  v_fmac_f32 v65, v40, v173
  v_fmac_f32 v66, v40, v174
  v_fmac_f32 v67, v40, v175
  v_fmac_f32 v68, v40, v164
  v_fmac_f32 v69, v40, v165
  v_fmac_f32 v70, v40, v166
  v_fmac_f32 v71, v40, v167
  v_cvt_pk_bf16_f32 v48, v64, v65
  v_cvt_pk_bf16_f32 v49, v66, v67
  v_cvt_pk_bf16_f32 v50, v68, v69
  v_cvt_pk_bf16_f32 v51, v70, v71
  s_lshl_b32 s3, s74, 1
  v_permlane16_swap_b32 v48, v50
  v_permlane16_swap_b32 v49, v51
  buffer_store_dwordx4 v[48:51], v206, s[28:31], s3 offen offset:0
  v_lshlrev_b32 v64, 16, v238
  v_and_b32 v65, 0xffff0000, v238
  v_lshlrev_b32 v66, 16, v239
  v_and_b32 v67, 0xffff0000, v239
  v_lshlrev_b32 v68, 16, v242
  v_and_b32 v69, 0xffff0000, v242
  v_lshlrev_b32 v70, 16, v243
  v_and_b32 v71, 0xffff0000, v243
  v_fmac_f32 v64, v41, v168
  v_fmac_f32 v65, v41, v169
  v_fmac_f32 v66, v41, v170
  v_fmac_f32 v67, v41, v171
  v_fmac_f32 v68, v41, v160
  v_fmac_f32 v69, v41, v161
  v_fmac_f32 v70, v41, v162
  v_fmac_f32 v71, v41, v163
  v_cvt_pk_bf16_f32 v52, v64, v65
  v_cvt_pk_bf16_f32 v53, v66, v67
  v_cvt_pk_bf16_f32 v54, v68, v69
  v_cvt_pk_bf16_f32 v55, v70, v71
  s_lshl_b32 s3, s74, 1
  v_permlane16_swap_b32 v52, v54
  v_permlane16_swap_b32 v53, v55
  buffer_store_dwordx4 v[52:55], v206, s[28:31], s3 offen offset:1152
ffn_end:
  s_endpgm
ffn_hopret:
  s_setpc_b64 s[90:91]
ffn_slow0:

  s_mov_b32 s87, 0x40000
ffn_spin0:
  buffer_load_dword v184, off, s[60:63], s85 offset:0 sc1
  s_waitcnt vmcnt(0)
  v_readfirstlane_b32 s77, v184
  s_sub_u32 s87, s87, 1
  s_cbranch_scc1 ffn_back0
  s_nop 1
  s_cmp_lg_u32 s77, 0
  s_cbranch_scc0 ffn_spin0
  s_branch ffn_back0
ffn_slow1:

  s_mov_b32 s87, 0x40000
ffn_spin1:
  buffer_load_dword v184, off, s[60:63], s85 offset:4 sc1
  s_waitcnt vmcnt(0)
  v_readfirstlane_b32 s77, v184
  s_sub_u32 s87, s87, 1
  s_cbranch_scc1 ffn_back1
  s_nop 1
  s_cmp_lg_u32 s77, 0
  s_cbranch_scc0 ffn_spin1
  s_branch ffn_back1
ffn_slow2:

  s_mov_b32 s87, 0x40000
ffn_spin2:
  buffer_load_dword v184, off, s[60:63], s85 offset:8 sc1
  s_waitcnt vmcnt(0)
  v_readfirstlane_b32 s77, v184
  s_sub_u32 s87, s87, 1
  s_cbranch_scc1 ffn_back2
  s_nop 1
  s_cmp_lg_u32 s77, 0
  s_cbranch_scc0 ffn_spin2
  s_branch ffn_back2
ffn_rwC:

  s_mov_b32 s87, 0x40000
ffn_rsC:
  v_mov_b32 v186, 0
  buffer_atomic_or v186, v204, s[60:63], 0 offen offset:20 sc0
  s_sub_u32 s87, s87, 1
  s_cbranch_scc1 ffn_rsCx
  s_waitcnt vmcnt(0)
  v_cmp_eq_u32 vcc, 0, v186
  s_nop 1
  s_and_b32 s50, vcc_lo, s8
  s_cbranch_scc0 ffn_rsCx
  s_sleep 2
  s_branch ffn_rsC
ffn_rsCx:
  s_branch ffn_rbC
ffn_rwD:

  s_mov_b32 s87, 0x40000
ffn_rsD:
  v_mov_b32 v187, 0
  buffer_atomic_or v187, v204, s[60:63], 0 offen offset:24 sc0
  s_sub_u32 s87, s87, 1
  s_cbranch_scc1 ffn_rsDx
  s_waitcnt vmcnt(0)
  v_cmp_eq_u32 vcc, 0, v187
  s_nop 1
  s_and_b32 s51, vcc_lo, s9
  s_cbranch_scc0 ffn_rsDx
  s_sleep 2
  s_branch ffn_rsD
ffn_rsDx:
  s_branch ffn_rbD
ffn_rwE:

  s_mov_b32 s87, 0x40000
ffn_rsE:
  v_mov_b32 v235, 0
  buffer_atomic_or v235, v204, s[60:63], 0 offen offset:28 sc0
  s_sub_u32 s87, s87, 1
  s_cbranch_scc1 ffn_rsEx
  s_waitcnt vmcnt(0)
  v_cmp_eq_u32 vcc, 0, v235
  s_nop 1
  s_and_b32 s65, vcc_lo, s13
  s_cbranch_scc0 ffn_rsEx
  s_sleep 2
  s_branch ffn_rsE
ffn_rsEx:
  s_branch ffn_rbE
ffn_redo:
  s_cmp_eq_u32 s48, 0
  s_cbranch_scc1 ffn_redo0n
  s_mov_b32 s87, 0x40000
ffn_redo0:
  v_mov_b32 v184, 0
  buffer_atomic_or v184, v204, s[60:63], 0 offen offset:12 sc0
  s_sub_u32 s87, s87, 1
  s_cbranch_scc1 ffn_redo0x
  s_waitcnt vmcnt(0)
  v_cmp_eq_u32 vcc, 0, v184
  s_nop 1
  s_and_b32 s48, vcc_lo, s4
  s_cbranch_scc0 ffn_redo0x
  s_sleep 2
  s_branch ffn_redo0
ffn_redo0x:
  buffer_load_dwordx4 a[144:147], v207, s[24:27], s22 offen offset:0 sc1 nt
  buffer_load_dwordx4 a[148:151], v207, s[24:27], s22 offen offset:1024 sc1 nt
  buffer_load_dwordx4 a[152:155], v207, s[24:27], s23 offen offset:0 sc1 nt
  buffer_load_dwordx4 a[156:159], v207, s[24:27], s23 offen offset:1024 sc1 nt
ffn_redo0n:
  s_cmp_eq_u32 s49, 0
  s_cbranch_scc1 ffn_redo1n
  s_mov_b32 s87, 0x40000
ffn_redo1:
  v_mov_b32 v185, 0
  buffer_atomic_or v185, v204, s[60:63], 0 offen offset:16 sc0
  s_sub_u32 s87, s87, 1
  s_cbranch_scc1 ffn_redo1x
  s_waitcnt vmcnt(0)
  v_cmp_eq_u32 vcc, 0, v185
  s_nop 1
  s_and_b32 s49, vcc_lo, s5
  s_cbranch_scc0 ffn_redo1x
  s_sleep 2
  s_branch ffn_redo1
ffn_redo1x:
  buffer_load_dwordx4 a[160:163], v207, s[24:27], s44 offen offset:0 sc1 nt
  buffer_load_dwordx4 a[164:167], v207, s[24:27], s44 offen offset:1024 sc1 nt
  buffer_load_dwordx4 a[168:171], v207, s[24:27], s45 offen offset:0 sc1 nt
  buffer_load_dwordx4 a[172:175], v207, s[24:27], s45 offen offset:1024 sc1 nt
ffn_redo1n:
  s_waitcnt vmcnt(0)
  s_branch ffn_redone
.section .rodata,"a"
.p2align 6
.amdhsa_kernel ffn_kernel
  .amdhsa_next_free_vgpr 512
  .amdhsa_next_free_sgpr 96
  .amdhsa_accum_offset 256
  .amdhsa_group_segment_fixed_size 0
  .amdhsa_kernarg_size 104
  .amdhsa_user_sgpr_count 2
  .amdhsa_user_sgpr_kernarg_segment_ptr 1
  .amdhsa_system_sgpr_workgroup_id_x 1
  .amdhsa_float_denorm_mode_32 3
.end_amdhsa_kernel
.text
code_end:
  s_endpgm
```
